```python
import torch

def _softmax(x, axis=-1):
    return torch.softmax(x, dim=axis)

def _gelu(x):
    return torch.nn.functional.gelu(x, approximate='tanh')

def _silu(x):
    return torch.nn.functional.silu(x)

def _sigmoid(x):
    return torch.sigmoid(x)

def _layernorm(x, axis=-1, eps=1e-05):
    m = x.mean(dim=axis, keepdim=True)
    v = x.var(dim=axis, keepdim=True, unbiased=False)
    return (x - m) / torch.sqrt(v + eps)

def _scatter_add(tgt, idx, src, axis=0):
    return tgt.clone().index_add_(axis, idx, src)

def _segment_sum(src, seg, n):
    out = torch.zeros((n,) + src.shape[1:], dtype=src.dtype)
    return out.index_add_(0, seg, src)

def _pad(x, pw):
    flat = tuple((v for pair in reversed(pw) for v in pair))
    return torch.nn.functional.pad(x, flat)
kernel_name = 'parallel_sum__ssm_conv_s4d__mixer_gmlp__prompt'

def setup_inputs():

    _w = lambda a: (lambda t: t.to(torch.bfloat16) if t.is_floating_point() else t)(torch.as_tensor(a))

    def _A_setup():
        Bsz, L, D, N = (1, 2048, 640, 128)
        return {'u': _w((lambda *s: torch.randn(*s, dtype=torch.bfloat16) * 0.05)(Bsz, L, D)), 'log_A_real': _w((lambda *s: torch.randn(*s, dtype=torch.bfloat16) * 3.2)(D, N) * 0.5), 'A_imag': _w((lambda *s: torch.randn(*s, dtype=torch.bfloat16) * 0.1)(D, N) * 3.14), 'C_real': _w((lambda *s: torch.randn(*s, dtype=torch.bfloat16) * 3.2)(D, N) / N ** 0.5), 'C_imag': _w((lambda *s: torch.randn(*s, dtype=torch.bfloat16) * 3.2)(D, N) / N ** 0.5), 'log_dt': _w((lambda *s: torch.randn(*s, dtype=torch.bfloat16) * 0.1)(D) * 0.5 - 4.0), 'D_skip': _w((lambda *s: torch.randn(*s, dtype=torch.bfloat16) * 0.4)(D))}
    _A_in = _A_setup()

    def _B_setup():
        B, S, D, F = (1, 2048, 640, 1728)
        Fh = F // 2
        return {'x': _w((lambda *s: torch.randn(*s, dtype=torch.bfloat16) * 0.05)(B, S, D)), 'w_in': _w((lambda *s: torch.randn(*s, dtype=torch.bfloat16) * 0.2)(D, 2 * Fh)), 'w_sp': _w(0.01 * (lambda *s: torch.randn(*s, dtype=torch.bfloat16) * 0.2)(S, S)), 'b_sp': _w(1.0 + 0.01 * (lambda *s: torch.randn(*s, dtype=torch.bfloat16) * 0.05)(S)), 'w_out': _w((lambda *s: torch.randn(*s, dtype=torch.bfloat16) * 0.05)(Fh, D))}
    _B_in = _B_setup()
    return {'A_u': _A_in['u'], 'A_log_A_real': _A_in['log_A_real'], 'A_A_imag': _A_in['A_imag'], 'A_C_real': _A_in['C_real'], 'A_C_imag': _A_in['C_imag'], 'A_log_dt': _A_in['log_dt'], 'A_D_skip': _A_in['D_skip'], 'B_x': _B_in['x'], 'B_w_in': _B_in['w_in'], 'B_w_sp': _B_in['w_sp'], 'B_b_sp': _B_in['b_sp'], 'B_w_out': _B_in['w_out']}

def reference(A_u, A_log_A_real, A_A_imag, A_C_real, A_C_imag, A_log_dt, A_D_skip, B_x, B_w_in, B_w_sp, B_b_sp, B_w_out):

    def _A_ref(u, log_A_real, A_imag, C_real, C_imag, log_dt, D_skip):
        L = u.shape[1]
        dt = torch.exp(log_dt)
        A = -torch.exp(log_A_real) + 1j * A_imag
        C = (C_real + 1j * C_imag) * dt[:, None]
        pos = (lambda x, dt: x.to(dt))(torch.arange(L), log_dt.dtype)
        P = torch.exp((A * dt[:, None])[:, :, None] * pos[None, None, :])
        K = 2.0 * torch.einsum('dn,dnl->dl', C, P).real
        L2 = 2 * L
        u_t = (lambda x, *d: x.permute(*d))(u, 0, 2, 1)
        Kf = (lambda x, *a, **k: torch.fft.rfft(x.float(), *a, **k))(K, L2)
        Uf = (lambda x, *a, **k: torch.fft.rfft(x.float(), *a, **k))(u_t, L2)
        y = (lambda x, *a, **k: torch.fft.irfft(x, *a, **k).to(torch.bfloat16))(Uf * Kf[None, :, :], L2)[:, :, :L]
        y = (lambda x, *d: x.permute(*d))(y, 0, 2, 1)
        return y + u * D_skip[None, None, :]

    def _B_ref(x, w_in, w_sp, b_sp, w_out):
        B, S, D = x.shape
        F = w_in.shape[-1]
        Fh = F // 2
        z = _gelu(torch.einsum('bsd,df->bsf', x, w_in))
        z1 = z[..., :Fh].clone()
        z2 = _layernorm(z[..., Fh:], axis=-1)
        g = torch.einsum('ts,bsf->btf', w_sp, z2) + b_sp[None, :, None]
        return torch.einsum('bsf,fd->bsd', z1 * g, w_out)
    x = A_u
    xn = _layernorm(x, axis=-1)
    return x + _A_ref(xn, A_log_A_real, A_A_imag, A_C_real, A_C_imag, A_log_dt, A_D_skip) + _B_ref(xn, B_w_in, B_w_sp, B_b_sp, B_w_out)
```

```asm
; @launch grid=(256,1,1) block=(512,1,1) lds=163840
.amdgcn_target "amdgcn-amd-amdhsa--gfx950"
.text
.globl parallel_sum__ssm_conv_s4d__mixer_gmlp__prompt_kernel
.p2align 8
.type parallel_sum__ssm_conv_s4d__mixer_gmlp__prompt_kernel,@function
parallel_sum__ssm_conv_s4d__mixer_gmlp__prompt_kernel:
    s_cmp_ge_u32 s2, 256
    s_cbranch_scc1 L_exit
    s_load_dwordx2 s[36:37], s[0:1], 0
    s_load_dwordx2 s[52:53], s[0:1], 64
    s_load_dwordx2 s[64:65], s[0:1], 112
    v_lshrrev_b32 v1, 6, v0
    s_and_b32 s78, s2, 7
    s_lshr_b32 s79, s2, 3
    v_readfirstlane_b32 s3, v1
    s_cmp_ge_u32 s79, 24
    s_cbranch_scc1 L_ssm
    s_lshr_b32 s4, s78, 1
    s_lshl_b32 s4, s4, 3
    s_and_b32 s80, s79, 7
    s_add_u32 s4, s4, s80
    v_and_b32 v1, 63, v0
    s_and_b32 s5, s2, 1
    s_mul_i32 s5, s5, 3
    s_lshr_b32 s80, s2, 6
    s_add_u32 s5, s5, s80
    s_and_b32 s66, s3, 3
    s_and_b32 s78, s4, 7
    s_mul_i32 s70, s78, 221184
    s_lshl_b32 s72, s78, 13
    s_mul_i32 s71, s5, 288
    s_and_b32 s71, s71, 0xffffffc0
    s_add_u32 s71, s71, 1728
    s_add_u32 s70, s70, s71
    s_mul_i32 s83, s66, 5120
    s_add_u32 s83, s83, 81920
    s_mov_b32 s69, s83
    v_mov_b32 v2, 0
    v_mov_b32 v3, 0
    v_mov_b32 v4, 0
    v_mov_b32 v5, 0
    v_mov_b32 v6, 0
    s_waitcnt lgkmcnt(0)
    s_mov_b32 s12, s52
    s_mov_b32 s13, s53
    s_mov_b32 s14, 2211840
    s_mov_b32 s15, 0x20000
    s_lshr_b32 s78, s2, 6
    s_mul_i32 s78, s78, 3
    s_add_u32 s78, s78, s3
    s_and_b32 s78, s78, 7
    s_lshl_b32 s78, s78, 3
    v_lshrrev_b32 v16, 3, v1
    v_add_u32 v16, s78, v16
    v_and_b32 v17, 7, v0
    v_mul_u32_u24 v18, 1280, v16
    v_lshl_add_u32 v18, v17, 4, v18
    s_mul_i32 s78, s4, 81920
    s_and_b32 s73, s4, 7
    s_lshl_b32 s79, s73, 7
    s_waitcnt lgkmcnt(0)
    s_mov_b32 s8, s36
    s_mov_b32 s9, s37
    s_mov_b32 s10, 2621440
    s_mov_b32 s11, 0x20000
    s_add_u32 s80, s78, s79
    buffer_load_dwordx4 v[40:43], v18, s[8:11], s80 offen
    s_add_u32 s79, s79, 128
    s_cmp_ge_u32 s79, 1280
    s_cselect_b32 s79, 0, s79
    s_add_u32 s80, s78, s79
    buffer_load_dwordx4 v[44:47], v18, s[8:11], s80 offen
    s_add_u32 s79, s79, 128
    s_cmp_ge_u32 s79, 1280
    s_cselect_b32 s79, 0, s79
    s_add_u32 s80, s78, s79
    buffer_load_dwordx4 v[48:51], v18, s[8:11], s80 offen
    s_add_u32 s79, s79, 128
    s_cmp_ge_u32 s79, 1280
    s_cselect_b32 s79, 0, s79
    s_add_u32 s80, s78, s79
    buffer_load_dwordx4 v[52:55], v18, s[8:11], s80 offen
    s_add_u32 s79, s79, 128
    s_cmp_ge_u32 s79, 1280
    s_cselect_b32 s79, 0, s79
    s_add_u32 s80, s78, s79
    buffer_load_dwordx4 v[56:59], v18, s[8:11], s80 offen
    s_add_u32 s79, s79, 128
    s_cmp_ge_u32 s79, 1280
    s_cselect_b32 s79, 0, s79
    s_add_u32 s80, s78, s79
    buffer_load_dwordx4 v[60:63], v18, s[8:11], s80 offen
    s_add_u32 s79, s79, 128
    s_cmp_ge_u32 s79, 1280
    s_cselect_b32 s79, 0, s79
    s_add_u32 s80, s78, s79
    buffer_load_dwordx4 v[64:67], v18, s[8:11], s80 offen
    s_add_u32 s79, s79, 128
    s_cmp_ge_u32 s79, 1280
    s_cselect_b32 s79, 0, s79
    s_add_u32 s80, s78, s79
    buffer_load_dwordx4 v[68:71], v18, s[8:11], s80 offen
    s_add_u32 s79, s79, 128
    s_cmp_ge_u32 s79, 1280
    s_cselect_b32 s79, 0, s79
    s_add_u32 s80, s78, s79
    buffer_load_dwordx4 v[72:75], v18, s[8:11], s80 offen
    s_add_u32 s79, s79, 128
    s_cmp_ge_u32 s79, 1280
    s_cselect_b32 s79, 0, s79
    s_add_u32 s80, s78, s79
    buffer_load_dwordx4 v[76:79], v18, s[8:11], s80 offen
    s_add_u32 s79, s79, 128
    s_cmp_ge_u32 s79, 1280
    s_cselect_b32 s79, 0, s79
    s_cmp_lt_u32 s3, 4
    s_cbranch_scc1 Lnyp
    s_setprio 2
Lnyp:
    s_load_dwordx4 s[56:59], s[0:1], 72
    s_load_dwordx2 s[60:61], s[0:1], 96
    s_load_dword s6, s[64:65], 0
    s_lshr_b32 s67, s66, 1
    s_and_b32 s68, s66, 1
    s_mov_b32 s28, s64
    s_mov_b32 s29, s65
    s_mov_b32 s30, 33554432
    s_mov_b32 s31, 0x20000
    v_bfe_u32 v19, v16, 1, 3
    v_xor_b32 v19, v19, v17
    v_lshlrev_b32 v19, 4, v19
    v_lshl_add_u32 v19, v16, 7, v19
    v_lshrrev_b32 v20, 4, v1
    v_and_b32 v21, 15, v1
    v_lshrrev_b32 v22, 1, v21
    v_xor_b32 v22, v22, v20
    v_lshlrev_b32 v22, 4, v22
    v_lshl_add_u32 v8, v21, 7, v22
    s_lshl_b32 s78, s67, 12
    v_add_u32 v8, s78, v8
    v_xor_b32 v9, 64, v8
    v_mul_u32_u24 v11, 2560, v20
    v_bfe_u32 v22, v1, 2, 2
    v_mul_u32_u24 v22, 320, v22
    v_add_u32 v11, v11, v22
    v_and_b32 v22, 3, v1
    v_lshl_add_u32 v11, v22, 3, v11
    v_and_b32 v22, 1, v20
    v_lshlrev_b32 v22, 5, v22
    s_and_b32 s80, s5, 1
    s_mul_i32 s78, s68, 5
    s_add_u32 s78, s78, s80
    s_lshl_b32 s78, s78, 5
    v_xor_b32 v23, s78, v22
    v_add_u32 v10, v23, v11
    s_add_u32 s78, s78, 32
    v_xor_b32 v23, s78, v22
    v_add_u32 v38, v23, v11
    s_lshl_b32 s80, s80, 5
    s_add_u32 s80, s80, 128
    v_xor_b32 v23, s80, v22
    v_add_u32_e64 v11, v23, v11
    s_mov_b32 s76, 0xbdd2d3e8
    s_mov_b32 s77, 0xbdd2d3e8
    v_mov_b32 v32, 0xc0135761
    v_mov_b32 v33, 0xc0135761
    s_waitcnt lgkmcnt(0)
    s_mov_b32 s16, s56
    s_mov_b32 s17, s57
    s_mov_b32 s18, 8388608
    s_mov_b32 s19, 0x20000
    s_mov_b32 s32, s58
    s_mov_b32 s33, s59
    s_mov_b32 s34, 4096
    s_mov_b32 s35, 0x20000
    s_mov_b32 s24, s60
    s_mov_b32 s25, s61
    s_mov_b32 s26, 2621440
    s_mov_b32 s27, 0x20000
    s_mul_i32 s78, s66, 320
    v_add_u32 v20, s78, v1
    s_add_u32 s78, s78, 64
    v_mul_u32_u24 v21, 3277, v20
    v_lshrrev_b32 v21, 16, v21
    v_mul_u32_u24 v22, 20, v21
    v_sub_u32 v22, v20, v22
    v_bfe_u32 v20, v21, 3, 1
    v_lshlrev_b32 v20, 1, v20
    v_xor_b32 v22, v22, v20
    v_mul_u32_u24 v2, 3456, v21
    v_lshl_add_u32 v2, v22, 4, v2
    v_add_u32 v20, s78, v1
    s_add_u32 s78, s78, 64
    v_mul_u32_u24 v21, 3277, v20
    v_lshrrev_b32 v21, 16, v21
    v_mul_u32_u24 v22, 20, v21
    v_sub_u32 v22, v20, v22
    v_bfe_u32 v20, v21, 3, 1
    v_lshlrev_b32 v20, 1, v20
    v_xor_b32 v22, v22, v20
    v_mul_u32_u24 v3, 3456, v21
    v_lshl_add_u32 v3, v22, 4, v3
    v_subrev_u32 v3, 1024, v3
    v_add_u32 v20, s78, v1
    s_add_u32 s78, s78, 64
    v_mul_u32_u24 v21, 3277, v20
    v_lshrrev_b32 v21, 16, v21
    v_mul_u32_u24 v22, 20, v21
    v_sub_u32 v22, v20, v22
    v_bfe_u32 v20, v21, 3, 1
    v_lshlrev_b32 v20, 1, v20
    v_xor_b32 v22, v22, v20
    v_mul_u32_u24 v4, 3456, v21
    v_lshl_add_u32 v4, v22, 4, v4
    v_subrev_u32 v4, 2048, v4
    v_add_u32 v20, s78, v1
    s_add_u32 s78, s78, 64
    v_mul_u32_u24 v21, 3277, v20
    v_lshrrev_b32 v21, 16, v21
    v_mul_u32_u24 v22, 20, v21
    v_sub_u32 v22, v20, v22
    v_bfe_u32 v20, v21, 3, 1
    v_lshlrev_b32 v20, 1, v20
    v_xor_b32 v22, v22, v20
    v_mul_u32_u24 v5, 3456, v21
    v_lshl_add_u32 v5, v22, 4, v5
    v_subrev_u32 v5, 3072, v5
    v_add_u32 v20, s78, v1
    s_add_u32 s78, s78, 64
    v_mul_u32_u24 v21, 3277, v20
    v_lshrrev_b32 v21, 16, v21
    v_mul_u32_u24 v22, 20, v21
    v_sub_u32 v22, v20, v22
    v_bfe_u32 v20, v21, 3, 1
    v_lshlrev_b32 v20, 1, v20
    v_xor_b32 v22, v22, v20
    v_mul_u32_u24 v6, 3456, v21
    v_lshl_add_u32 v6, v22, 4, v6
    v_mov_b32 v7, 0
    v_mov_b32 v37, 0
    v_mov_b32 v248, 0
    s_cmp_ge_u32 s3, 4
    s_cbranch_scc1 L_xs
    v_lshlrev_b32 v7, 4, v1
    v_and_b32 v37, 31, v1
    v_min_u32 v37, 26, v37
    v_lshlrev_b32 v37, 7, v37
    s_min_u32 s78, s5, 4
    s_lshl_b32 s91, s78, 1
    s_add_u32 s91, s91, s67
    s_lshl_b32 s91, s91, 12
    s_add_u32 s91, s91, 458752
    s_lshl_b32 s78, s78, 2
    s_add_u32 s78, s78, s66
    s_mul_i32 s93, s78, 55296
    s_add_u32 s93, s93, 15597568
    s_add_u32 s94, s93, 27648
    s_mul_i32 s44, s5, 4096
    s_lshr_b32 s7, s2, 6
    s_sub_u32 s51, s5, s7
    s_mov_b32 s50, 0
    s_add_u32 s7, s7, 1
    s_cmp_ge_u32 s7, 3
    s_cselect_b32 s7, 0, s7
    s_add_u32 s92, s7, s51
    s_mul_i32 s45, s92, 4096
    s_lshl_b32 s92, s92, 2
    s_lshl_b32 s92, 1, s92
    s_or_b32 s50, s50, s92
    s_add_u32 s7, s7, 1
    s_cmp_ge_u32 s7, 3
    s_cselect_b32 s7, 0, s7
    s_add_u32 s92, s7, s51
    s_mul_i32 s46, s92, 4096
    s_lshl_b32 s92, s92, 2
    s_lshl_b32 s92, 2, s92
    s_or_b32 s50, s50, s92
    s_sub_u32 s51, 3, s51
    s_add_u32 s7, s7, 1
    s_cmp_ge_u32 s7, 3
    s_cselect_b32 s7, 0, s7
    s_add_u32 s92, s7, s51
    s_mul_i32 s47, s92, 4096
    s_lshl_b32 s92, s92, 2
    s_lshl_b32 s92, 3, s92
    s_or_b32 s50, s50, s92
    s_add_u32 s7, s7, 1
    s_cmp_ge_u32 s7, 3
    s_cselect_b32 s7, 0, s7
    s_add_u32 s92, s7, s51
    s_mul_i32 s48, s92, 4096
    s_lshl_b32 s92, s92, 2
    s_lshl_b32 s92, 4, s92
    s_or_b32 s50, s50, s92
    s_add_u32 s7, s7, 1
    s_cmp_ge_u32 s7, 3
    s_cselect_b32 s7, 0, s7
    s_add_u32 s92, s7, s51
    s_mul_i32 s49, s92, 4096
    s_lshl_b32 s92, s92, 2
    s_lshl_b32 s92, 5, s92
    s_or_b32 s50, s50, s92
    v_lshrrev_b32 v240, 4, v1
    v_bfe_u32 v241, v1, 2, 2
    v_and_b32 v242, 3, v1
    v_lshl_add_u32 v243, v240, 3, v241
    v_add_u32 v243, 0, v243
    v_bfe_u32 v244, v243, 1, 3
    v_lshrrev_b32 v246, 1, v242
    v_xor_b32 v244, v244, v246
    v_lshlrev_b32 v244, 4, v244
    v_lshl_add_u32 v246, v243, 7, v244
    v_and_b32 v244, 1, v242
    v_lshl_add_u32 v246, v244, 3, v246
    v_lshl_add_u32 v243, v240, 3, v241
    v_add_u32 v243, 4, v243
    v_bfe_u32 v244, v243, 1, 3
    v_lshrrev_b32 v247, 1, v242
    v_xor_b32 v244, v244, v247
    v_lshlrev_b32 v244, 4, v244
    v_lshl_add_u32 v247, v243, 7, v244
    v_and_b32 v244, 1, v242
    v_lshl_add_u32 v247, v244, 3, v247
    v_and_b32 v248, 7, v1
    v_lshlrev_b32 v248, 12, v248
    v_lshl_add_u32 v248, v240, 4, v248
    v_bfe_u32 v243, v1, 3, 1
    v_lshl_add_u32 v248, v243, 6, v248
    s_mul_i32 s78, s5, 7
    s_sub_u32 s79, s5, 2
    s_max_i32 s79, s79, 0
    s_sub_u32 s78, s78, s79
    s_lshl_b32 s79, s66, 1
    s_add_u32 s78, s78, s79
    s_add_u32 s79, s78, 0
    s_and_b32 s80, s79, 3
    s_lshl_b32 s80, s80, 5
    s_lshr_b32 s81, s79, 2
    s_lshl_b32 s81, s81, 13
    v_xor_b32 v208, s80, v246
    v_add_u32 v208, s81, v208
    v_xor_b32 v209, s80, v247
    v_add_u32 v209, s81, v209
    s_add_u32 s79, s78, 1
    s_and_b32 s80, s79, 3
    s_lshl_b32 s80, s80, 5
    s_lshr_b32 s81, s79, 2
    s_lshl_b32 s81, s81, 13
    v_xor_b32 v210, s80, v246
    v_add_u32 v210, s81, v210
    v_xor_b32 v211, s80, v247
    v_add_u32 v211, s81, v211
    s_lshl_b32 s79, s4, 7
    s_add_u32 s79, s79, 1048576
    s_lshl_b32 s78, s78, 16
    s_add_u32 s38, s78, s79
    s_lshl_b32 s81, s5, 5
    s_add_u32 s81, s81, s4
    s_lshl_b32 s81, s81, 7
    s_add_u32 s39, s81, 917504
    s_mov_b32 s40, 0xffff0000
L_xs:
    v_mov_b32 v24, 0
    v_mov_b32 v25, 0
    s_mov_b32 s78, 0x3f803f80
    s_cmp_lt_u32 s3, 4
    s_waitcnt vmcnt(9)
    v_dot2c_f32_bf16 v24, s78, v40
    v_dot2c_f32_bf16 v25, v40, v40
    v_dot2c_f32_bf16 v24, s78, v41
    v_dot2c_f32_bf16 v25, v41, v41
    v_dot2c_f32_bf16 v24, s78, v42
    v_dot2c_f32_bf16 v25, v42, v42
    v_dot2c_f32_bf16 v24, s78, v43
    v_dot2c_f32_bf16 v25, v43, v43
    s_waitcnt vmcnt(8)
    v_dot2c_f32_bf16 v24, s78, v44
    v_dot2c_f32_bf16 v25, v44, v44
    v_dot2c_f32_bf16 v24, s78, v45
    v_dot2c_f32_bf16 v25, v45, v45
    v_dot2c_f32_bf16 v24, s78, v46
    v_dot2c_f32_bf16 v25, v46, v46
    v_dot2c_f32_bf16 v24, s78, v47
    v_dot2c_f32_bf16 v25, v47, v47
    s_waitcnt vmcnt(7)
    v_dot2c_f32_bf16 v24, s78, v48
    v_dot2c_f32_bf16 v25, v48, v48
    v_dot2c_f32_bf16 v24, s78, v49
    v_dot2c_f32_bf16 v25, v49, v49
    v_dot2c_f32_bf16 v24, s78, v50
    v_dot2c_f32_bf16 v25, v50, v50
    v_dot2c_f32_bf16 v24, s78, v51
    v_dot2c_f32_bf16 v25, v51, v51
    s_waitcnt vmcnt(6)
    v_dot2c_f32_bf16 v24, s78, v52
    v_dot2c_f32_bf16 v25, v52, v52
    v_dot2c_f32_bf16 v24, s78, v53
    v_dot2c_f32_bf16 v25, v53, v53
    v_dot2c_f32_bf16 v24, s78, v54
    v_dot2c_f32_bf16 v25, v54, v54
    v_dot2c_f32_bf16 v24, s78, v55
    v_dot2c_f32_bf16 v25, v55, v55
    s_waitcnt vmcnt(5)
    v_dot2c_f32_bf16 v24, s78, v56
    v_dot2c_f32_bf16 v25, v56, v56
    v_dot2c_f32_bf16 v24, s78, v57
    v_dot2c_f32_bf16 v25, v57, v57
    v_dot2c_f32_bf16 v24, s78, v58
    v_dot2c_f32_bf16 v25, v58, v58
    v_dot2c_f32_bf16 v24, s78, v59
    v_dot2c_f32_bf16 v25, v59, v59
    s_waitcnt vmcnt(4)
    v_dot2c_f32_bf16 v24, s78, v60
    v_dot2c_f32_bf16 v25, v60, v60
    v_dot2c_f32_bf16 v24, s78, v61
    v_dot2c_f32_bf16 v25, v61, v61
    v_dot2c_f32_bf16 v24, s78, v62
    v_dot2c_f32_bf16 v25, v62, v62
    v_dot2c_f32_bf16 v24, s78, v63
    v_dot2c_f32_bf16 v25, v63, v63
    s_waitcnt vmcnt(3)
    v_dot2c_f32_bf16 v24, s78, v64
    v_dot2c_f32_bf16 v25, v64, v64
    v_dot2c_f32_bf16 v24, s78, v65
    v_dot2c_f32_bf16 v25, v65, v65
    v_dot2c_f32_bf16 v24, s78, v66
    v_dot2c_f32_bf16 v25, v66, v66
    v_dot2c_f32_bf16 v24, s78, v67
    v_dot2c_f32_bf16 v25, v67, v67
    s_waitcnt vmcnt(2)
    v_dot2c_f32_bf16 v24, s78, v68
    v_dot2c_f32_bf16 v25, v68, v68
    v_dot2c_f32_bf16 v24, s78, v69
    v_dot2c_f32_bf16 v25, v69, v69
    v_dot2c_f32_bf16 v24, s78, v70
    v_dot2c_f32_bf16 v25, v70, v70
    v_dot2c_f32_bf16 v24, s78, v71
    v_dot2c_f32_bf16 v25, v71, v71
    s_waitcnt vmcnt(1)
    v_dot2c_f32_bf16 v24, s78, v72
    v_dot2c_f32_bf16 v25, v72, v72
    v_dot2c_f32_bf16 v24, s78, v73
    v_dot2c_f32_bf16 v25, v73, v73
    v_dot2c_f32_bf16 v24, s78, v74
    v_dot2c_f32_bf16 v25, v74, v74
    v_dot2c_f32_bf16 v24, s78, v75
    v_dot2c_f32_bf16 v25, v75, v75
    s_waitcnt vmcnt(0)
    v_dot2c_f32_bf16 v24, s78, v76
    v_dot2c_f32_bf16 v25, v76, v76
    v_dot2c_f32_bf16 v24, s78, v77
    v_dot2c_f32_bf16 v25, v77, v77
    v_dot2c_f32_bf16 v24, s78, v78
    v_dot2c_f32_bf16 v25, v78, v78
    v_dot2c_f32_bf16 v24, s78, v79
    v_dot2c_f32_bf16 v25, v79, v79
    s_cmp_ge_u32 s3, 4
    s_cbranch_scc1 L_xe
    s_mov_b32 m0, s69
    s_add_u32 s69, s69, 20480
    buffer_load_dwordx4 v2, s[12:15], s70 offen lds
    buffer_load_dwordx4 v3, s[12:15], s70 offen offset:1024 lds
    buffer_load_dwordx4 v4, s[12:15], s70 offen offset:2048 lds
    buffer_load_dwordx4 v5, s[12:15], s70 offen offset:3072 lds
    s_add_u32 m0, m0, 4096
    s_cmp_ge_u32 s69, 163840
    buffer_load_dwordx4 v6, s[12:15], s70 offen lds
    s_cselect_b32 s69, s83, s69
    s_add_u32 s70, s70, 221184
    s_cmp_ge_u32 s70, 2211840
    s_cselect_b32 s70, s71, s70
    s_mov_b32 m0, s69
    s_nop 0
    s_add_u32 s69, s69, 20480
    buffer_load_dwordx4 v2, s[12:15], s70 offen lds
    buffer_load_dwordx4 v3, s[12:15], s70 offen offset:1024 lds
    buffer_load_dwordx4 v4, s[12:15], s70 offen offset:2048 lds
    buffer_load_dwordx4 v5, s[12:15], s70 offen offset:3072 lds
    s_add_u32 m0, m0, 4096
    s_cmp_ge_u32 s69, 163840
    buffer_load_dwordx4 v6, s[12:15], s70 offen lds
    s_cselect_b32 s69, s83, s69
    s_add_u32 s70, s70, 221184
    s_cmp_ge_u32 s70, 2211840
    s_cselect_b32 s70, s71, s70
L_xe:
    v_add_f32_dpp v24, v24, v24 quad_perm:[1,0,3,2] row_mask:0xf bank_mask:0xf
    v_add_f32_dpp v25, v25, v25 quad_perm:[1,0,3,2] row_mask:0xf bank_mask:0xf
    s_nop 0
    v_add_f32_dpp v24, v24, v24 quad_perm:[2,3,0,1] row_mask:0xf bank_mask:0xf
    v_add_f32_dpp v25, v25, v25 quad_perm:[2,3,0,1] row_mask:0xf bank_mask:0xf
    s_nop 0
    v_add_f32_dpp v24, v24, v24 row_half_mirror row_mask:0xf bank_mask:0xf
    v_add_f32_dpp v25, v25, v25 row_half_mirror row_mask:0xf bank_mask:0xf
    v_mul_f32 v24, 0x3acccccd, v24
    v_mul_f32 v25, 0x3acccccd, v25
    v_fma_f32 v25, -v24, v24, v25
    v_max_f32 v25, 0, v25
    v_cvt_pk_bf16_f32 v30, v24, v25
    v_lshlrev_b32 v26, 16, v30
    v_xor_b32 v26, 0x80000000, v26
    v_mov_b32 v27, v26
    v_and_b32 v25, 0xffff0000, v30
    v_add_f32 v25, 0x3727c5ac, v25
    v_cvt_pk_bf16_f32 v30, v25, v25
    v_lshlrev_b32 v25, 16, v30
    v_sqrt_f32 v25, v25
    s_nop 0
    v_cvt_pk_bf16_f32 v30, v25, v25
    v_lshlrev_b32 v25, 16, v30
    v_rcp_f32 v28, v25
    s_nop 0
    v_mov_b32 v29, v28
    v_cvt_pk_bf16_f32 v28, v28, v28
    s_lshl_b32 s79, s73, 13
    v_and_b32 v29, 0xffff0000, v28
    v_and_b32 v28, 0xffff, v28
    v_mul_f32 v26, v26, v29
    v_dot2_f32_bf16 v80, v40, v28, v26
    v_dot2_f32_bf16 v82, v41, v28, v26
    v_dot2_f32_bf16 v84, v42, v28, v26
    v_dot2_f32_bf16 v86, v43, v28, v26
    v_dot2_f32_bf16 v81, v40, v29, v26
    v_dot2_f32_bf16 v83, v41, v29, v26
    v_dot2_f32_bf16 v85, v42, v29, v26
    v_dot2_f32_bf16 v87, v43, v29, v26
    v_cvt_pk_bf16_f32 v40, v80, v81
    v_cvt_pk_bf16_f32 v41, v82, v83
    v_cvt_pk_bf16_f32 v42, v84, v85
    v_cvt_pk_bf16_f32 v43, v86, v87
    v_add_u32 v22, s79, v19
    ds_write_b128 v22, v[40:43]
    s_add_u32 s79, s79, 8192
    s_cmp_ge_u32 s79, 81920
    s_cselect_b32 s79, 0, s79
    v_dot2_f32_bf16 v80, v44, v28, v26
    v_dot2_f32_bf16 v82, v45, v28, v26
    v_dot2_f32_bf16 v84, v46, v28, v26
    v_dot2_f32_bf16 v86, v47, v28, v26
    v_dot2_f32_bf16 v81, v44, v29, v26
    v_dot2_f32_bf16 v83, v45, v29, v26
    v_dot2_f32_bf16 v85, v46, v29, v26
    v_dot2_f32_bf16 v87, v47, v29, v26
    v_cvt_pk_bf16_f32 v44, v80, v81
    v_cvt_pk_bf16_f32 v45, v82, v83
    v_cvt_pk_bf16_f32 v46, v84, v85
    v_cvt_pk_bf16_f32 v47, v86, v87
    v_add_u32 v22, s79, v19
    ds_write_b128 v22, v[44:47]
    s_add_u32 s79, s79, 8192
    s_cmp_ge_u32 s79, 81920
    s_cselect_b32 s79, 0, s79
    v_dot2_f32_bf16 v80, v48, v28, v26
    v_dot2_f32_bf16 v82, v49, v28, v26
    v_dot2_f32_bf16 v84, v50, v28, v26
    v_dot2_f32_bf16 v86, v51, v28, v26
    v_dot2_f32_bf16 v81, v48, v29, v26
    v_dot2_f32_bf16 v83, v49, v29, v26
    v_dot2_f32_bf16 v85, v50, v29, v26
    v_dot2_f32_bf16 v87, v51, v29, v26
    v_cvt_pk_bf16_f32 v48, v80, v81
    v_cvt_pk_bf16_f32 v49, v82, v83
    v_cvt_pk_bf16_f32 v50, v84, v85
    v_cvt_pk_bf16_f32 v51, v86, v87
    v_add_u32 v22, s79, v19
    ds_write_b128 v22, v[48:51]
    s_add_u32 s79, s79, 8192
    s_cmp_ge_u32 s79, 81920
    s_cselect_b32 s79, 0, s79
    v_dot2_f32_bf16 v80, v52, v28, v26
    v_dot2_f32_bf16 v82, v53, v28, v26
    v_dot2_f32_bf16 v84, v54, v28, v26
    v_dot2_f32_bf16 v86, v55, v28, v26
    v_dot2_f32_bf16 v81, v52, v29, v26
    v_dot2_f32_bf16 v83, v53, v29, v26
    v_dot2_f32_bf16 v85, v54, v29, v26
    v_dot2_f32_bf16 v87, v55, v29, v26
    v_cvt_pk_bf16_f32 v52, v80, v81
    v_cvt_pk_bf16_f32 v53, v82, v83
    v_cvt_pk_bf16_f32 v54, v84, v85
    v_cvt_pk_bf16_f32 v55, v86, v87
    v_add_u32 v22, s79, v19
    ds_write_b128 v22, v[52:55]
    s_add_u32 s79, s79, 8192
    s_cmp_ge_u32 s79, 81920
    s_cselect_b32 s79, 0, s79
    v_dot2_f32_bf16 v80, v56, v28, v26
    v_dot2_f32_bf16 v82, v57, v28, v26
    v_dot2_f32_bf16 v84, v58, v28, v26
    v_dot2_f32_bf16 v86, v59, v28, v26
    v_dot2_f32_bf16 v81, v56, v29, v26
    v_dot2_f32_bf16 v83, v57, v29, v26
    v_dot2_f32_bf16 v85, v58, v29, v26
    v_dot2_f32_bf16 v87, v59, v29, v26
    v_cvt_pk_bf16_f32 v56, v80, v81
    v_cvt_pk_bf16_f32 v57, v82, v83
    v_cvt_pk_bf16_f32 v58, v84, v85
    v_cvt_pk_bf16_f32 v59, v86, v87
    v_add_u32 v22, s79, v19
    ds_write_b128 v22, v[56:59]
    s_add_u32 s79, s79, 8192
    s_cmp_ge_u32 s79, 81920
    s_cselect_b32 s79, 0, s79
    v_dot2_f32_bf16 v80, v60, v28, v26
    v_dot2_f32_bf16 v82, v61, v28, v26
    v_dot2_f32_bf16 v84, v62, v28, v26
    v_dot2_f32_bf16 v86, v63, v28, v26
    v_dot2_f32_bf16 v81, v60, v29, v26
    v_dot2_f32_bf16 v83, v61, v29, v26
    v_dot2_f32_bf16 v85, v62, v29, v26
    v_dot2_f32_bf16 v87, v63, v29, v26
    v_cvt_pk_bf16_f32 v60, v80, v81
    v_cvt_pk_bf16_f32 v61, v82, v83
    v_cvt_pk_bf16_f32 v62, v84, v85
    v_cvt_pk_bf16_f32 v63, v86, v87
    v_add_u32 v22, s79, v19
    ds_write_b128 v22, v[60:63]
    s_add_u32 s79, s79, 8192
    s_cmp_ge_u32 s79, 81920
    s_cselect_b32 s79, 0, s79
    v_dot2_f32_bf16 v80, v64, v28, v26
    v_dot2_f32_bf16 v82, v65, v28, v26
    v_dot2_f32_bf16 v84, v66, v28, v26
    v_dot2_f32_bf16 v86, v67, v28, v26
    v_dot2_f32_bf16 v81, v64, v29, v26
    v_dot2_f32_bf16 v83, v65, v29, v26
    v_dot2_f32_bf16 v85, v66, v29, v26
    v_dot2_f32_bf16 v87, v67, v29, v26
    v_cvt_pk_bf16_f32 v64, v80, v81
    v_cvt_pk_bf16_f32 v65, v82, v83
    v_cvt_pk_bf16_f32 v66, v84, v85
    v_cvt_pk_bf16_f32 v67, v86, v87
    v_add_u32 v22, s79, v19
    ds_write_b128 v22, v[64:67]
    s_add_u32 s79, s79, 8192
    s_cmp_ge_u32 s79, 81920
    s_cselect_b32 s79, 0, s79
    v_dot2_f32_bf16 v80, v68, v28, v26
    v_dot2_f32_bf16 v82, v69, v28, v26
    v_dot2_f32_bf16 v84, v70, v28, v26
    v_dot2_f32_bf16 v86, v71, v28, v26
    v_dot2_f32_bf16 v81, v68, v29, v26
    v_dot2_f32_bf16 v83, v69, v29, v26
    v_dot2_f32_bf16 v85, v70, v29, v26
    v_dot2_f32_bf16 v87, v71, v29, v26
    v_cvt_pk_bf16_f32 v68, v80, v81
    v_cvt_pk_bf16_f32 v69, v82, v83
    v_cvt_pk_bf16_f32 v70, v84, v85
    v_cvt_pk_bf16_f32 v71, v86, v87
    v_add_u32 v22, s79, v19
    ds_write_b128 v22, v[68:71]
    s_add_u32 s79, s79, 8192
    s_cmp_ge_u32 s79, 81920
    s_cselect_b32 s79, 0, s79
    v_dot2_f32_bf16 v80, v72, v28, v26
    v_dot2_f32_bf16 v82, v73, v28, v26
    v_dot2_f32_bf16 v84, v74, v28, v26
    v_dot2_f32_bf16 v86, v75, v28, v26
    v_dot2_f32_bf16 v81, v72, v29, v26
    v_dot2_f32_bf16 v83, v73, v29, v26
    v_dot2_f32_bf16 v85, v74, v29, v26
    v_dot2_f32_bf16 v87, v75, v29, v26
    v_cvt_pk_bf16_f32 v72, v80, v81
    v_cvt_pk_bf16_f32 v73, v82, v83
    v_cvt_pk_bf16_f32 v74, v84, v85
    v_cvt_pk_bf16_f32 v75, v86, v87
    v_add_u32 v22, s79, v19
    ds_write_b128 v22, v[72:75]
    s_add_u32 s79, s79, 8192
    s_cmp_ge_u32 s79, 81920
    s_cselect_b32 s79, 0, s79
    v_dot2_f32_bf16 v80, v76, v28, v26
    v_dot2_f32_bf16 v82, v77, v28, v26
    v_dot2_f32_bf16 v84, v78, v28, v26
    v_dot2_f32_bf16 v86, v79, v28, v26
    v_dot2_f32_bf16 v81, v76, v29, v26
    v_dot2_f32_bf16 v83, v77, v29, v26
    v_dot2_f32_bf16 v85, v78, v29, v26
    v_dot2_f32_bf16 v87, v79, v29, v26
    v_cvt_pk_bf16_f32 v76, v80, v81
    v_cvt_pk_bf16_f32 v77, v82, v83
    v_cvt_pk_bf16_f32 v78, v84, v85
    v_cvt_pk_bf16_f32 v79, v86, v87
    v_add_u32 v22, s79, v19
    ds_write_b128 v22, v[76:79]
    s_add_u32 s79, s79, 8192
    s_cmp_ge_u32 s79, 81920
    s_cselect_b32 s79, 0, s79
    s_waitcnt lgkmcnt(0)
    s_mul_i32 s6, s6, 0x9E3779B1
    s_add_u32 s6, s6, 0x7F4A7C15
    s_cmp_ge_u32 s3, 4
    s_cbranch_scc1 L_Y
    s_mov_b32 s73, 81920
    s_waitcnt vmcnt(5)
    s_cmp_eq_u32 s68, 0
    s_cbranch_scc1 Lnh5_1
    v_add_u32 v39, s73, v38
    v_add_u32 v12, s72, v8
    v_add_u32 v13, s72, v9
    v_add_u32 v14, s73, v10
    v_add_u32 v15, s73, v11
    s_add_u32 s72, s72, 8192
    s_cmp_ge_u32 s72, 81920
    s_cselect_b32 s72, 0, s72
    s_add_u32 s73, s73, 20480
    s_cmp_ge_u32 s73, 163840
    s_cselect_b32 s73, 81920, s73
    s_barrier
    s_nop 0
    ds_read_b128 v[40:43], v12 offset:0
    ds_read_b128 v[44:47], v12 offset:2048
    ds_read_b64_tr_b16 v[48:49], v14 offset:0
    ds_read_b64_tr_b16 v[50:51], v14 offset:1280
    ds_read_b64_tr_b16 v[52:53], v39 offset:0
    ds_read_b64_tr_b16 v[54:55], v39 offset:1280
    ds_read_b64_tr_b16 v[56:57], v14 offset:64
    ds_read_b64_tr_b16 v[58:59], v14 offset:1344
    ds_read_b64_tr_b16 v[60:61], v39 offset:64
    ds_read_b64_tr_b16 v[62:63], v39 offset:1344
    ds_read_b128 v[68:71], v13 offset:0
    ds_read_b128 v[72:75], v13 offset:2048
    ds_read_b64_tr_b16 v[76:77], v14 offset:10240
    ds_read_b64_tr_b16 v[78:79], v14 offset:11520
    ds_read_b64_tr_b16 v[80:81], v39 offset:10240
    ds_read_b64_tr_b16 v[82:83], v39 offset:11520
    ds_read_b64_tr_b16 v[84:85], v14 offset:10304
    ds_read_b64_tr_b16 v[86:87], v14 offset:11584
    ds_read_b64_tr_b16 v[88:89], v39 offset:10304
    ds_read_b64_tr_b16 v[90:91], v39 offset:11584
    v_add_u32 v39, s73, v38
    v_add_u32 v12, s72, v8
    v_add_u32 v13, s72, v9
    v_add_u32 v14, s73, v10
    v_add_u32 v15, s73, v11
    s_add_u32 s72, s72, 8192
    s_cmp_ge_u32 s72, 81920
    s_cselect_b32 s72, 0, s72
    s_add_u32 s73, s73, 20480
    s_cmp_ge_u32 s73, 163840
    s_cselect_b32 s73, 81920, s73
    ds_read_b64_tr_b16 v[192:193], v208 offset:0
    ds_read_b64_tr_b16 v[194:195], v209 offset:0
    ds_read_b64_tr_b16 v[196:197], v208 offset:4096
    ds_read_b64_tr_b16 v[198:199], v209 offset:4096
    ds_read_b64_tr_b16 v[200:201], v210 offset:0
    ds_read_b64_tr_b16 v[202:203], v211 offset:0
    ds_read_b64_tr_b16 v[204:205], v210 offset:4096
    ds_read_b64_tr_b16 v[206:207], v211 offset:4096
    s_waitcnt vmcnt(0)
    s_waitcnt lgkmcnt(0)
    s_barrier
    s_nop 0
    v_mfma_f32_16x16x32_bf16 v[152:155], v[40:43], v[48:51], 0
    ds_read_b128 v[96:99], v12 offset:0
    ds_read_b128 v[100:103], v12 offset:2048
    v_mfma_f32_16x16x32_bf16 v[156:159], v[44:47], v[48:51], 0
    ds_read_b64_tr_b16 v[104:105], v14 offset:0
    ds_read_b64_tr_b16 v[106:107], v14 offset:1280
    v_mfma_f32_16x16x32_bf16 v[160:163], v[40:43], v[52:55], 0
    ds_read_b64_tr_b16 v[108:109], v39 offset:0
    ds_read_b64_tr_b16 v[110:111], v39 offset:1280
    v_mfma_f32_16x16x32_bf16 v[164:167], v[44:47], v[52:55], 0
    ds_read_b64_tr_b16 v[112:113], v14 offset:64
    ds_read_b64_tr_b16 v[114:115], v14 offset:1344
    v_mfma_f32_16x16x32_bf16 v[168:171], v[40:43], v[56:59], 0
    ds_read_b64_tr_b16 v[116:117], v39 offset:64
    ds_read_b64_tr_b16 v[118:119], v39 offset:1344
    v_mfma_f32_16x16x32_bf16 v[172:175], v[44:47], v[56:59], 0
    ds_read_b128 v[124:127], v13 offset:0
    ds_read_b128 v[128:131], v13 offset:2048
    v_mfma_f32_16x16x32_bf16 v[176:179], v[40:43], v[60:63], 0
    ds_read_b64_tr_b16 v[132:133], v14 offset:10240
    ds_read_b64_tr_b16 v[134:135], v14 offset:11520
    v_mfma_f32_16x16x32_bf16 v[180:183], v[44:47], v[60:63], 0
    ds_read_b64_tr_b16 v[136:137], v39 offset:10240
    ds_read_b64_tr_b16 v[138:139], v39 offset:11520
    v_mfma_f32_16x16x32_bf16 v[152:155], v[68:71], v[76:79], v[152:155]
    ds_read_b64_tr_b16 v[140:141], v14 offset:10304
    ds_read_b64_tr_b16 v[142:143], v14 offset:11584
    v_mfma_f32_16x16x32_bf16 v[156:159], v[72:75], v[76:79], v[156:159]
    ds_read_b64_tr_b16 v[144:145], v39 offset:10304
    ds_read_b64_tr_b16 v[146:147], v39 offset:11584
    v_mfma_f32_16x16x32_bf16 v[160:163], v[68:71], v[80:83], v[160:163]
    v_add_u32 v39, s73, v38
    v_add_u32 v12, s72, v8
    v_add_u32 v13, s72, v9
    v_mfma_f32_16x16x32_bf16 v[164:167], v[72:75], v[80:83], v[164:167]
    v_add_u32 v14, s73, v10
    v_add_u32 v15, s73, v11
    s_add_u32 s72, s72, 8192
    v_mfma_f32_16x16x32_bf16 v[168:171], v[68:71], v[84:87], v[168:171]
    s_cmp_ge_u32 s72, 81920
    s_cselect_b32 s72, 0, s72
    s_add_u32 s73, s73, 20480
    v_mfma_f32_16x16x32_bf16 v[172:175], v[72:75], v[84:87], v[172:175]
    s_cmp_ge_u32 s73, 163840
    s_cselect_b32 s73, 81920, s73
    s_mov_b32 s74, 4
    v_mfma_f32_16x16x32_bf16 v[176:179], v[68:71], v[88:91], v[176:179]
    v_mov_b32 v244, v192
    v_mov_b32_dpp v192, v196 row_ror:8 row_mask:0xf bank_mask:0xc
    s_nop 0
    v_mov_b32_dpp v196, v244 row_ror:8 row_mask:0xf bank_mask:0x3
    v_mfma_f32_16x16x32_bf16 v[180:183], v[72:75], v[88:91], v[180:183]
    v_mov_b32 v245, v193
    v_mov_b32_dpp v193, v197 row_ror:8 row_mask:0xf bank_mask:0xc
    s_nop 0
    v_mov_b32_dpp v197, v245 row_ror:8 row_mask:0xf bank_mask:0x3
    v_mov_b32 v244, v194
    v_mov_b32_dpp v194, v198 row_ror:8 row_mask:0xf bank_mask:0xc
    s_nop 0
    v_mov_b32_dpp v198, v244 row_ror:8 row_mask:0xf bank_mask:0x3
    v_mov_b32 v245, v195
    v_mov_b32_dpp v195, v199 row_ror:8 row_mask:0xf bank_mask:0xc
    s_nop 0
    v_mov_b32_dpp v199, v245 row_ror:8 row_mask:0xf bank_mask:0x3
    buffer_store_dwordx4 v[192:195], v248, s[28:31], s38 offen sc1
    s_add_u32 s38, s38, 32768
    buffer_store_dwordx4 v[196:199], v248, s[28:31], s38 offen sc1
    s_add_u32 s38, s38, 32768
    v_mov_b32 v244, v200
    v_mov_b32_dpp v200, v204 row_ror:8 row_mask:0xf bank_mask:0xc
    s_nop 0
    v_mov_b32_dpp v204, v244 row_ror:8 row_mask:0xf bank_mask:0x3
    v_mov_b32 v245, v201
    v_mov_b32_dpp v201, v205 row_ror:8 row_mask:0xf bank_mask:0xc
    s_nop 0
    v_mov_b32_dpp v205, v245 row_ror:8 row_mask:0xf bank_mask:0x3
    v_mov_b32 v244, v202
    v_mov_b32_dpp v202, v206 row_ror:8 row_mask:0xf bank_mask:0xc
    s_nop 0
    v_mov_b32_dpp v206, v244 row_ror:8 row_mask:0xf bank_mask:0x3
    v_mov_b32 v245, v203
    v_mov_b32_dpp v203, v207 row_ror:8 row_mask:0xf bank_mask:0xc
    s_nop 0
    v_mov_b32_dpp v207, v245 row_ror:8 row_mask:0xf bank_mask:0x3
    buffer_store_dwordx4 v[200:203], v248, s[28:31], s38 offen sc1
    s_add_u32 s38, s38, 32768
    buffer_store_dwordx4 v[204:207], v248, s[28:31], s38 offen sc1
    s_add_u32 s38, s38, 32768
    s_waitcnt lgkmcnt(0)
Lcp1a_3:
    s_cmp_lg_u32 s74, 3
    s_cbranch_scc1 Lfw_4
    s_waitcnt vmcnt(0)
Lfw_4:
    s_barrier
    v_mfma_f32_16x16x32_bf16 v[152:155], v[96:99], v[104:107], v[152:155]
    ds_read_b128 v[40:43], v12 offset:0
    ds_read_b128 v[44:47], v12 offset:2048
    v_mfma_f32_16x16x32_bf16 v[156:159], v[100:103], v[104:107], v[156:159]
    ds_read_b64_tr_b16 v[48:49], v14 offset:0
    ds_read_b64_tr_b16 v[50:51], v14 offset:1280
    v_mfma_f32_16x16x32_bf16 v[160:163], v[96:99], v[108:111], v[160:163]
    ds_read_b64_tr_b16 v[52:53], v39 offset:0
    ds_read_b64_tr_b16 v[54:55], v39 offset:1280
    v_mfma_f32_16x16x32_bf16 v[164:167], v[100:103], v[108:111], v[164:167]
    ds_read_b64_tr_b16 v[56:57], v14 offset:64
    ds_read_b64_tr_b16 v[58:59], v14 offset:1344
    v_mfma_f32_16x16x32_bf16 v[168:171], v[96:99], v[112:115], v[168:171]
    ds_read_b64_tr_b16 v[60:61], v39 offset:64
    ds_read_b64_tr_b16 v[62:63], v39 offset:1344
    v_mfma_f32_16x16x32_bf16 v[172:175], v[100:103], v[112:115], v[172:175]
    ds_read_b128 v[68:71], v13 offset:0
    ds_read_b128 v[72:75], v13 offset:2048
    v_mfma_f32_16x16x32_bf16 v[176:179], v[96:99], v[116:119], v[176:179]
    ds_read_b64_tr_b16 v[76:77], v14 offset:10240
    ds_read_b64_tr_b16 v[78:79], v14 offset:11520
    v_mfma_f32_16x16x32_bf16 v[180:183], v[100:103], v[116:119], v[180:183]
    ds_read_b64_tr_b16 v[80:81], v39 offset:10240
    ds_read_b64_tr_b16 v[82:83], v39 offset:11520
    v_mfma_f32_16x16x32_bf16 v[152:155], v[124:127], v[132:135], v[152:155]
    ds_read_b64_tr_b16 v[84:85], v14 offset:10304
    ds_read_b64_tr_b16 v[86:87], v14 offset:11584
    v_mfma_f32_16x16x32_bf16 v[156:159], v[128:131], v[132:135], v[156:159]
    ds_read_b64_tr_b16 v[88:89], v39 offset:10304
    ds_read_b64_tr_b16 v[90:91], v39 offset:11584
    v_mfma_f32_16x16x32_bf16 v[160:163], v[124:127], v[136:139], v[160:163]
    v_add_u32 v39, s73, v38
    v_add_u32 v12, s72, v8
    v_mfma_f32_16x16x32_bf16 v[164:167], v[128:131], v[136:139], v[164:167]
    v_add_u32 v13, s72, v9
    v_add_u32 v14, s73, v10
    v_mfma_f32_16x16x32_bf16 v[168:171], v[124:127], v[140:143], v[168:171]
    v_add_u32 v15, s73, v11
    s_add_u32 s72, s72, 8192
    v_mfma_f32_16x16x32_bf16 v[172:175], v[128:131], v[140:143], v[172:175]
    s_cmp_ge_u32 s72, 81920
    s_cselect_b32 s72, 0, s72
    v_mfma_f32_16x16x32_bf16 v[176:179], v[124:127], v[144:147], v[176:179]
    s_add_u32 s73, s73, 20480
    s_cmp_ge_u32 s73, 163840
    v_mfma_f32_16x16x32_bf16 v[180:183], v[128:131], v[144:147], v[180:183]
    s_cselect_b32 s73, 81920, s73
    s_cmp_lg_u32 s74, 3
    s_cbranch_scc1 Lfx_5
    s_cmp_lg_u32 s66, 0
    s_cbranch_scc1 Lfx_5
    v_mov_b32 v16, s6
    v_lshlrev_b32 v17, 2, v1
    s_mov_b32 exec_hi, 0
    buffer_store_dword v16, v17, s[28:31], s39 offen sc1
    s_mov_b64 exec, -1
Lfx_5:
    s_waitcnt lgkmcnt(0)
    s_barrier
    v_mfma_f32_16x16x32_bf16 v[152:155], v[40:43], v[48:51], v[152:155]
    ds_read_b128 v[96:99], v12 offset:0
    ds_read_b128 v[100:103], v12 offset:2048
    v_mfma_f32_16x16x32_bf16 v[156:159], v[44:47], v[48:51], v[156:159]
    ds_read_b64_tr_b16 v[104:105], v14 offset:0
    ds_read_b64_tr_b16 v[106:107], v14 offset:1280
    v_mfma_f32_16x16x32_bf16 v[160:163], v[40:43], v[52:55], v[160:163]
    ds_read_b64_tr_b16 v[108:109], v39 offset:0
    ds_read_b64_tr_b16 v[110:111], v39 offset:1280
    v_mfma_f32_16x16x32_bf16 v[164:167], v[44:47], v[52:55], v[164:167]
    ds_read_b64_tr_b16 v[112:113], v14 offset:64
    ds_read_b64_tr_b16 v[114:115], v14 offset:1344
    v_mfma_f32_16x16x32_bf16 v[168:171], v[40:43], v[56:59], v[168:171]
    ds_read_b64_tr_b16 v[116:117], v39 offset:64
    ds_read_b64_tr_b16 v[118:119], v39 offset:1344
    v_mfma_f32_16x16x32_bf16 v[172:175], v[44:47], v[56:59], v[172:175]
    ds_read_b128 v[124:127], v13 offset:0
    ds_read_b128 v[128:131], v13 offset:2048
    v_mfma_f32_16x16x32_bf16 v[176:179], v[40:43], v[60:63], v[176:179]
    ds_read_b64_tr_b16 v[132:133], v14 offset:10240
    ds_read_b64_tr_b16 v[134:135], v14 offset:11520
    v_mfma_f32_16x16x32_bf16 v[180:183], v[44:47], v[60:63], v[180:183]
    ds_read_b64_tr_b16 v[136:137], v39 offset:10240
    ds_read_b64_tr_b16 v[138:139], v39 offset:11520
    v_mfma_f32_16x16x32_bf16 v[152:155], v[68:71], v[76:79], v[152:155]
    ds_read_b64_tr_b16 v[140:141], v14 offset:10304
    ds_read_b64_tr_b16 v[142:143], v14 offset:11584
    v_mfma_f32_16x16x32_bf16 v[156:159], v[72:75], v[76:79], v[156:159]
    ds_read_b64_tr_b16 v[144:145], v39 offset:10304
    ds_read_b64_tr_b16 v[146:147], v39 offset:11584
    v_mfma_f32_16x16x32_bf16 v[160:163], v[68:71], v[80:83], v[160:163]
    v_add_u32 v39, s73, v38
    v_add_u32 v12, s72, v8
    v_mfma_f32_16x16x32_bf16 v[164:167], v[72:75], v[80:83], v[164:167]
    v_add_u32 v13, s72, v9
    v_add_u32 v14, s73, v10
    v_mfma_f32_16x16x32_bf16 v[168:171], v[68:71], v[84:87], v[168:171]
    v_add_u32 v15, s73, v11
    s_add_u32 s72, s72, 8192
    v_mfma_f32_16x16x32_bf16 v[172:175], v[72:75], v[84:87], v[172:175]
    s_cmp_ge_u32 s72, 81920
    s_cselect_b32 s72, 0, s72
    v_mfma_f32_16x16x32_bf16 v[176:179], v[68:71], v[88:91], v[176:179]
    s_add_u32 s73, s73, 20480
    s_cmp_ge_u32 s73, 163840
    v_mfma_f32_16x16x32_bf16 v[180:183], v[72:75], v[88:91], v[180:183]
    s_cselect_b32 s73, 81920, s73
    s_sub_u32 s74, s74, 1
    s_cmp_lg_u32 s74, 0
    s_waitcnt lgkmcnt(0)
    s_cbranch_scc1 Lcp1a_3
    s_branch Lnhj_2
Lnh5_1:
    v_add_u32 v39, s73, v38
    v_add_u32 v12, s72, v8
    v_add_u32 v13, s72, v9
    v_add_u32 v14, s73, v10
    v_add_u32 v15, s73, v11
    s_add_u32 s72, s72, 8192
    s_cmp_ge_u32 s72, 81920
    s_cselect_b32 s72, 0, s72
    s_add_u32 s73, s73, 20480
    s_cmp_ge_u32 s73, 163840
    s_cselect_b32 s73, 81920, s73
    s_barrier
    ds_read_b128 v[40:43], v12 offset:0
    ds_read_b128 v[44:47], v12 offset:2048
    ds_read_b64_tr_b16 v[48:49], v14 offset:0
    ds_read_b64_tr_b16 v[50:51], v14 offset:1280
    ds_read_b64_tr_b16 v[52:53], v39 offset:0
    ds_read_b64_tr_b16 v[54:55], v39 offset:1280
    ds_read_b64_tr_b16 v[56:57], v14 offset:64
    ds_read_b64_tr_b16 v[58:59], v14 offset:1344
    ds_read_b64_tr_b16 v[60:61], v39 offset:64
    ds_read_b64_tr_b16 v[62:63], v39 offset:1344
    ds_read_b64_tr_b16 v[64:65], v15 offset:0
    ds_read_b64_tr_b16 v[66:67], v15 offset:1280
    ds_read_b128 v[68:71], v13 offset:0
    ds_read_b128 v[72:75], v13 offset:2048
    ds_read_b64_tr_b16 v[76:77], v14 offset:10240
    ds_read_b64_tr_b16 v[78:79], v14 offset:11520
    ds_read_b64_tr_b16 v[80:81], v39 offset:10240
    ds_read_b64_tr_b16 v[82:83], v39 offset:11520
    ds_read_b64_tr_b16 v[84:85], v14 offset:10304
    ds_read_b64_tr_b16 v[86:87], v14 offset:11584
    ds_read_b64_tr_b16 v[88:89], v39 offset:10304
    ds_read_b64_tr_b16 v[90:91], v39 offset:11584
    ds_read_b64_tr_b16 v[92:93], v15 offset:10240
    ds_read_b64_tr_b16 v[94:95], v15 offset:11520
    v_add_u32 v39, s73, v38
    v_add_u32 v12, s72, v8
    v_add_u32 v13, s72, v9
    v_add_u32 v14, s73, v10
    v_add_u32 v15, s73, v11
    s_add_u32 s72, s72, 8192
    s_cmp_ge_u32 s72, 81920
    s_cselect_b32 s72, 0, s72
    s_add_u32 s73, s73, 20480
    s_cmp_ge_u32 s73, 163840
    s_cselect_b32 s73, 81920, s73
    ds_read_b64_tr_b16 v[192:193], v208 offset:0
    ds_read_b64_tr_b16 v[194:195], v209 offset:0
    ds_read_b64_tr_b16 v[196:197], v208 offset:4096
    ds_read_b64_tr_b16 v[198:199], v209 offset:4096
    ds_read_b64_tr_b16 v[200:201], v210 offset:0
    ds_read_b64_tr_b16 v[202:203], v211 offset:0
    ds_read_b64_tr_b16 v[204:205], v210 offset:4096
    ds_read_b64_tr_b16 v[206:207], v211 offset:4096
    s_waitcnt vmcnt(0)
    s_waitcnt lgkmcnt(0)
    s_barrier
    s_nop 0
    v_mfma_f32_16x16x32_bf16 v[152:155], v[40:43], v[48:51], 0
    ds_read_b128 v[96:99], v12 offset:0
    ds_read_b128 v[100:103], v12 offset:2048
    v_mfma_f32_16x16x32_bf16 v[156:159], v[44:47], v[48:51], 0
    ds_read_b64_tr_b16 v[104:105], v14 offset:0
    ds_read_b64_tr_b16 v[106:107], v14 offset:1280
    v_mfma_f32_16x16x32_bf16 v[160:163], v[40:43], v[52:55], 0
    ds_read_b64_tr_b16 v[108:109], v39 offset:0
    ds_read_b64_tr_b16 v[110:111], v39 offset:1280
    v_mfma_f32_16x16x32_bf16 v[164:167], v[44:47], v[52:55], 0
    ds_read_b64_tr_b16 v[112:113], v14 offset:64
    ds_read_b64_tr_b16 v[114:115], v14 offset:1344
    v_mfma_f32_16x16x32_bf16 v[168:171], v[40:43], v[56:59], 0
    ds_read_b64_tr_b16 v[116:117], v39 offset:64
    ds_read_b64_tr_b16 v[118:119], v39 offset:1344
    v_mfma_f32_16x16x32_bf16 v[172:175], v[44:47], v[56:59], 0
    ds_read_b64_tr_b16 v[120:121], v15 offset:0
    ds_read_b64_tr_b16 v[122:123], v15 offset:1280
    v_mfma_f32_16x16x32_bf16 v[176:179], v[40:43], v[60:63], 0
    ds_read_b128 v[124:127], v13 offset:0
    ds_read_b128 v[128:131], v13 offset:2048
    v_mfma_f32_16x16x32_bf16 v[180:183], v[44:47], v[60:63], 0
    ds_read_b64_tr_b16 v[132:133], v14 offset:10240
    ds_read_b64_tr_b16 v[134:135], v14 offset:11520
    v_mfma_f32_16x16x32_bf16 v[184:187], v[40:43], v[64:67], 0
    ds_read_b64_tr_b16 v[136:137], v39 offset:10240
    ds_read_b64_tr_b16 v[138:139], v39 offset:11520
    v_mfma_f32_16x16x32_bf16 v[188:191], v[44:47], v[64:67], 0
    ds_read_b64_tr_b16 v[140:141], v14 offset:10304
    ds_read_b64_tr_b16 v[142:143], v14 offset:11584
    v_mfma_f32_16x16x32_bf16 v[152:155], v[68:71], v[76:79], v[152:155]
    ds_read_b64_tr_b16 v[144:145], v39 offset:10304
    ds_read_b64_tr_b16 v[146:147], v39 offset:11584
    v_mfma_f32_16x16x32_bf16 v[156:159], v[72:75], v[76:79], v[156:159]
    ds_read_b64_tr_b16 v[148:149], v15 offset:10240
    ds_read_b64_tr_b16 v[150:151], v15 offset:11520
    v_mfma_f32_16x16x32_bf16 v[160:163], v[68:71], v[80:83], v[160:163]
    v_add_u32 v39, s73, v38
    v_add_u32 v12, s72, v8
    v_add_u32 v13, s72, v9
    v_mfma_f32_16x16x32_bf16 v[164:167], v[72:75], v[80:83], v[164:167]
    v_add_u32 v14, s73, v10
    v_add_u32 v15, s73, v11
    s_add_u32 s72, s72, 8192
    v_mfma_f32_16x16x32_bf16 v[168:171], v[68:71], v[84:87], v[168:171]
    s_cmp_ge_u32 s72, 81920
    s_cselect_b32 s72, 0, s72
    s_add_u32 s73, s73, 20480
    v_mfma_f32_16x16x32_bf16 v[172:175], v[72:75], v[84:87], v[172:175]
    s_cmp_ge_u32 s73, 163840
    s_cselect_b32 s73, 81920, s73
    s_mov_b32 s74, 4
    v_mfma_f32_16x16x32_bf16 v[176:179], v[68:71], v[88:91], v[176:179]
    v_mov_b32 v244, v192
    v_mov_b32_dpp v192, v196 row_ror:8 row_mask:0xf bank_mask:0xc
    s_nop 0
    v_mov_b32_dpp v196, v244 row_ror:8 row_mask:0xf bank_mask:0x3
    v_mfma_f32_16x16x32_bf16 v[180:183], v[72:75], v[88:91], v[180:183]
    v_mov_b32 v245, v193
    v_mov_b32_dpp v193, v197 row_ror:8 row_mask:0xf bank_mask:0xc
    s_nop 0
    v_mov_b32_dpp v197, v245 row_ror:8 row_mask:0xf bank_mask:0x3
    v_mfma_f32_16x16x32_bf16 v[184:187], v[68:71], v[92:95], v[184:187]
    v_mov_b32 v244, v194
    v_mov_b32_dpp v194, v198 row_ror:8 row_mask:0xf bank_mask:0xc
    s_nop 0
    v_mov_b32_dpp v198, v244 row_ror:8 row_mask:0xf bank_mask:0x3
    v_mfma_f32_16x16x32_bf16 v[188:191], v[72:75], v[92:95], v[188:191]
    v_mov_b32 v245, v195
    v_mov_b32_dpp v195, v199 row_ror:8 row_mask:0xf bank_mask:0xc
    s_nop 0
    v_mov_b32_dpp v199, v245 row_ror:8 row_mask:0xf bank_mask:0x3
    buffer_store_dwordx4 v[192:195], v248, s[28:31], s38 offen sc1
    s_add_u32 s38, s38, 32768
    buffer_store_dwordx4 v[196:199], v248, s[28:31], s38 offen sc1
    s_add_u32 s38, s38, 32768
    v_mov_b32 v244, v200
    v_mov_b32_dpp v200, v204 row_ror:8 row_mask:0xf bank_mask:0xc
    s_nop 0
    v_mov_b32_dpp v204, v244 row_ror:8 row_mask:0xf bank_mask:0x3
    v_mov_b32 v245, v201
    v_mov_b32_dpp v201, v205 row_ror:8 row_mask:0xf bank_mask:0xc
    s_nop 0
    v_mov_b32_dpp v205, v245 row_ror:8 row_mask:0xf bank_mask:0x3
    v_mov_b32 v244, v202
    v_mov_b32_dpp v202, v206 row_ror:8 row_mask:0xf bank_mask:0xc
    s_nop 0
    v_mov_b32_dpp v206, v244 row_ror:8 row_mask:0xf bank_mask:0x3
    v_mov_b32 v245, v203
    v_mov_b32_dpp v203, v207 row_ror:8 row_mask:0xf bank_mask:0xc
    s_nop 0
    v_mov_b32_dpp v207, v245 row_ror:8 row_mask:0xf bank_mask:0x3
    buffer_store_dwordx4 v[200:203], v248, s[28:31], s38 offen sc1
    s_add_u32 s38, s38, 32768
    buffer_store_dwordx4 v[204:207], v248, s[28:31], s38 offen sc1
    s_add_u32 s38, s38, 32768
    s_waitcnt lgkmcnt(0)
Lcp1a_6:
    s_cmp_lg_u32 s74, 3
    s_cbranch_scc1 Lfw_7
    s_waitcnt vmcnt(0)
Lfw_7:
    s_barrier
    v_mfma_f32_16x16x32_bf16 v[152:155], v[96:99], v[104:107], v[152:155]
    ds_read_b128 v[40:43], v12 offset:0
    ds_read_b128 v[44:47], v12 offset:2048
    v_mfma_f32_16x16x32_bf16 v[156:159], v[100:103], v[104:107], v[156:159]
    ds_read_b64_tr_b16 v[48:49], v14 offset:0
    ds_read_b64_tr_b16 v[50:51], v14 offset:1280
    v_mfma_f32_16x16x32_bf16 v[160:163], v[96:99], v[108:111], v[160:163]
    ds_read_b64_tr_b16 v[52:53], v39 offset:0
    ds_read_b64_tr_b16 v[54:55], v39 offset:1280
    v_mfma_f32_16x16x32_bf16 v[164:167], v[100:103], v[108:111], v[164:167]
    ds_read_b64_tr_b16 v[56:57], v14 offset:64
    ds_read_b64_tr_b16 v[58:59], v14 offset:1344
    v_mfma_f32_16x16x32_bf16 v[168:171], v[96:99], v[112:115], v[168:171]
    ds_read_b64_tr_b16 v[60:61], v39 offset:64
    ds_read_b64_tr_b16 v[62:63], v39 offset:1344
    v_mfma_f32_16x16x32_bf16 v[172:175], v[100:103], v[112:115], v[172:175]
    ds_read_b64_tr_b16 v[64:65], v15 offset:0
    ds_read_b64_tr_b16 v[66:67], v15 offset:1280
    v_mfma_f32_16x16x32_bf16 v[176:179], v[96:99], v[116:119], v[176:179]
    ds_read_b128 v[68:71], v13 offset:0
    ds_read_b128 v[72:75], v13 offset:2048
    v_mfma_f32_16x16x32_bf16 v[180:183], v[100:103], v[116:119], v[180:183]
    ds_read_b64_tr_b16 v[76:77], v14 offset:10240
    ds_read_b64_tr_b16 v[78:79], v14 offset:11520
    v_mfma_f32_16x16x32_bf16 v[184:187], v[96:99], v[120:123], v[184:187]
    ds_read_b64_tr_b16 v[80:81], v39 offset:10240
    ds_read_b64_tr_b16 v[82:83], v39 offset:11520
    v_mfma_f32_16x16x32_bf16 v[188:191], v[100:103], v[120:123], v[188:191]
    ds_read_b64_tr_b16 v[84:85], v14 offset:10304
    ds_read_b64_tr_b16 v[86:87], v14 offset:11584
    v_mfma_f32_16x16x32_bf16 v[152:155], v[124:127], v[132:135], v[152:155]
    ds_read_b64_tr_b16 v[88:89], v39 offset:10304
    ds_read_b64_tr_b16 v[90:91], v39 offset:11584
    v_mfma_f32_16x16x32_bf16 v[156:159], v[128:131], v[132:135], v[156:159]
    ds_read_b64_tr_b16 v[92:93], v15 offset:10240
    ds_read_b64_tr_b16 v[94:95], v15 offset:11520
    v_mfma_f32_16x16x32_bf16 v[160:163], v[124:127], v[136:139], v[160:163]
    v_add_u32 v39, s73, v38
    v_add_u32 v12, s72, v8
    v_mfma_f32_16x16x32_bf16 v[164:167], v[128:131], v[136:139], v[164:167]
    v_add_u32 v13, s72, v9
    v_add_u32 v14, s73, v10
    v_mfma_f32_16x16x32_bf16 v[168:171], v[124:127], v[140:143], v[168:171]
    v_add_u32 v15, s73, v11
    s_add_u32 s72, s72, 8192
    v_mfma_f32_16x16x32_bf16 v[172:175], v[128:131], v[140:143], v[172:175]
    s_cmp_ge_u32 s72, 81920
    s_cselect_b32 s72, 0, s72
    v_mfma_f32_16x16x32_bf16 v[176:179], v[124:127], v[144:147], v[176:179]
    s_add_u32 s73, s73, 20480
    s_cmp_ge_u32 s73, 163840
    v_mfma_f32_16x16x32_bf16 v[180:183], v[128:131], v[144:147], v[180:183]
    s_cselect_b32 s73, 81920, s73
    v_mfma_f32_16x16x32_bf16 v[184:187], v[124:127], v[148:151], v[184:187]
    v_mfma_f32_16x16x32_bf16 v[188:191], v[128:131], v[148:151], v[188:191]
    s_cmp_lg_u32 s74, 3
    s_cbranch_scc1 Lfx_8
    s_cmp_lg_u32 s66, 0
    s_cbranch_scc1 Lfx_8
    v_mov_b32 v16, s6
    v_lshlrev_b32 v17, 2, v1
    s_mov_b32 exec_hi, 0
    buffer_store_dword v16, v17, s[28:31], s39 offen sc1
    s_mov_b64 exec, -1
Lfx_8:
    s_waitcnt lgkmcnt(0)
    s_barrier
    v_mfma_f32_16x16x32_bf16 v[152:155], v[40:43], v[48:51], v[152:155]
    ds_read_b128 v[96:99], v12 offset:0
    ds_read_b128 v[100:103], v12 offset:2048
    v_mfma_f32_16x16x32_bf16 v[156:159], v[44:47], v[48:51], v[156:159]
    ds_read_b64_tr_b16 v[104:105], v14 offset:0
    ds_read_b64_tr_b16 v[106:107], v14 offset:1280
    v_mfma_f32_16x16x32_bf16 v[160:163], v[40:43], v[52:55], v[160:163]
    ds_read_b64_tr_b16 v[108:109], v39 offset:0
    ds_read_b64_tr_b16 v[110:111], v39 offset:1280
    v_mfma_f32_16x16x32_bf16 v[164:167], v[44:47], v[52:55], v[164:167]
    ds_read_b64_tr_b16 v[112:113], v14 offset:64
    ds_read_b64_tr_b16 v[114:115], v14 offset:1344
    v_mfma_f32_16x16x32_bf16 v[168:171], v[40:43], v[56:59], v[168:171]
    ds_read_b64_tr_b16 v[116:117], v39 offset:64
    ds_read_b64_tr_b16 v[118:119], v39 offset:1344
    v_mfma_f32_16x16x32_bf16 v[172:175], v[44:47], v[56:59], v[172:175]
    ds_read_b64_tr_b16 v[120:121], v15 offset:0
    ds_read_b64_tr_b16 v[122:123], v15 offset:1280
    v_mfma_f32_16x16x32_bf16 v[176:179], v[40:43], v[60:63], v[176:179]
    ds_read_b128 v[124:127], v13 offset:0
    ds_read_b128 v[128:131], v13 offset:2048
    v_mfma_f32_16x16x32_bf16 v[180:183], v[44:47], v[60:63], v[180:183]
    ds_read_b64_tr_b16 v[132:133], v14 offset:10240
    ds_read_b64_tr_b16 v[134:135], v14 offset:11520
    v_mfma_f32_16x16x32_bf16 v[184:187], v[40:43], v[64:67], v[184:187]
    ds_read_b64_tr_b16 v[136:137], v39 offset:10240
    ds_read_b64_tr_b16 v[138:139], v39 offset:11520
    v_mfma_f32_16x16x32_bf16 v[188:191], v[44:47], v[64:67], v[188:191]
    ds_read_b64_tr_b16 v[140:141], v14 offset:10304
    ds_read_b64_tr_b16 v[142:143], v14 offset:11584
    v_mfma_f32_16x16x32_bf16 v[152:155], v[68:71], v[76:79], v[152:155]
    ds_read_b64_tr_b16 v[144:145], v39 offset:10304
    ds_read_b64_tr_b16 v[146:147], v39 offset:11584
    v_mfma_f32_16x16x32_bf16 v[156:159], v[72:75], v[76:79], v[156:159]
    ds_read_b64_tr_b16 v[148:149], v15 offset:10240
    ds_read_b64_tr_b16 v[150:151], v15 offset:11520
    v_mfma_f32_16x16x32_bf16 v[160:163], v[68:71], v[80:83], v[160:163]
    v_add_u32 v39, s73, v38
    v_add_u32 v12, s72, v8
    v_mfma_f32_16x16x32_bf16 v[164:167], v[72:75], v[80:83], v[164:167]
    v_add_u32 v13, s72, v9
    v_add_u32 v14, s73, v10
    v_mfma_f32_16x16x32_bf16 v[168:171], v[68:71], v[84:87], v[168:171]
    v_add_u32 v15, s73, v11
    s_add_u32 s72, s72, 8192
    v_mfma_f32_16x16x32_bf16 v[172:175], v[72:75], v[84:87], v[172:175]
    s_cmp_ge_u32 s72, 81920
    s_cselect_b32 s72, 0, s72
    v_mfma_f32_16x16x32_bf16 v[176:179], v[68:71], v[88:91], v[176:179]
    s_add_u32 s73, s73, 20480
    s_cmp_ge_u32 s73, 163840
    v_mfma_f32_16x16x32_bf16 v[180:183], v[72:75], v[88:91], v[180:183]
    s_cselect_b32 s73, 81920, s73
    s_sub_u32 s74, s74, 1
    v_mfma_f32_16x16x32_bf16 v[184:187], v[68:71], v[92:95], v[184:187]
    s_cmp_lg_u32 s74, 0
    v_mfma_f32_16x16x32_bf16 v[188:191], v[72:75], v[92:95], v[188:191]
    s_waitcnt lgkmcnt(0)
    s_cbranch_scc1 Lcp1a_6
Lnhj_2:
    s_and_b32 s78, s4, 7
    s_add_u32 s78, s78, 3
    s_cmp_ge_u32 s78, 10
    s_cselect_b32 s78, 0, s78
    s_mul_i32 s70, s78, 221184
    s_sub_u32 s71, s71, 1728
    s_add_u32 s70, s70, s71
    s_nop 0
    s_add_u32 s69, s83, 20480
    s_mov_b32 s79, 0xffff0000
    v_mfma_f32_16x16x32_bf16 v[152:155], v[96:99], v[104:107], v[152:155]
    v_mfma_f32_16x16x32_bf16 v[156:159], v[100:103], v[104:107], v[156:159]
    v_mfma_f32_16x16x32_bf16 v[160:163], v[96:99], v[108:111], v[160:163]
    v_mfma_f32_16x16x32_bf16 v[164:167], v[100:103], v[108:111], v[164:167]
    v_mfma_f32_16x16x32_bf16 v[168:171], v[96:99], v[112:115], v[168:171]
    v_mfma_f32_16x16x32_bf16 v[172:175], v[100:103], v[112:115], v[172:175]
    v_mfma_f32_16x16x32_bf16 v[176:179], v[96:99], v[116:119], v[176:179]
    v_mfma_f32_16x16x32_bf16 v[180:183], v[100:103], v[116:119], v[180:183]
    v_mfma_f32_16x16x32_bf16 v[184:187], v[96:99], v[120:123], v[184:187]
    v_mfma_f32_16x16x32_bf16 v[188:191], v[100:103], v[120:123], v[188:191]
    v_mfma_f32_16x16x32_bf16 v[152:155], v[124:127], v[132:135], v[152:155]
    v_mfma_f32_16x16x32_bf16 v[156:159], v[128:131], v[132:135], v[156:159]
    v_mfma_f32_16x16x32_bf16 v[160:163], v[124:127], v[136:139], v[160:163]
    v_mfma_f32_16x16x32_bf16 v[164:167], v[128:131], v[136:139], v[164:167]
    v_mfma_f32_16x16x32_bf16 v[168:171], v[124:127], v[140:143], v[168:171]
    v_mfma_f32_16x16x32_bf16 v[172:175], v[128:131], v[140:143], v[172:175]
    v_mfma_f32_16x16x32_bf16 v[176:179], v[124:127], v[144:147], v[176:179]
    v_mfma_f32_16x16x32_bf16 v[180:183], v[128:131], v[144:147], v[180:183]
    v_mfma_f32_16x16x32_bf16 v[184:187], v[124:127], v[148:151], v[184:187]
    v_mfma_f32_16x16x32_bf16 v[188:191], v[128:131], v[148:151], v[188:191]
    s_waitcnt lgkmcnt(0)
    v_mov_b32 v192, 0
    v_mov_b32 v193, 0
    v_mov_b32 v194, 0
    v_mov_b32 v195, 0
    v_mov_b32 v196, 0
    v_mov_b32 v197, 0
    v_mov_b32 v198, 0
    v_mov_b32 v199, 0
    v_mov_b32 v200, 0
    v_mov_b32 v201, 0
    v_mov_b32 v202, 0
    v_mov_b32 v203, 0
    v_mov_b32 v204, 0
    v_mov_b32 v205, 0
    v_mov_b32 v206, 0
    v_mov_b32_e64 v207, 0
    v_pk_mul_f32 v[16:17], v[152:153], v[152:153]
    v_pk_mul_f32 v[18:19], v[154:155], v[154:155]
    v_pk_mul_f32 v[20:21], v[156:157], v[156:157]
    v_pk_mul_f32 v[22:23], v[158:159], v[158:159]
    v_pk_fma_f32 v[16:17], v[16:17], s[76:77], v[32:33]
    v_pk_fma_f32 v[18:19], v[18:19], s[76:77], v[32:33]
    v_pk_fma_f32 v[20:21], v[20:21], s[76:77], v[32:33]
    v_pk_fma_f32 v[22:23], v[22:23], s[76:77], v[32:33]
    v_pk_mul_f32 v[16:17], v[16:17], v[152:153]
    v_pk_mul_f32 v[18:19], v[18:19], v[154:155]
    v_pk_mul_f32 v[20:21], v[20:21], v[156:157]
    v_pk_mul_f32 v[22:23], v[22:23], v[158:159]
    v_exp_f32 v16, v16
    v_exp_f32 v18, v18
    v_exp_f32 v20, v20
    v_exp_f32 v22, v22
    v_exp_f32 v17, v17
    v_exp_f32 v19, v19
    v_exp_f32 v21, v21
    v_exp_f32 v23, v23
    v_pk_add_f32 v[16:17], v[16:17], 1.0 op_sel_hi:[1,0]
    v_pk_add_f32 v[18:19], v[18:19], 1.0 op_sel_hi:[1,0]
    v_pk_add_f32 v[20:21], v[20:21], 1.0 op_sel_hi:[1,0]
    v_pk_add_f32 v[22:23], v[22:23], 1.0 op_sel_hi:[1,0]
    v_rcp_f32 v16, v16
    v_rcp_f32 v18, v18
    v_rcp_f32 v20, v20
    v_rcp_f32 v22, v22
    v_rcp_f32 v17, v17
    v_rcp_f32 v19, v19
    v_rcp_f32 v21, v21
    v_rcp_f32 v23, v23
    v_pk_mul_f32 v[152:153], v[16:17], v[152:153]
    v_pk_mul_f32 v[154:155], v[18:19], v[154:155]
    v_pk_mul_f32 v[156:157], v[20:21], v[156:157]
    v_pk_mul_f32 v[158:159], v[22:23], v[158:159]
    v_pk_add_f32 v[192:193], v[192:193], v[152:153]
    v_pk_add_f32 v[194:195], v[194:195], v[154:155]
    v_pk_add_f32 v[196:197], v[196:197], v[156:157]
    v_pk_add_f32 v[198:199], v[198:199], v[158:159]
    v_pk_fma_f32 v[200:201], v[152:153], v[152:153], v[200:201]
    v_pk_fma_f32 v[202:203], v[154:155], v[154:155], v[202:203]
    v_pk_fma_f32 v[204:205], v[156:157], v[156:157], v[204:205]
    v_pk_fma_f32 v[206:207], v[158:159], v[158:159], v[206:207]
    v_pk_mul_f32 v[16:17], v[160:161], v[160:161]
    v_pk_mul_f32 v[18:19], v[162:163], v[162:163]
    v_pk_mul_f32 v[20:21], v[164:165], v[164:165]
    v_pk_mul_f32 v[22:23], v[166:167], v[166:167]
    v_pk_fma_f32 v[16:17], v[16:17], s[76:77], v[32:33]
    v_pk_fma_f32 v[18:19], v[18:19], s[76:77], v[32:33]
    v_pk_fma_f32 v[20:21], v[20:21], s[76:77], v[32:33]
    v_pk_fma_f32 v[22:23], v[22:23], s[76:77], v[32:33]
    v_pk_mul_f32 v[16:17], v[16:17], v[160:161]
    v_pk_mul_f32 v[18:19], v[18:19], v[162:163]
    v_pk_mul_f32 v[20:21], v[20:21], v[164:165]
    v_pk_mul_f32 v[22:23], v[22:23], v[166:167]
    v_exp_f32 v16, v16
    v_exp_f32 v18, v18
    v_exp_f32 v20, v20
    v_exp_f32 v22, v22
    v_exp_f32 v17, v17
    v_exp_f32 v19, v19
    v_exp_f32 v21, v21
    v_exp_f32 v23, v23
    v_pk_add_f32 v[16:17], v[16:17], 1.0 op_sel_hi:[1,0]
    v_pk_add_f32 v[18:19], v[18:19], 1.0 op_sel_hi:[1,0]
    v_pk_add_f32 v[20:21], v[20:21], 1.0 op_sel_hi:[1,0]
    v_pk_add_f32 v[22:23], v[22:23], 1.0 op_sel_hi:[1,0]
    v_rcp_f32 v16, v16
    v_rcp_f32 v18, v18
    v_rcp_f32 v20, v20
    v_rcp_f32 v22, v22
    v_rcp_f32 v17, v17
    v_rcp_f32 v19, v19
    v_rcp_f32 v21, v21
    v_rcp_f32 v23, v23
    v_pk_mul_f32 v[160:161], v[16:17], v[160:161]
    v_pk_mul_f32 v[162:163], v[18:19], v[162:163]
    v_pk_mul_f32 v[164:165], v[20:21], v[164:165]
    v_pk_mul_f32 v[166:167], v[22:23], v[166:167]
    v_pk_add_f32 v[192:193], v[192:193], v[160:161]
    v_pk_add_f32 v[194:195], v[194:195], v[162:163]
    v_pk_add_f32 v[196:197], v[196:197], v[164:165]
    v_pk_add_f32 v[198:199], v[198:199], v[166:167]
    v_pk_fma_f32 v[200:201], v[160:161], v[160:161], v[200:201]
    v_pk_fma_f32 v[202:203], v[162:163], v[162:163], v[202:203]
    v_pk_fma_f32 v[204:205], v[164:165], v[164:165], v[204:205]
    v_pk_fma_f32 v[206:207], v[166:167], v[166:167], v[206:207]
    v_pk_mul_f32 v[16:17], v[168:169], v[168:169]
    v_pk_mul_f32 v[18:19], v[170:171], v[170:171]
    v_pk_mul_f32 v[20:21], v[172:173], v[172:173]
    v_pk_mul_f32 v[22:23], v[174:175], v[174:175]
    v_pk_fma_f32 v[16:17], v[16:17], s[76:77], v[32:33]
    v_pk_fma_f32 v[18:19], v[18:19], s[76:77], v[32:33]
    v_pk_fma_f32 v[20:21], v[20:21], s[76:77], v[32:33]
    v_pk_fma_f32 v[22:23], v[22:23], s[76:77], v[32:33]
    v_pk_mul_f32 v[16:17], v[16:17], v[168:169]
    v_pk_mul_f32 v[18:19], v[18:19], v[170:171]
    v_pk_mul_f32 v[20:21], v[20:21], v[172:173]
    v_pk_mul_f32 v[22:23], v[22:23], v[174:175]
    v_exp_f32 v16, v16
    v_exp_f32 v18, v18
    v_exp_f32 v20, v20
    v_exp_f32 v22, v22
    v_exp_f32 v17, v17
    v_exp_f32 v19, v19
    v_exp_f32 v21, v21
    v_exp_f32 v23, v23
    v_pk_add_f32 v[16:17], v[16:17], 1.0 op_sel_hi:[1,0]
    v_pk_add_f32 v[18:19], v[18:19], 1.0 op_sel_hi:[1,0]
    v_pk_add_f32 v[20:21], v[20:21], 1.0 op_sel_hi:[1,0]
    v_pk_add_f32 v[22:23], v[22:23], 1.0 op_sel_hi:[1,0]
    v_rcp_f32 v16, v16
    v_rcp_f32 v18, v18
    v_rcp_f32 v20, v20
    v_rcp_f32 v22, v22
    v_rcp_f32 v17, v17
    v_rcp_f32 v19, v19
    v_rcp_f32 v21, v21
    v_rcp_f32 v23, v23
    v_pk_mul_f32 v[168:169], v[16:17], v[168:169]
    v_pk_mul_f32 v[170:171], v[18:19], v[170:171]
    v_pk_mul_f32 v[172:173], v[20:21], v[172:173]
    v_pk_mul_f32 v[174:175], v[22:23], v[174:175]
    v_pk_add_f32 v[192:193], v[192:193], v[168:169]
    v_pk_add_f32 v[194:195], v[194:195], v[170:171]
    v_pk_add_f32 v[196:197], v[196:197], v[172:173]
    v_pk_add_f32 v[198:199], v[198:199], v[174:175]
    v_pk_fma_f32 v[200:201], v[168:169], v[168:169], v[200:201]
    v_pk_fma_f32 v[202:203], v[170:171], v[170:171], v[202:203]
    v_pk_fma_f32 v[204:205], v[172:173], v[172:173], v[204:205]
    v_pk_fma_f32 v[206:207], v[174:175], v[174:175], v[206:207]
    v_pk_mul_f32 v[16:17], v[176:177], v[176:177]
    v_pk_mul_f32 v[18:19], v[178:179], v[178:179]
    v_pk_mul_f32 v[20:21], v[180:181], v[180:181]
    v_pk_mul_f32 v[22:23], v[182:183], v[182:183]
    v_pk_fma_f32 v[16:17], v[16:17], s[76:77], v[32:33]
    v_pk_fma_f32 v[18:19], v[18:19], s[76:77], v[32:33]
    v_pk_fma_f32 v[20:21], v[20:21], s[76:77], v[32:33]
    v_pk_fma_f32 v[22:23], v[22:23], s[76:77], v[32:33]
    v_pk_mul_f32 v[16:17], v[16:17], v[176:177]
    v_pk_mul_f32 v[18:19], v[18:19], v[178:179]
    v_pk_mul_f32 v[20:21], v[20:21], v[180:181]
    v_pk_mul_f32 v[22:23], v[22:23], v[182:183]
    v_exp_f32 v16, v16
    v_exp_f32 v18, v18
    v_exp_f32 v20, v20
    v_exp_f32 v22, v22
    v_exp_f32 v17, v17
    v_exp_f32 v19, v19
    v_exp_f32 v21, v21
    v_exp_f32 v23, v23
    v_pk_add_f32 v[16:17], v[16:17], 1.0 op_sel_hi:[1,0]
    v_pk_add_f32 v[18:19], v[18:19], 1.0 op_sel_hi:[1,0]
    v_pk_add_f32 v[20:21], v[20:21], 1.0 op_sel_hi:[1,0]
    v_pk_add_f32 v[22:23], v[22:23], 1.0 op_sel_hi:[1,0]
    v_rcp_f32 v16, v16
    v_rcp_f32 v18, v18
    v_rcp_f32 v20, v20
    v_rcp_f32 v22, v22
    v_rcp_f32 v17, v17
    v_rcp_f32 v19, v19
    v_rcp_f32 v21, v21
    v_rcp_f32 v23, v23
    v_pk_mul_f32 v[176:177], v[16:17], v[176:177]
    v_pk_mul_f32 v[178:179], v[18:19], v[178:179]
    v_pk_mul_f32 v[180:181], v[20:21], v[180:181]
    v_pk_mul_f32 v[182:183], v[22:23], v[182:183]
    v_pk_add_f32 v[192:193], v[192:193], v[176:177]
    v_pk_add_f32 v[194:195], v[194:195], v[178:179]
    v_pk_add_f32 v[196:197], v[196:197], v[180:181]
    v_pk_add_f32 v[198:199], v[198:199], v[182:183]
    v_pk_fma_f32 v[200:201], v[176:177], v[176:177], v[200:201]
    v_pk_fma_f32 v[202:203], v[178:179], v[178:179], v[202:203]
    v_pk_fma_f32 v[204:205], v[180:181], v[180:181], v[204:205]
    v_pk_fma_f32 v[206:207], v[182:183], v[182:183], v[206:207]
    s_cmp_eq_u32 s68, 1
    s_cbranch_scc1 Lz4_9
    v_pk_mul_f32 v[16:17], v[184:185], v[184:185]
    v_pk_mul_f32 v[18:19], v[186:187], v[186:187]
    v_pk_mul_f32 v[20:21], v[188:189], v[188:189]
    v_pk_mul_f32 v[22:23], v[190:191], v[190:191]
    v_pk_fma_f32 v[16:17], v[16:17], s[76:77], v[32:33]
    v_pk_fma_f32 v[18:19], v[18:19], s[76:77], v[32:33]
    v_pk_fma_f32 v[20:21], v[20:21], s[76:77], v[32:33]
    v_pk_fma_f32 v[22:23], v[22:23], s[76:77], v[32:33]
    v_pk_mul_f32 v[16:17], v[16:17], v[184:185]
    v_pk_mul_f32 v[18:19], v[18:19], v[186:187]
    v_pk_mul_f32 v[20:21], v[20:21], v[188:189]
    v_pk_mul_f32 v[22:23], v[22:23], v[190:191]
    v_exp_f32 v16, v16
    v_exp_f32 v18, v18
    v_exp_f32 v20, v20
    v_exp_f32 v22, v22
    v_exp_f32 v17, v17
    v_exp_f32 v19, v19
    v_exp_f32 v21, v21
    v_exp_f32 v23, v23
    v_pk_add_f32 v[16:17], v[16:17], 1.0 op_sel_hi:[1,0]
    v_pk_add_f32 v[18:19], v[18:19], 1.0 op_sel_hi:[1,0]
    v_pk_add_f32 v[20:21], v[20:21], 1.0 op_sel_hi:[1,0]
    v_pk_add_f32 v[22:23], v[22:23], 1.0 op_sel_hi:[1,0]
    v_rcp_f32 v16, v16
    v_rcp_f32 v18, v18
    v_rcp_f32 v20, v20
    v_rcp_f32 v22, v22
    v_rcp_f32 v17, v17
    v_rcp_f32 v19, v19
    v_rcp_f32 v21, v21
    v_rcp_f32 v23, v23
    v_pk_mul_f32 v[184:185], v[16:17], v[184:185]
    v_pk_mul_f32 v[186:187], v[18:19], v[186:187]
    v_pk_mul_f32 v[188:189], v[20:21], v[188:189]
    v_pk_mul_f32 v[190:191], v[22:23], v[190:191]
    v_pk_add_f32 v[192:193], v[192:193], v[184:185]
    v_pk_add_f32 v[194:195], v[194:195], v[186:187]
    v_pk_add_f32 v[196:197], v[196:197], v[188:189]
    v_pk_add_f32 v[198:199], v[198:199], v[190:191]
    v_pk_fma_f32 v[200:201], v[184:185], v[184:185], v[200:201]
    v_pk_fma_f32 v[202:203], v[186:187], v[186:187], v[202:203]
    v_pk_fma_f32 v[204:205], v[188:189], v[188:189], v[204:205]
    v_pk_fma_f32 v[206:207], v[190:191], v[190:191], v[206:207]
Lz4_9:
    v_add_f32_dpp v192, v192, v192 row_mirror row_mask:0xf bank_mask:0x3
    v_add_f32_dpp v193, v193, v193 row_mirror row_mask:0xf bank_mask:0x3
    v_add_f32_dpp v194, v194, v194 row_mirror row_mask:0xf bank_mask:0x3
    v_add_f32_dpp v195, v195, v195 row_mirror row_mask:0xf bank_mask:0x3
    v_add_f32_dpp v196, v196, v196 row_mirror row_mask:0xf bank_mask:0x3
    v_add_f32_dpp v197, v197, v197 row_mirror row_mask:0xf bank_mask:0x3
    v_add_f32_dpp v198, v198, v198 row_mirror row_mask:0xf bank_mask:0x3
    v_add_f32_dpp v199, v199, v199 row_mirror row_mask:0xf bank_mask:0x3
    v_add_f32_dpp v192, v200, v200 row_mirror row_mask:0xf bank_mask:0xc
    v_add_f32_dpp v193, v201, v201 row_mirror row_mask:0xf bank_mask:0xc
    v_add_f32_dpp v194, v202, v202 row_mirror row_mask:0xf bank_mask:0xc
    v_add_f32_dpp v195, v203, v203 row_mirror row_mask:0xf bank_mask:0xc
    v_add_f32_dpp v196, v204, v204 row_mirror row_mask:0xf bank_mask:0xc
    v_add_f32_dpp v197, v205, v205 row_mirror row_mask:0xf bank_mask:0xc
    v_add_f32_dpp v198, v206, v206 row_mirror row_mask:0xf bank_mask:0xc
    v_add_f32_dpp v199, v207, v207 row_mirror row_mask:0xf bank_mask:0xc
    v_add_f32_dpp v192, v192, v192 row_half_mirror row_mask:0xf bank_mask:0x5
    v_add_f32_dpp v193, v193, v193 row_half_mirror row_mask:0xf bank_mask:0x5
    v_add_f32_dpp v194, v194, v194 row_half_mirror row_mask:0xf bank_mask:0x5
    v_add_f32_dpp v195, v195, v195 row_half_mirror row_mask:0xf bank_mask:0x5
    v_add_f32_dpp v192, v196, v196 row_half_mirror row_mask:0xf bank_mask:0xa
    v_add_f32_dpp v193, v197, v197 row_half_mirror row_mask:0xf bank_mask:0xa
    v_add_f32_dpp v194, v198, v198 row_half_mirror row_mask:0xf bank_mask:0xa
    v_add_f32_dpp v195, v199, v199 row_half_mirror row_mask:0xf bank_mask:0xa
    v_add_f32_dpp v192, v192, v192 quad_perm:[2,3,0,1] row_mask:0xf bank_mask:0xf
    v_add_f32_dpp v193, v193, v193 quad_perm:[2,3,0,1] row_mask:0xf bank_mask:0xf
    v_add_f32_dpp v194, v194, v194 quad_perm:[2,3,0,1] row_mask:0xf bank_mask:0xf
    v_add_f32_dpp v195, v195, v195 quad_perm:[2,3,0,1] row_mask:0xf bank_mask:0xf
    v_add_f32_dpp v192, v192, v192 quad_perm:[1,0,3,2] row_mask:0xf bank_mask:0xf
    v_add_f32_dpp v193, v193, v193 quad_perm:[1,0,3,2] row_mask:0xf bank_mask:0xf
    v_add_f32_dpp v194, v194, v194 quad_perm:[1,0,3,2] row_mask:0xf bank_mask:0xf
    v_add_f32_dpp v195, v195, v195 quad_perm:[1,0,3,2] row_mask:0xf bank_mask:0xf
    s_mov_b32 vcc_lo, 0xaaaaaaaa
    s_mov_b32 vcc_hi, 0xaaaaaaaa
    s_mov_b32 s86, 0xcccccccc
    s_mov_b32 s87, 0xcccccccc
    v_cndmask_b32 v192, v192, v193, vcc
    v_cndmask_b32 v194, v194, v195, vcc
    v_mov_b32 v193, s6
    v_cndmask_b32 v192, v192, v194, s[86:87]
    v_lshlrev_b32 v16, 3, v1
    s_lshl_b32 s80, s4, 1
    s_add_u32 s80, s80, s67
    s_mul_i32 s80, s80, 6144
    s_add_u32 s80, s80, 524288
    s_lshl_b32 s78, s5, 1
    s_add_u32 s78, s78, s68
    s_lshl_b32 s78, s78, 9
    s_add_u32 s78, s78, s80
    buffer_store_dwordx2 v[192:193], v16, s[28:31], s78 offen sc1
    s_barrier
    s_mov_b32 m0, s69
    s_add_u32 s69, s69, 20480
    buffer_load_dwordx4 v2, s[12:15], s70 offen lds
    buffer_load_dwordx4 v3, s[12:15], s70 offen offset:1024 lds
    buffer_load_dwordx4 v4, s[12:15], s70 offen offset:2048 lds
    buffer_load_dwordx4 v5, s[12:15], s70 offen offset:3072 lds
    s_add_u32 m0, m0, 4096
    s_cmp_ge_u32 s69, 163840
    buffer_load_dwordx4 v6, s[12:15], s70 offen lds
    s_cselect_b32 s69, s83, s69
    s_add_u32 s70, s70, 221184
    s_cmp_ge_u32 s70, 2211840
    s_cselect_b32 s70, s71, s70
    s_barrier
    s_mov_b32 m0, s69
    s_add_u32 s69, s69, 20480
    buffer_load_dwordx4 v2, s[12:15], s70 offen lds
    buffer_load_dwordx4 v3, s[12:15], s70 offen offset:1024 lds
    buffer_load_dwordx4 v4, s[12:15], s70 offen offset:2048 lds
    buffer_load_dwordx4 v5, s[12:15], s70 offen offset:3072 lds
    s_add_u32 m0, m0, 4096
    s_cmp_ge_u32 s69, 163840
    buffer_load_dwordx4 v6, s[12:15], s70 offen lds
    s_cselect_b32 s69, s83, s69
    s_add_u32 s70, s70, 221184
    s_cmp_ge_u32 s70, 2211840
    s_cselect_b32 s70, s71, s70
    s_barrier
    s_mov_b32 s82, 200000
    s_add_u32 s78, s80, 4096
    s_mov_b32 m0, s69
    s_add_u32 s69, s69, 20480
    buffer_load_dwordx4 v2, s[12:15], s70 offen lds
    buffer_load_dwordx4 v3, s[12:15], s70 offen offset:1024 lds
    buffer_load_dwordx4 v4, s[12:15], s70 offen offset:2048 lds
    buffer_load_dwordx4 v5, s[12:15], s70 offen offset:3072 lds
    s_add_u32 m0, m0, 4096
    s_cmp_ge_u32 s69, 163840
    buffer_load_dwordx4 v6, s[12:15], s70 offen lds
    s_cselect_b32 s69, s83, s69
    s_add_u32 s70, s70, 221184
    s_cmp_ge_u32 s70, 2211840
    s_cselect_b32 s70, s71, s70
    s_waitcnt vmcnt(10)
    s_barrier
    buffer_load_dwordx2 v[128:129], v16, s[28:31], s80 offen offset:0 sc1
    buffer_load_dwordx2 v[130:131], v16, s[28:31], s80 offen offset:512 sc1
    buffer_load_dwordx2 v[132:133], v16, s[28:31], s80 offen offset:1024 sc1
    buffer_load_dwordx2 v[134:135], v16, s[28:31], s80 offen offset:1536 sc1
    buffer_load_dwordx2 v[136:137], v16, s[28:31], s80 offen offset:2048 sc1
    buffer_load_dwordx2 v[138:139], v16, s[28:31], s80 offen offset:2560 sc1
    buffer_load_dwordx2 v[140:141], v16, s[28:31], s80 offen offset:3072 sc1
    buffer_load_dwordx2 v[142:143], v16, s[28:31], s80 offen offset:3584 sc1
    buffer_load_dwordx2 v[144:145], v16, s[28:31], s78 offen offset:0 sc1
    buffer_load_dwordx2 v[146:147], v16, s[28:31], s78 offen offset:512 sc1
    buffer_load_dwordx2 v[148:149], v16, s[28:31], s78 offen offset:1024 sc1
    buffer_load_dwordx2 v[150:151], v16, s[28:31], s78 offen offset:1536 sc1
    s_mov_b32 m0, s69
    s_nop 0
    s_add_u32 s69, s69, 20480
    buffer_load_dwordx4 v2, s[12:15], s70 offen lds
    buffer_load_dwordx4 v3, s[12:15], s70 offen offset:1024 lds
    buffer_load_dwordx4 v4, s[12:15], s70 offen offset:2048 lds
    buffer_load_dwordx4 v5, s[12:15], s70 offen offset:3072 lds
    s_add_u32 m0, m0, 4096
    s_cmp_ge_u32 s69, 163840
    buffer_load_dwordx4 v6, s[12:15], s70 offen lds
    s_cselect_b32 s69, s83, s69
    s_add_u32 s70, s70, 221184
    s_cmp_ge_u32 s70, 2211840
    s_cselect_b32 s70, s71, s70
    s_waitcnt vmcnt(22)
    s_barrier
    s_mov_b32 m0, s69
    s_nop 0
    s_add_u32 s69, s69, 20480
    buffer_load_dwordx4 v2, s[12:15], s70 offen lds
    buffer_load_dwordx4 v3, s[12:15], s70 offen offset:1024 lds
    buffer_load_dwordx4 v4, s[12:15], s70 offen offset:2048 lds
    buffer_load_dwordx4 v5, s[12:15], s70 offen offset:3072 lds
    s_add_u32 m0, m0, 4096
    s_cmp_ge_u32 s69, 163840
    buffer_load_dwordx4 v6, s[12:15], s70 offen lds
    s_cselect_b32 s69, s83, s69
    s_add_u32 s70, s70, 221184
    s_cmp_ge_u32 s70, 2211840
    s_cselect_b32 s70, s71, s70
    s_waitcnt vmcnt(10)
    s_branch Lchk_12
Lst_10:
    buffer_load_dwordx2 v[128:129], v16, s[28:31], s80 offen offset:0 sc1
    buffer_load_dwordx2 v[130:131], v16, s[28:31], s80 offen offset:512 sc1
    buffer_load_dwordx2 v[132:133], v16, s[28:31], s80 offen offset:1024 sc1
    buffer_load_dwordx2 v[134:135], v16, s[28:31], s80 offen offset:1536 sc1
    buffer_load_dwordx2 v[136:137], v16, s[28:31], s80 offen offset:2048 sc1
    buffer_load_dwordx2 v[138:139], v16, s[28:31], s80 offen offset:2560 sc1
    buffer_load_dwordx2 v[140:141], v16, s[28:31], s80 offen offset:3072 sc1
    buffer_load_dwordx2 v[142:143], v16, s[28:31], s80 offen offset:3584 sc1
    buffer_load_dwordx2 v[144:145], v16, s[28:31], s78 offen offset:0 sc1
    buffer_load_dwordx2 v[146:147], v16, s[28:31], s78 offen offset:512 sc1
    buffer_load_dwordx2 v[148:149], v16, s[28:31], s78 offen offset:1024 sc1
    buffer_load_dwordx2 v[150:151], v16, s[28:31], s78 offen offset:1536 sc1
    s_waitcnt vmcnt(0)
Lchk_12:
    v_xor_b32 v17, s6, v129
    v_xor_b32 v18, s6, v131
    v_or_b32 v17, v17, v18
    v_xor_b32 v18, s6, v133
    v_or_b32 v17, v17, v18
    v_xor_b32 v18, s6, v135
    v_or_b32 v17, v17, v18
    v_xor_b32 v18, s6, v137
    v_or_b32 v17, v17, v18
    v_xor_b32 v18, s6, v139
    v_or_b32 v17, v17, v18
    v_xor_b32 v18, s6, v141
    v_or_b32 v17, v17, v18
    v_xor_b32 v18, s6, v143
    v_or_b32 v17, v17, v18
    v_xor_b32 v18, s6, v145
    v_or_b32 v17, v17, v18
    v_xor_b32 v18, s6, v147
    v_or_b32 v17, v17, v18
    v_xor_b32 v18, s6, v149
    v_or_b32 v17, v17, v18
    v_xor_b32 v18, s6, v151
    v_or_b32 v17, v17, v18
    v_cmp_ne_u32 vcc, 0, v17
    s_cbranch_vccz Lstd_11
    s_sleep 2
    s_sub_u32 s82, s82, 1
    s_cmp_lg_u32 s82, 0
    s_cbranch_scc1 Lst_10
Lstd_11:
    v_add_f32 v128, v128, v130
    v_add_f32 v128, v128, v132
    v_add_f32 v128, v128, v134
    v_add_f32 v128, v128, v136
    v_add_f32 v128, v128, v138
    v_add_f32 v128, v128, v140
    v_add_f32 v128, v128, v142
    v_add_f32 v128, v128, v144
    v_add_f32 v128, v128, v146
    v_add_f32 v128, v128, v148
    v_add_f32 v128, v128, v150
    s_nop 1
    v_mov_b32_dpp v129, v128 row_ror:8 row_mask:0xf bank_mask:0xf
    v_mul_f32 v128, 0x3a97b426, v128
    v_mul_f32 v129, 0x3a97b426, v129
    v_fma_f32 v129, -v128, v128, v129
    v_max_f32 v129, 0, v129
    v_cvt_pk_bf16_f32 v30, v128, v129
    v_lshlrev_b32 v26, 16, v30
    v_xor_b32 v26, 0x80000000, v26
    v_mov_b32 v27, v26
    v_and_b32 v129, 0xffff0000, v30
    v_add_f32 v129, 0x3727c5ac, v129
    v_cvt_pk_bf16_f32 v30, v129, v129
    v_lshlrev_b32 v129, 16, v30
    v_sqrt_f32 v129, v129
    s_nop 0
    v_cvt_pk_bf16_f32 v30, v129, v129
    v_lshlrev_b32 v129, 16, v30
    v_rcp_f32 v28, v129
    s_nop 0
    v_mov_b32 v29, v28
    v_mul_f32 v26, v26, v28
    s_nop 1
    v_mov_b32_dpp v192, v26 row_newbcast:0 row_mask:0xf bank_mask:0xf
    v_mov_b32_dpp v200, v28 row_newbcast:0 row_mask:0xf bank_mask:0xf
    v_mov_b32_dpp v193, v26 row_newbcast:1 row_mask:0xf bank_mask:0xf
    v_mov_b32_dpp v201, v28 row_newbcast:1 row_mask:0xf bank_mask:0xf
    v_mov_b32_dpp v194, v26 row_newbcast:2 row_mask:0xf bank_mask:0xf
    v_mov_b32_dpp v202, v28 row_newbcast:2 row_mask:0xf bank_mask:0xf
    v_mov_b32_dpp v195, v26 row_newbcast:3 row_mask:0xf bank_mask:0xf
    v_mov_b32_dpp v203, v28 row_newbcast:3 row_mask:0xf bank_mask:0xf
    v_mov_b32_dpp v196, v26 row_newbcast:4 row_mask:0xf bank_mask:0xf
    v_mov_b32_dpp v204, v28 row_newbcast:4 row_mask:0xf bank_mask:0xf
    v_mov_b32_dpp v197, v26 row_newbcast:5 row_mask:0xf bank_mask:0xf
    v_mov_b32_dpp v205, v28 row_newbcast:5 row_mask:0xf bank_mask:0xf
    v_mov_b32_dpp v198, v26 row_newbcast:6 row_mask:0xf bank_mask:0xf
    v_mov_b32_dpp v206, v28 row_newbcast:6 row_mask:0xf bank_mask:0xf
    v_mov_b32_dpp v199, v26 row_newbcast:7 row_mask:0xf bank_mask:0xf
    v_mov_b32_dpp v207, v28 row_newbcast:7 row_mask:0xf bank_mask:0xf
    v_lshrrev_b32 v16, 4, v1
    v_and_b32 v17, 1, v16
    v_lshrrev_b32 v16, 1, v16
    v_lshl_add_u32 v16, v17, 1, v16
    v_lshlrev_b32 v16, 8, v16
    v_and_b32 v17, 15, v1
    v_lshl_add_u32 v16, v17, 4, v16
    s_lshl_b32 s78, s5, 5
    s_add_u32 s78, s78, s4
    s_mul_i32 s78, s78, 18432
    s_mul_i32 s80, s67, 9216
    s_add_u32 s78, s78, s80
    s_add_u32 s78, s78, 4194304
    s_mul_i32 s80, s68, 5120
    s_add_u32 s80, s80, s78
    s_nop 0
    s_add_u32 s78, s78, 4096
    v_pk_fma_f32 v[152:153], v[152:153], v[200:201], v[192:193]
    v_pk_fma_f32 v[154:155], v[154:155], v[202:203], v[194:195]
    v_pk_fma_f32 v[156:157], v[156:157], v[204:205], v[196:197]
    v_pk_fma_f32 v[158:159], v[158:159], v[206:207], v[198:199]
    v_cvt_pk_bf16_f32 v128, v152, v153
    v_cvt_pk_bf16_f32 v129, v154, v155
    v_cvt_pk_bf16_f32 v130, v156, v157
    v_cvt_pk_bf16_f32 v131, v158, v159
    s_nop 0
    v_permlane16_swap_b32 v128, v130
    v_permlane16_swap_b32 v129, v131
    s_nop 0
    buffer_store_dwordx4 v[128:131], v16, s[28:31], s80 offen offset:0 sc1
    v_pk_fma_f32 v[160:161], v[160:161], v[200:201], v[192:193]
    v_pk_fma_f32 v[162:163], v[162:163], v[202:203], v[194:195]
    v_pk_fma_f32 v[164:165], v[164:165], v[204:205], v[196:197]
    v_pk_fma_f32 v[166:167], v[166:167], v[206:207], v[198:199]
    v_cvt_pk_bf16_f32 v132, v160, v161
    v_cvt_pk_bf16_f32 v133, v162, v163
    v_cvt_pk_bf16_f32 v134, v164, v165
    v_cvt_pk_bf16_f32 v135, v166, v167
    s_nop 0
    v_permlane16_swap_b32 v132, v134
    v_permlane16_swap_b32 v133, v135
    s_nop 0
    buffer_store_dwordx4 v[132:135], v16, s[28:31], s80 offen offset:1024 sc1
    v_pk_fma_f32 v[168:169], v[168:169], v[200:201], v[192:193]
    v_pk_fma_f32 v[170:171], v[170:171], v[202:203], v[194:195]
    v_pk_fma_f32 v[172:173], v[172:173], v[204:205], v[196:197]
    v_pk_fma_f32 v[174:175], v[174:175], v[206:207], v[198:199]
    v_cvt_pk_bf16_f32 v136, v168, v169
    v_cvt_pk_bf16_f32 v137, v170, v171
    v_cvt_pk_bf16_f32 v138, v172, v173
    v_cvt_pk_bf16_f32 v139, v174, v175
    s_nop 0
    v_permlane16_swap_b32 v136, v138
    v_permlane16_swap_b32 v137, v139
    s_nop 0
    buffer_store_dwordx4 v[136:139], v16, s[28:31], s80 offen offset:2048 sc1
    v_pk_fma_f32 v[176:177], v[176:177], v[200:201], v[192:193]
    v_pk_fma_f32 v[178:179], v[178:179], v[202:203], v[194:195]
    v_pk_fma_f32 v[180:181], v[180:181], v[204:205], v[196:197]
    v_pk_fma_f32 v[182:183], v[182:183], v[206:207], v[198:199]
    v_cvt_pk_bf16_f32 v140, v176, v177
    v_cvt_pk_bf16_f32 v141, v178, v179
    v_cvt_pk_bf16_f32 v142, v180, v181
    v_cvt_pk_bf16_f32 v143, v182, v183
    s_nop 0
    v_permlane16_swap_b32 v140, v142
    v_permlane16_swap_b32 v141, v143
    buffer_store_dwordx4 v[140:143], v16, s[28:31], s80 offen offset:3072 sc1
    s_cmp_eq_u32 s68, 1
    s_cbranch_scc1 Lz4b_13
    s_nop 0
    v_pk_fma_f32 v[184:185], v[184:185], v[200:201], v[192:193]
    v_pk_fma_f32 v[186:187], v[186:187], v[202:203], v[194:195]
    v_pk_fma_f32 v[188:189], v[188:189], v[204:205], v[196:197]
    v_pk_fma_f32 v[190:191], v[190:191], v[206:207], v[198:199]
    v_cvt_pk_bf16_f32 v144, v184, v185
    v_cvt_pk_bf16_f32 v145, v186, v187
    v_cvt_pk_bf16_f32 v146, v188, v189
    v_cvt_pk_bf16_f32 v147, v190, v191
    s_nop 0
    v_permlane16_swap_b32 v144, v146
    v_permlane16_swap_b32 v145, v147
    buffer_store_dwordx4 v[144:147], v16, s[28:31], s78 offen sc1
Lz4b_13:
    s_barrier
    s_mov_b32 m0, s69
    s_nop 0
    s_add_u32 s69, s69, 20480
    buffer_load_dwordx4 v2, s[12:15], s70 offen lds
    buffer_load_dwordx4 v3, s[12:15], s70 offen offset:1024 lds
    buffer_load_dwordx4 v4, s[12:15], s70 offen offset:2048 lds
    buffer_load_dwordx4 v5, s[12:15], s70 offen offset:3072 lds
    s_add_u32 m0, m0, 4096
    s_cmp_ge_u32 s69, 163840
    buffer_load_dwordx4 v6, s[12:15], s70 offen lds
    s_cselect_b32 s69, s83, s69
    s_add_u32 s70, s70, 221184
    s_cmp_ge_u32 s70, 2211840
    s_cselect_b32 s70, s71, s70
    s_waitcnt vmcnt(14)
    s_barrier
    s_mov_b32 m0, s69
    s_nop 0
    s_add_u32 s69, s69, 20480
    buffer_load_dwordx4 v2, s[12:15], s70 offen lds
    buffer_load_dwordx4 v3, s[12:15], s70 offen offset:1024 lds
    buffer_load_dwordx4 v4, s[12:15], s70 offen offset:2048 lds
    buffer_load_dwordx4 v5, s[12:15], s70 offen offset:3072 lds
    s_add_u32 m0, m0, 4096
    s_cmp_ge_u32 s69, 163840
    buffer_load_dwordx4 v6, s[12:15], s70 offen lds
    s_cselect_b32 s69, s83, s69
    s_add_u32 s70, s70, 221184
    s_cmp_ge_u32 s70, 2211840
    s_cselect_b32 s70, s71, s70
    s_lshl_b32 s81, s5, 2
    s_add_u32 s81, s81, s66
    s_lshl_b32 s81, s81, 12
    s_add_u32 s81, s81, 131072
    s_lshl_b32 s78, s4, 7
    s_add_u32 s78, s78, s81
    s_waitcnt vmcnt(14)
    s_barrier
    s_waitcnt vmcnt(10)
    v_mov_b32 v24, s6
    v_lshlrev_b32 v25, 2, v1
    s_mov_b32 exec_hi, 0
    buffer_store_dword v24, v25, s[28:31], s78 offen sc1
    s_mov_b64 exec, -1
    s_lshl_b32 s7, s68, 3
    s_sub_u32 s7, 39, s7
    v_min_u32 v20, s7, v1
    v_lshlrev_b32 v20, 7, v20
    buffer_load_dword v30, v20, s[28:31], s80 offen sc1
    s_waitcnt vmcnt(7)
    s_barrier
    s_lshl_b32 s92, s66, 4
    v_lshrrev_b32 v20, 3, v1
    v_add_u32 v20, s92, v20
    v_add_u32 v20, 0, v20
    v_bfe_u32 v21, v20, 1, 3
    v_and_b32 v22, 7, v1
    v_xor_b32 v21, v21, v22
    v_lshlrev_b32 v21, 4, v21
    v_lshl_add_u32 v2, v20, 12, v21
    v_lshrrev_b32 v20, 3, v1
    v_add_u32 v20, s92, v20
    v_add_u32 v20, 8, v20
    v_bfe_u32 v21, v20, 1, 3
    v_and_b32 v22, 7, v1
    v_xor_b32 v21, v21, v22
    v_lshlrev_b32 v21, 4, v21
    v_lshl_add_u32 v3, v20, 12, v21
    v_subrev_u32 v3, 1024, v3
    v_and_b32 v5, 31, v1
    v_lshlrev_b32 v5, 7, v5
    s_lshl_b32 s70, s4, 18
    s_add_u32 s42, s70, 4096
    s_and_b32 s92, s4, 24
    s_lshl_b32 s7, s92, 7
    s_add_u32 s70, s70, s7
    s_lshl_b32 s69, s66, 11
    s_mul_i32 s73, s67, 9216
    s_mul_i32 s7, s68, 5120
    s_add_u32 s73, s73, s7
    s_mul_i32 s72, s5, 589824
    s_add_u32 s72, s72, s73
    s_add_u32 s72, s72, 4194304
    s_add_u32 s43, s72, 589824
    s_mul_i32 s7, s92, 18432
    s_add_u32 s72, s72, s7
    s_add_u32 s95, s72, 4096
    s_add_u32 s73, s73, 0
    s_waitcnt vmcnt(2)
    s_barrier
    s_add_u32 m0, s69, 81920
    s_nop 0
    buffer_load_dwordx4 v2, s[16:19], s70 offen lds
    buffer_load_dwordx4 v3, s[16:19], s70 offen offset:1024 lds
    s_add_u32 s70, s70, 128
    s_add_u32 m0, s69, 90112
    s_nop 0
    buffer_load_dwordx4 v2, s[16:19], s70 offen lds
    buffer_load_dwordx4 v3, s[16:19], s70 offen offset:1024 lds
    s_add_u32 s70, s70, 128
    s_add_u32 m0, s69, 98304
    s_nop 0
    buffer_load_dwordx4 v2, s[16:19], s70 offen lds
    buffer_load_dwordx4 v3, s[16:19], s70 offen offset:1024 lds
    s_add_u32 s70, s70, 128
    s_add_u32 m0, s69, 106496
    s_nop 0
    buffer_load_dwordx4 v2, s[16:19], s70 offen lds
    buffer_load_dwordx4 v3, s[16:19], s70 offen offset:1024 lds
    s_add_u32 s70, s70, 128
    s_add_u32 m0, s69, 114688
    s_nop 0
    buffer_load_dwordx4 v2, s[16:19], s70 offen lds
    buffer_load_dwordx4 v3, s[16:19], s70 offen offset:1024 lds
    s_add_u32 s70, s70, 128
    s_add_u32 m0, s69, 122880
    s_nop 0
    buffer_load_dwordx4 v2, s[16:19], s70 offen lds
    buffer_load_dwordx4 v3, s[16:19], s70 offen offset:1024 lds
    s_add_u32 s70, s70, 128
    s_barrier
    s_and_b32 s7, s4, 24
    s_lshl_b32 exec_lo, 0xff, s7
    s_mov_b32 exec_hi, 0
    s_add_u32 s7, s7, 8
    s_and_b32 s7, s7, 31
    s_lshl_b32 s41, 0xff, s7
    s_mov_b32 s82, 200000
Lpoll_14:
    buffer_load_dword v16, v5, s[28:31], s81 offen sc1
    s_waitcnt vmcnt(0)
    v_cmp_ne_u32 vcc, s6, v16
    s_cbranch_vccz Lpolld_15
    s_mov_b64 exec, vcc
    s_sleep 8
    s_sub_u32 s82, s82, 1
    s_cmp_lg_u32 s82, 0
    s_cbranch_scc1 Lpoll_14
Lpolld_15:
    s_mov_b64 exec, -1
    s_cmp_eq_u32 s68, 1
    s_cbranch_scc1 Lp2four_16
    s_add_u32 m0, s73, 0
    s_nop 0
    buffer_load_dwordx4 v7, s[28:31], s72 offen offset:0 sc1 lds
    buffer_load_dwordx4 v7, s[28:31], s72 offen offset:1024 sc1 lds
    buffer_load_dwordx4 v7, s[28:31], s72 offen offset:2048 sc1 lds
    buffer_load_dwordx4 v7, s[28:31], s72 offen offset:3072 sc1 lds
    s_add_u32 m0, s73, 4096
    s_add_u32 s72, s72, 18432
    buffer_load_dwordx4 v7, s[28:31], s95 offen sc1 lds
    s_add_u32 s95, s95, 18432
    s_add_u32 m0, s73, 18432
    s_nop 0
    s_nop 0
    buffer_load_dwordx4 v7, s[28:31], s72 offen offset:0 sc1 lds
    buffer_load_dwordx4 v7, s[28:31], s72 offen offset:1024 sc1 lds
    buffer_load_dwordx4 v7, s[28:31], s72 offen offset:2048 sc1 lds
    buffer_load_dwordx4 v7, s[28:31], s72 offen offset:3072 sc1 lds
    s_add_u32 m0, s73, 22528
    s_add_u32 s72, s72, 18432
    buffer_load_dwordx4 v7, s[28:31], s95 offen sc1 lds
    s_add_u32 s95, s95, 18432
    s_waitcnt vmcnt(5)
    s_barrier
    s_add_u32 m0, s73, 36864
    s_nop 0
    s_nop 0
    buffer_load_dwordx4 v7, s[28:31], s72 offen offset:0 sc1 lds
    buffer_load_dwordx4 v7, s[28:31], s72 offen offset:1024 sc1 lds
    buffer_load_dwordx4 v7, s[28:31], s72 offen offset:2048 sc1 lds
    buffer_load_dwordx4 v7, s[28:31], s72 offen offset:3072 sc1 lds
    s_add_u32 m0, s73, 40960
    s_add_u32 s72, s72, 18432
    buffer_load_dwordx4 v7, s[28:31], s95 offen sc1 lds
    s_add_u32 s95, s95, 18432
    s_add_u32 m0, s73, 55296
    s_nop 0
    s_nop 0
    buffer_load_dwordx4 v7, s[28:31], s72 offen offset:0 sc1 lds
    buffer_load_dwordx4 v7, s[28:31], s72 offen offset:1024 sc1 lds
    buffer_load_dwordx4 v7, s[28:31], s72 offen offset:2048 sc1 lds
    buffer_load_dwordx4 v7, s[28:31], s72 offen offset:3072 sc1 lds
    s_add_u32 m0, s73, 59392
    s_add_u32 s72, s72, 18432
    buffer_load_dwordx4 v7, s[28:31], s95 offen sc1 lds
    s_add_u32 s95, s95, 18432
    s_add_u32 m0, s69, 131072
    s_nop 0
    buffer_load_dwordx4 v2, s[16:19], s70 offen lds
    buffer_load_dwordx4 v3, s[16:19], s70 offen offset:1024 lds
    s_add_u32 s70, s70, 128
    s_add_u32 m0, s69, 139264
    s_nop 0
    buffer_load_dwordx4 v2, s[16:19], s70 offen lds
    buffer_load_dwordx4 v3, s[16:19], s70 offen offset:1024 lds
    s_add_u32 s70, s70, 128
    s_waitcnt vmcnt(14)
    s_mov_b32 s74, 6
Lp2f_18:
    s_cmp_ge_u32 s70, s42
    s_cselect_b32 s7, 4096, 0
    s_sub_u32 s70, s70, s7
    s_cmp_ge_u32 s72, s43
    s_cselect_b32 s7, 589824, 0
    s_sub_u32 s72, s72, s7
    s_sub_u32 s95, s95, s7
    s_bitcmp0_b32 s74, 0
    s_cbranch_scc1 Lfk_19
    v_cmp_ne_u32 vcc, s6, v6
    s_nop 0
    s_and_b32 s7, vcc_lo, s41
    s_cbranch_scc0 Lfr_20
    s_mov_b32 exec_lo, s7
    s_mov_b32 exec_hi, 0
    s_mov_b32 s82, 200000
Lpoll_21:
    buffer_load_dword v16, v5, s[28:31], s81 offen sc1
    s_waitcnt vmcnt(0)
    v_cmp_ne_u32 vcc, s6, v16
    s_cbranch_vccz Lpolld_22
    s_mov_b64 exec, vcc
    s_sleep 8
    s_sub_u32 s82, s82, 1
    s_cmp_lg_u32 s82, 0
    s_cbranch_scc1 Lpoll_21
Lpolld_22:
    s_mov_b64 exec, -1
Lfr_20:
    s_lshr_b32 s7, s41, 24
    s_lshl_b32 s41, s41, 8
    s_or_b32 s41, s41, s7
Lfk_19:
    s_barrier
    s_add_u32 m0, s73, 0
    s_nop 0
    buffer_load_dwordx4 v7, s[28:31], s72 offen offset:0 sc1 lds
    buffer_load_dwordx4 v7, s[28:31], s72 offen offset:1024 sc1 lds
    buffer_load_dwordx4 v7, s[28:31], s72 offen offset:2048 sc1 lds
    buffer_load_dwordx4 v7, s[28:31], s72 offen offset:3072 sc1 lds
    s_add_u32 m0, s73, 4096
    s_add_u32 s72, s72, 18432
    buffer_load_dwordx4 v7, s[28:31], s95 offen sc1 lds
    s_add_u32 s95, s95, 18432
    s_add_u32 m0, s69, 81920
    s_nop 0
    buffer_load_dwordx4 v2, s[16:19], s70 offen lds
    buffer_load_dwordx4 v3, s[16:19], s70 offen offset:1024 lds
    s_add_u32 s70, s70, 128
    s_waitcnt vmcnt(12)
    s_bitcmp1_b32 s74, 0
    s_cbranch_scc1 Lfq_23
    s_mov_b32 exec_lo, s41
    s_mov_b32 exec_hi, 0
    buffer_load_dword v6, v5, s[28:31], s81 offen sc1
    s_mov_b64 exec, -1
    s_cmp_lg_u32 s74, 6
    s_cbranch_scc1 Lfq_23
    buffer_load_dword v31, v37, s[28:31], s91 offen sc1
Lfq_23:
    s_barrier
    s_add_u32 m0, s73, 18432
    s_nop 0
    s_nop 0
    buffer_load_dwordx4 v7, s[28:31], s72 offen offset:0 sc1 lds
    buffer_load_dwordx4 v7, s[28:31], s72 offen offset:1024 sc1 lds
    buffer_load_dwordx4 v7, s[28:31], s72 offen offset:2048 sc1 lds
    buffer_load_dwordx4 v7, s[28:31], s72 offen offset:3072 sc1 lds
    s_add_u32 m0, s73, 22528
    s_add_u32 s72, s72, 18432
    buffer_load_dwordx4 v7, s[28:31], s95 offen sc1 lds
    s_add_u32 s95, s95, 18432
    s_add_u32 m0, s69, 90112
    s_nop 0
    buffer_load_dwordx4 v2, s[16:19], s70 offen lds
    buffer_load_dwordx4 v3, s[16:19], s70 offen offset:1024 lds
    s_add_u32 s70, s70, 128
    s_waitcnt vmcnt(12)
    s_barrier
    s_add_u32 m0, s73, 36864
    s_nop 0
    buffer_load_dwordx4 v7, s[28:31], s72 offen offset:0 sc1 lds
    buffer_load_dwordx4 v7, s[28:31], s72 offen offset:1024 sc1 lds
    buffer_load_dwordx4 v7, s[28:31], s72 offen offset:2048 sc1 lds
    buffer_load_dwordx4 v7, s[28:31], s72 offen offset:3072 sc1 lds
    s_add_u32 m0, s73, 40960
    s_add_u32 s72, s72, 18432
    buffer_load_dwordx4 v7, s[28:31], s95 offen sc1 lds
    s_add_u32 s95, s95, 18432
    s_add_u32 m0, s69, 98304
    s_nop 0
    buffer_load_dwordx4 v2, s[16:19], s70 offen lds
    buffer_load_dwordx4 v3, s[16:19], s70 offen offset:1024 lds
    s_add_u32 s70, s70, 128
    s_waitcnt vmcnt(12)
    s_barrier
    s_add_u32 m0, s73, 55296
    s_nop 0
    buffer_load_dwordx4 v7, s[28:31], s72 offen offset:0 sc1 lds
    buffer_load_dwordx4 v7, s[28:31], s72 offen offset:1024 sc1 lds
    buffer_load_dwordx4 v7, s[28:31], s72 offen offset:2048 sc1 lds
    buffer_load_dwordx4 v7, s[28:31], s72 offen offset:3072 sc1 lds
    s_add_u32 m0, s73, 59392
    s_add_u32 s72, s72, 18432
    buffer_load_dwordx4 v7, s[28:31], s95 offen sc1 lds
    s_add_u32 s95, s95, 18432
    s_add_u32 m0, s69, 106496
    s_nop 0
    buffer_load_dwordx4 v2, s[16:19], s70 offen lds
    buffer_load_dwordx4 v3, s[16:19], s70 offen offset:1024 lds
    s_add_u32 s70, s70, 128
    s_waitcnt vmcnt(12)
    s_xor_b32 s69, s69, 32768
    s_sub_u32 s74, s74, 1
    s_cmp_lg_u32 s74, 0
    s_cbranch_scc1 Lp2f_18
    s_cmp_ge_u32 s70, s42
    s_cselect_b32 s7, 4096, 0
    s_sub_u32 s70, s70, s7
    s_cmp_ge_u32 s72, s43
    s_cselect_b32 s7, 589824, 0
    s_sub_u32 s72, s72, s7
    s_sub_u32 s95, s95, s7
    s_barrier
    s_add_u32 m0, s73, 0
    s_nop 0
    s_nop 0
    buffer_load_dwordx4 v7, s[28:31], s72 offen offset:0 sc1 lds
    buffer_load_dwordx4 v7, s[28:31], s72 offen offset:1024 sc1 lds
    buffer_load_dwordx4 v7, s[28:31], s72 offen offset:2048 sc1 lds
    buffer_load_dwordx4 v7, s[28:31], s72 offen offset:3072 sc1 lds
    s_add_u32 m0, s73, 4096
    s_add_u32 s72, s72, 18432
    buffer_load_dwordx4 v7, s[28:31], s95 offen sc1 lds
    s_add_u32 s95, s95, 18432
    s_waitcnt vmcnt(10)
    s_barrier
    s_add_u32 m0, s73, 18432
    s_nop 0
    s_nop 0
    buffer_load_dwordx4 v7, s[28:31], s72 offen offset:0 sc1 lds
    buffer_load_dwordx4 v7, s[28:31], s72 offen offset:1024 sc1 lds
    buffer_load_dwordx4 v7, s[28:31], s72 offen offset:2048 sc1 lds
    buffer_load_dwordx4 v7, s[28:31], s72 offen offset:3072 sc1 lds
    s_add_u32 m0, s73, 22528
    s_add_u32 s72, s72, 18432
    buffer_load_dwordx4 v7, s[28:31], s95 offen sc1 lds
    s_add_u32 s95, s95, 18432
    s_waitcnt vmcnt(10)
    s_barrier
    s_add_u32 m0, s73, 36864
    s_nop 0
    s_nop 0
    buffer_load_dwordx4 v7, s[28:31], s72 offen offset:0 sc1 lds
    buffer_load_dwordx4 v7, s[28:31], s72 offen offset:1024 sc1 lds
    buffer_load_dwordx4 v7, s[28:31], s72 offen offset:2048 sc1 lds
    buffer_load_dwordx4 v7, s[28:31], s72 offen offset:3072 sc1 lds
    s_add_u32 m0, s73, 40960
    s_add_u32 s72, s72, 18432
    buffer_load_dwordx4 v7, s[28:31], s95 offen sc1 lds
    s_add_u32 s95, s95, 18432
    s_waitcnt vmcnt(10)
    s_barrier
    s_add_u32 m0, s73, 55296
    s_nop 0
    s_nop 0
    buffer_load_dwordx4 v7, s[28:31], s72 offen offset:0 sc1 lds
    buffer_load_dwordx4 v7, s[28:31], s72 offen offset:1024 sc1 lds
    buffer_load_dwordx4 v7, s[28:31], s72 offen offset:2048 sc1 lds
    buffer_load_dwordx4 v7, s[28:31], s72 offen offset:3072 sc1 lds
    s_add_u32 m0, s73, 59392
    s_add_u32 s72, s72, 18432
    buffer_load_dwordx4 v7, s[28:31], s95 offen sc1 lds
    s_add_u32 s95, s95, 18432
    s_waitcnt vmcnt(10)
    s_branch Lp2done_17
Lp2four_16:
    s_add_u32 m0, s73, 0
    s_nop 0
    buffer_load_dwordx4 v7, s[28:31], s72 offen offset:0 sc1 lds
    buffer_load_dwordx4 v7, s[28:31], s72 offen offset:1024 sc1 lds
    buffer_load_dwordx4 v7, s[28:31], s72 offen offset:2048 sc1 lds
    buffer_load_dwordx4 v7, s[28:31], s72 offen offset:3072 sc1 lds
    s_add_u32 s72, s72, 18432
    s_add_u32 m0, s73, 18432
    s_nop 0
    buffer_load_dwordx4 v7, s[28:31], s72 offen offset:0 sc1 lds
    buffer_load_dwordx4 v7, s[28:31], s72 offen offset:1024 sc1 lds
    buffer_load_dwordx4 v7, s[28:31], s72 offen offset:2048 sc1 lds
    buffer_load_dwordx4 v7, s[28:31], s72 offen offset:3072 sc1 lds
    s_add_u32 s72, s72, 18432
    s_waitcnt vmcnt(4)
    s_barrier
    s_add_u32 m0, s73, 36864
    s_nop 0
    buffer_load_dwordx4 v7, s[28:31], s72 offen offset:0 sc1 lds
    buffer_load_dwordx4 v7, s[28:31], s72 offen offset:1024 sc1 lds
    buffer_load_dwordx4 v7, s[28:31], s72 offen offset:2048 sc1 lds
    buffer_load_dwordx4 v7, s[28:31], s72 offen offset:3072 sc1 lds
    s_add_u32 s72, s72, 18432
    s_add_u32 m0, s73, 55296
    s_nop 0
    buffer_load_dwordx4 v7, s[28:31], s72 offen offset:0 sc1 lds
    buffer_load_dwordx4 v7, s[28:31], s72 offen offset:1024 sc1 lds
    buffer_load_dwordx4 v7, s[28:31], s72 offen offset:2048 sc1 lds
    buffer_load_dwordx4 v7, s[28:31], s72 offen offset:3072 sc1 lds
    s_add_u32 s72, s72, 18432
    s_add_u32 m0, s69, 131072
    s_nop 0
    buffer_load_dwordx4 v2, s[16:19], s70 offen lds
    buffer_load_dwordx4 v3, s[16:19], s70 offen offset:1024 lds
    s_add_u32 s70, s70, 128
    s_add_u32 m0, s69, 139264
    s_nop 0
    buffer_load_dwordx4 v2, s[16:19], s70 offen lds
    buffer_load_dwordx4 v3, s[16:19], s70 offen offset:1024 lds
    s_add_u32 s70, s70, 128
    s_waitcnt vmcnt(12)
    s_mov_b32 s74, 6
Lp2f_25:
    s_cmp_ge_u32 s70, s42
    s_cselect_b32 s7, 4096, 0
    s_sub_u32 s70, s70, s7
    s_cmp_ge_u32 s72, s43
    s_cselect_b32 s7, 589824, 0
    s_sub_u32 s72, s72, s7
    s_sub_u32 s95, s95, s7
    s_bitcmp0_b32 s74, 0
    s_cbranch_scc1 Lfk_26
    v_cmp_ne_u32 vcc, s6, v6
    s_nop 0
    s_and_b32 s7, vcc_lo, s41
    s_cbranch_scc0 Lfr_27
    s_mov_b32 exec_lo, s7
    s_mov_b32 exec_hi, 0
    s_mov_b32 s82, 200000
Lpoll_28:
    buffer_load_dword v16, v5, s[28:31], s81 offen sc1
    s_waitcnt vmcnt(0)
    v_cmp_ne_u32 vcc, s6, v16
    s_cbranch_vccz Lpolld_29
    s_mov_b64 exec, vcc
    s_sleep 8
    s_sub_u32 s82, s82, 1
    s_cmp_lg_u32 s82, 0
    s_cbranch_scc1 Lpoll_28
Lpolld_29:
    s_mov_b64 exec, -1
Lfr_27:
    s_lshr_b32 s7, s41, 24
    s_lshl_b32 s41, s41, 8
    s_or_b32 s41, s41, s7
Lfk_26:
    s_barrier
    s_add_u32 m0, s73, 0
    s_nop 0
    buffer_load_dwordx4 v7, s[28:31], s72 offen offset:0 sc1 lds
    buffer_load_dwordx4 v7, s[28:31], s72 offen offset:1024 sc1 lds
    buffer_load_dwordx4 v7, s[28:31], s72 offen offset:2048 sc1 lds
    buffer_load_dwordx4 v7, s[28:31], s72 offen offset:3072 sc1 lds
    s_add_u32 s72, s72, 18432
    s_add_u32 m0, s69, 81920
    s_nop 0
    buffer_load_dwordx4 v2, s[16:19], s70 offen lds
    buffer_load_dwordx4 v3, s[16:19], s70 offen offset:1024 lds
    s_add_u32 s70, s70, 128
    s_waitcnt vmcnt(10)
    s_bitcmp1_b32 s74, 0
    s_cbranch_scc1 Lfq_30
    s_mov_b32 exec_lo, s41
    s_mov_b32 exec_hi, 0
    buffer_load_dword v6, v5, s[28:31], s81 offen sc1
    s_mov_b64 exec, -1
    s_cmp_lg_u32 s74, 6
    s_cbranch_scc1 Lfq_30
    buffer_load_dword v31, v37, s[28:31], s91 offen sc1
Lfq_30:
    s_barrier
    s_add_u32 m0, s73, 18432
    s_nop 0
    buffer_load_dwordx4 v7, s[28:31], s72 offen offset:0 sc1 lds
    buffer_load_dwordx4 v7, s[28:31], s72 offen offset:1024 sc1 lds
    buffer_load_dwordx4 v7, s[28:31], s72 offen offset:2048 sc1 lds
    buffer_load_dwordx4 v7, s[28:31], s72 offen offset:3072 sc1 lds
    s_add_u32 s72, s72, 18432
    s_add_u32 m0, s69, 90112
    s_nop 0
    buffer_load_dwordx4 v2, s[16:19], s70 offen lds
    buffer_load_dwordx4 v3, s[16:19], s70 offen offset:1024 lds
    s_add_u32 s70, s70, 128
    s_waitcnt vmcnt(10)
    s_barrier
    s_add_u32 m0, s73, 36864
    s_nop 0
    buffer_load_dwordx4 v7, s[28:31], s72 offen offset:0 sc1 lds
    buffer_load_dwordx4 v7, s[28:31], s72 offen offset:1024 sc1 lds
    buffer_load_dwordx4 v7, s[28:31], s72 offen offset:2048 sc1 lds
    buffer_load_dwordx4 v7, s[28:31], s72 offen offset:3072 sc1 lds
    s_add_u32 s72, s72, 18432
    s_add_u32 m0, s69, 98304
    s_nop 0
    buffer_load_dwordx4 v2, s[16:19], s70 offen lds
    buffer_load_dwordx4 v3, s[16:19], s70 offen offset:1024 lds
    s_add_u32 s70, s70, 128
    s_waitcnt vmcnt(10)
    s_barrier
    s_add_u32 m0, s73, 55296
    s_nop 0
    buffer_load_dwordx4 v7, s[28:31], s72 offen offset:0 sc1 lds
    buffer_load_dwordx4 v7, s[28:31], s72 offen offset:1024 sc1 lds
    buffer_load_dwordx4 v7, s[28:31], s72 offen offset:2048 sc1 lds
    buffer_load_dwordx4 v7, s[28:31], s72 offen offset:3072 sc1 lds
    s_add_u32 s72, s72, 18432
    s_add_u32 m0, s69, 106496
    s_nop 0
    buffer_load_dwordx4 v2, s[16:19], s70 offen lds
    buffer_load_dwordx4 v3, s[16:19], s70 offen offset:1024 lds
    s_add_u32 s70, s70, 128
    s_waitcnt vmcnt(10)
    s_xor_b32 s69, s69, 32768
    s_sub_u32 s74, s74, 1
    s_cmp_lg_u32 s74, 0
    s_cbranch_scc1 Lp2f_25
    s_cmp_ge_u32 s70, s42
    s_cselect_b32 s7, 4096, 0
    s_sub_u32 s70, s70, s7
    s_cmp_ge_u32 s72, s43
    s_cselect_b32 s7, 589824, 0
    s_sub_u32 s72, s72, s7
    s_sub_u32 s95, s95, s7
    s_barrier
    s_add_u32 m0, s73, 0
    s_nop 0
    buffer_load_dwordx4 v7, s[28:31], s72 offen offset:0 sc1 lds
    buffer_load_dwordx4 v7, s[28:31], s72 offen offset:1024 sc1 lds
    buffer_load_dwordx4 v7, s[28:31], s72 offen offset:2048 sc1 lds
    buffer_load_dwordx4 v7, s[28:31], s72 offen offset:3072 sc1 lds
    s_add_u32 s72, s72, 18432
    s_waitcnt vmcnt(8)
    s_barrier
    s_add_u32 m0, s73, 18432
    s_nop 0
    buffer_load_dwordx4 v7, s[28:31], s72 offen offset:0 sc1 lds
    buffer_load_dwordx4 v7, s[28:31], s72 offen offset:1024 sc1 lds
    buffer_load_dwordx4 v7, s[28:31], s72 offen offset:2048 sc1 lds
    buffer_load_dwordx4 v7, s[28:31], s72 offen offset:3072 sc1 lds
    s_add_u32 s72, s72, 18432
    s_waitcnt vmcnt(8)
    s_barrier
    s_add_u32 m0, s73, 36864
    s_nop 0
    buffer_load_dwordx4 v7, s[28:31], s72 offen offset:0 sc1 lds
    buffer_load_dwordx4 v7, s[28:31], s72 offen offset:1024 sc1 lds
    buffer_load_dwordx4 v7, s[28:31], s72 offen offset:2048 sc1 lds
    buffer_load_dwordx4 v7, s[28:31], s72 offen offset:3072 sc1 lds
    s_add_u32 s72, s72, 18432
    s_waitcnt vmcnt(8)
    s_barrier
    s_add_u32 m0, s73, 55296
    s_nop 0
    buffer_load_dwordx4 v7, s[28:31], s72 offen offset:0 sc1 lds
    buffer_load_dwordx4 v7, s[28:31], s72 offen offset:1024 sc1 lds
    buffer_load_dwordx4 v7, s[28:31], s72 offen offset:2048 sc1 lds
    buffer_load_dwordx4 v7, s[28:31], s72 offen offset:3072 sc1 lds
    s_add_u32 s72, s72, 18432
    s_waitcnt vmcnt(8)
Lp2done_17:
    v_cmp_ne_u32 vcc, s6, v31
    s_cbranch_vccz Lwok_32
    s_mov_b32 s82, 200000
Lpoll_33:
    buffer_load_dword v16, v37, s[28:31], s91 offen sc1
    s_waitcnt vmcnt(0)
    v_cmp_ne_u32 vcc, s6, v16
    s_cbranch_vccz Lpolld_34
    s_mov_b64 exec, vcc
    s_sleep 8
    s_sub_u32 s82, s82, 1
    s_cmp_lg_u32 s82, 0
    s_cbranch_scc1 Lpoll_33
Lpolld_34:
    s_mov_b64 exec, -1
Lwok_32:
    s_barrier
    s_add_u32 s7, s93, s44
    buffer_load_dwordx4 v[40:43], v7, s[28:31], s7 offen offset:0 sc1
    s_add_u32 s7, s94, s44
    buffer_load_dwordx4 v[44:47], v7, s[28:31], s7 offen offset:0 sc1
    s_add_u32 s7, s93, s44
    buffer_load_dwordx4 v[48:51], v7, s[28:31], s7 offen offset:1024 sc1
    s_add_u32 s7, s94, s44
    buffer_load_dwordx4 v[52:55], v7, s[28:31], s7 offen offset:1024 sc1
    s_add_u32 s7, s93, s44
    buffer_load_dwordx4 v[56:59], v7, s[28:31], s7 offen offset:2048 sc1
    s_waitcnt vmcnt(9)
    s_barrier
    s_add_u32 s7, s94, s44
    buffer_load_dwordx4 v[60:63], v7, s[28:31], s7 offen offset:2048 sc1
    s_add_u32 s7, s93, s44
    buffer_load_dwordx4 v[64:67], v7, s[28:31], s7 offen offset:3072 sc1
    s_add_u32 s7, s94, s44
    buffer_load_dwordx4 v[68:71], v7, s[28:31], s7 offen offset:3072 sc1
    s_add_u32 s7, s93, s45
    buffer_load_dwordx4 v[72:75], v7, s[28:31], s7 offen offset:0 sc1
    s_add_u32 s7, s94, s45
    buffer_load_dwordx4 v[76:79], v7, s[28:31], s7 offen offset:0 sc1
    s_waitcnt vmcnt(10)
    s_barrier
    s_add_u32 s7, s93, s45
    buffer_load_dwordx4 v[80:83], v7, s[28:31], s7 offen offset:1024 sc1
    s_add_u32 s7, s94, s45
    buffer_load_dwordx4 v[84:87], v7, s[28:31], s7 offen offset:1024 sc1
    s_add_u32 s7, s93, s45
    buffer_load_dwordx4 v[88:91], v7, s[28:31], s7 offen offset:2048 sc1
    s_add_u32 s7, s94, s45
    buffer_load_dwordx4 v[92:95], v7, s[28:31], s7 offen offset:2048 sc1
    s_add_u32 s7, s93, s45
    buffer_load_dwordx4 v[96:99], v7, s[28:31], s7 offen offset:3072 sc1
    s_add_u32 s7, s94, s45
    buffer_load_dwordx4 v[100:103], v7, s[28:31], s7 offen offset:3072 sc1
    s_add_u32 s7, s93, s46
    buffer_load_dwordx4 v[104:107], v7, s[28:31], s7 offen offset:0 sc1
    s_add_u32 s7, s94, s46
    buffer_load_dwordx4 v[108:111], v7, s[28:31], s7 offen offset:0 sc1
    s_barrier
    s_cmp_eq_u32 s5, 5
    s_cbranch_scc1 Lp3idle_35
    s_barrier
    v_and_b32 v2, 15, v1
    v_mul_u32_u24 v2, 1280, v2
    v_lshrrev_b32 v3, 4, v1
    s_mul_i32 s78, s4, 81920
    s_lshl_b32 s80, s5, 8
    s_add_u32 s78, s78, s80
    s_lshl_b32 s80, s66, 6
    s_add_u32 s78, s78, s80
    v_and_b32 v6, 1, v3
    v_lshlrev_b32 v6, 5, v6
    v_lshrrev_b32 v3, 1, v3
    v_lshl_add_u32 v6, v3, 4, v6
    v_add_u32 v6, v6, v2
    s_mov_b32 s79, 0xffff0000
    v_add_u32 v2, 49152, v7
    v_add_u32 v3, 0x10000, v2
    v_lshlrev_b32 v4, 3, v1
    ds_read_b128 v[8:11], v2 offset:0
    ds_read_b128 v[12:15], v2 offset:1024
    ds_read_b128 v[16:19], v2 offset:9216
    ds_read_b128 v[20:23], v2 offset:10240
    ds_read_b128 v[24:27], v2 offset:2048
    ds_read_b128 v[28:31], v2 offset:3072
    ds_read_b128 v[32:35], v2 offset:11264
    ds_read_b128 v[36:39], v2 offset:12288
    v_lshrrev_b32 v5, 2, v1
    v_lshlrev_b32 v5, 7, v5
    v_and_b32 v224, 3, v1
    v_lshl_add_u32 v5, v224, 3, v5
    s_lshl_b32 s80, s66, 12
    s_add_u32 s80, s80, 16384
    v_add_u32 v5, s80, v5
    s_waitcnt lgkmcnt(4) vmcnt(16)
    v_mfma_f32_16x16x32_bf16 v[224:227], v[40:43], v[8:11], 0
    ds_read_b128 v[208:211], v2 offset:5120
    v_mfma_f32_16x16x32_bf16 v[228:231], v[44:47], v[8:11], 0
    ds_read_b128 v[212:215], v2 offset:6144
    v_mfma_f32_16x16x32_bf16 v[232:235], v[40:43], v[12:15], 0
    ds_read_b128 v[216:219], v2 offset:14336
    v_mfma_f32_16x16x32_bf16 v[236:239], v[44:47], v[12:15], 0
    ds_read_b128 v[220:223], v2 offset:15360
    v_mfma_f32_16x16x32_bf16 v[240:243], v[40:43], v[16:19], 0
    v_mfma_f32_16x16x32_bf16 v[244:247], v[44:47], v[16:19], 0
    v_mfma_f32_16x16x32_bf16 v[248:251], v[40:43], v[20:23], 0
    v_mfma_f32_16x16x32_bf16 v[252:255], v[44:47], v[20:23], 0
    s_add_u32 s7, s93, s46
    buffer_load_dwordx4 v[112:115], v7, s[28:31], s7 offen offset:1024 sc1
    s_waitcnt vmcnt(5)
    s_add_u32 s7, s94, s46
    buffer_load_dwordx4 v[116:119], v7, s[28:31], s7 offen offset:1024 sc1
    s_waitcnt vmcnt(5)
    s_add_u32 s7, s93, s46
    buffer_load_dwordx4 v[120:123], v7, s[28:31], s7 offen offset:2048 sc1
    s_waitcnt vmcnt(5)
    s_add_u32 s7, s94, s46
    buffer_load_dwordx4 v[124:127], v7, s[28:31], s7 offen offset:2048 sc1
    s_waitcnt vmcnt(5)
    s_add_u32 s7, s93, s46
    buffer_load_dwordx4 v[128:131], v7, s[28:31], s7 offen offset:3072 sc1
    s_waitcnt vmcnt(5)
    s_add_u32 s7, s94, s46
    buffer_load_dwordx4 v[132:135], v7, s[28:31], s7 offen offset:3072 sc1
    s_waitcnt vmcnt(5)
    s_waitcnt lgkmcnt(4) vmcnt(20)
    s_nop 0
    v_mfma_f32_16x16x32_bf16 v[224:227], v[48:51], v[24:27], v[224:227]
    ds_read_b128 v[8:11], v2 offset:7168
    v_mfma_f32_16x16x32_bf16 v[228:231], v[52:55], v[24:27], v[228:231]
    ds_read_b128 v[12:15], v2 offset:8192
    v_mfma_f32_16x16x32_bf16 v[232:235], v[48:51], v[28:31], v[232:235]
    ds_read_b128 v[16:19], v2 offset:16384
    v_mfma_f32_16x16x32_bf16 v[236:239], v[52:55], v[28:31], v[236:239]
    ds_read_b128 v[20:23], v2 offset:17408
    v_mfma_f32_16x16x32_bf16 v[240:243], v[48:51], v[32:35], v[240:243]
    v_mfma_f32_16x16x32_bf16 v[244:247], v[52:55], v[32:35], v[244:247]
    v_mfma_f32_16x16x32_bf16 v[248:251], v[48:51], v[36:39], v[248:251]
    v_mfma_f32_16x16x32_bf16 v[252:255], v[52:55], v[36:39], v[252:255]
    s_add_u32 s7, s93, s47
    buffer_load_dwordx4 v[136:139], v7, s[28:31], s7 offen offset:0 sc1
    s_waitcnt vmcnt(5)
    s_add_u32 s7, s94, s47
    buffer_load_dwordx4 v[140:143], v7, s[28:31], s7 offen offset:0 sc1
    s_waitcnt vmcnt(5)
    s_add_u32 s7, s93, s47
    buffer_load_dwordx4 v[144:147], v7, s[28:31], s7 offen offset:1024 sc1
    s_waitcnt vmcnt(5)
    s_add_u32 s7, s94, s47
    buffer_load_dwordx4 v[148:151], v7, s[28:31], s7 offen offset:1024 sc1
    s_waitcnt vmcnt(5)
    s_add_u32 s7, s93, s47
    buffer_load_dwordx4 v[152:155], v7, s[28:31], s7 offen offset:2048 sc1
    s_waitcnt vmcnt(5)
    s_add_u32 s7, s94, s47
    buffer_load_dwordx4 v[156:159], v7, s[28:31], s7 offen offset:2048 sc1
    s_waitcnt vmcnt(5)
    s_waitcnt lgkmcnt(4) vmcnt(24)
    s_nop 0
    v_mfma_f32_16x16x32_bf16 v[224:227], v[56:59], v[208:211], v[224:227]
    v_mfma_f32_16x16x32_bf16 v[228:231], v[60:63], v[208:211], v[228:231]
    v_mfma_f32_16x16x32_bf16 v[232:235], v[56:59], v[212:215], v[232:235]
    v_mfma_f32_16x16x32_bf16 v[236:239], v[60:63], v[212:215], v[236:239]
    v_mfma_f32_16x16x32_bf16 v[240:243], v[56:59], v[216:219], v[240:243]
    v_mfma_f32_16x16x32_bf16 v[244:247], v[60:63], v[216:219], v[244:247]
    v_mfma_f32_16x16x32_bf16 v[248:251], v[56:59], v[220:223], v[248:251]
    v_mfma_f32_16x16x32_bf16 v[252:255], v[60:63], v[220:223], v[252:255]
    s_add_u32 s7, s93, s47
    buffer_load_dwordx4 v[160:163], v7, s[28:31], s7 offen offset:3072 sc1
    s_waitcnt vmcnt(5)
    s_add_u32 s7, s94, s47
    buffer_load_dwordx4 v[164:167], v7, s[28:31], s7 offen offset:3072 sc1
    s_waitcnt vmcnt(5)
    s_add_u32 s7, s93, s48
    buffer_load_dwordx4 v[168:171], v7, s[28:31], s7 offen offset:0 sc1
    s_waitcnt vmcnt(5)
    s_add_u32 s7, s94, s48
    buffer_load_dwordx4 v[172:175], v7, s[28:31], s7 offen offset:0 sc1
    s_waitcnt vmcnt(5)
    s_add_u32 s7, s93, s48
    buffer_load_dwordx4 v[176:179], v7, s[28:31], s7 offen offset:1024 sc1
    s_waitcnt vmcnt(5)
    s_add_u32 s7, s94, s48
    buffer_load_dwordx4 v[180:183], v7, s[28:31], s7 offen offset:1024 sc1
    s_waitcnt vmcnt(5)
    s_waitcnt lgkmcnt(0) vmcnt(28)
    s_nop 0
    v_mfma_f32_16x16x32_bf16 v[224:227], v[64:67], v[8:11], v[224:227]
    v_mfma_f32_16x16x32_bf16 v[228:231], v[68:71], v[8:11], v[228:231]
    v_mfma_f32_16x16x32_bf16 v[232:235], v[64:67], v[12:15], v[232:235]
    v_mfma_f32_16x16x32_bf16 v[236:239], v[68:71], v[12:15], v[236:239]
    v_mfma_f32_16x16x32_bf16 v[240:243], v[64:67], v[16:19], v[240:243]
    v_mfma_f32_16x16x32_bf16 v[244:247], v[68:71], v[16:19], v[244:247]
    v_mfma_f32_16x16x32_bf16 v[248:251], v[64:67], v[20:23], v[248:251]
    v_mfma_f32_16x16x32_bf16 v[252:255], v[68:71], v[20:23], v[252:255]
    s_add_u32 s7, s93, s48
    buffer_load_dwordx4 v[184:187], v7, s[28:31], s7 offen offset:2048 sc1
    s_waitcnt vmcnt(5)
    s_add_u32 s7, s94, s48
    buffer_load_dwordx4 v[188:191], v7, s[28:31], s7 offen offset:2048 sc1
    s_waitcnt vmcnt(5)
    s_add_u32 s7, s93, s48
    buffer_load_dwordx4 v[192:195], v7, s[28:31], s7 offen offset:3072 sc1
    s_waitcnt vmcnt(5)
    s_add_u32 s7, s94, s48
    buffer_load_dwordx4 v[196:199], v7, s[28:31], s7 offen offset:3072 sc1
    s_waitcnt vmcnt(5)
    s_add_u32 s7, s93, s49
    buffer_load_dwordx4 v[200:203], v7, s[28:31], s7 offen offset:0 sc1
    s_waitcnt vmcnt(5)
    s_add_u32 s7, s94, s49
    buffer_load_dwordx4 v[204:207], v7, s[28:31], s7 offen offset:0 sc1
    s_waitcnt vmcnt(5)
    s_barrier
    s_nop 0
    ds_read_b128 v[24:27], v2 offset:18432
    ds_read_b128 v[28:31], v2 offset:19456
    ds_read_b128 v[32:35], v2 offset:27648
    ds_read_b128 v[36:39], v2 offset:28672
    ds_read_b128 v[208:211], v2 offset:20480
    ds_read_b128 v[212:215], v2 offset:21504
    ds_read_b128 v[216:219], v2 offset:29696
    ds_read_b128 v[220:223], v2 offset:30720
    s_waitcnt lgkmcnt(4) vmcnt(32)
    s_nop 0
    v_mfma_f32_16x16x32_bf16 v[224:227], v[72:75], v[24:27], v[224:227]
    ds_read_b128 v[8:11], v2 offset:23552
    v_mfma_f32_16x16x32_bf16 v[228:231], v[76:79], v[24:27], v[228:231]
    ds_read_b128 v[12:15], v2 offset:24576
    v_mfma_f32_16x16x32_bf16 v[232:235], v[72:75], v[28:31], v[232:235]
    ds_read_b128 v[16:19], v2 offset:32768
    v_mfma_f32_16x16x32_bf16 v[236:239], v[76:79], v[28:31], v[236:239]
    ds_read_b128 v[20:23], v2 offset:33792
    v_mfma_f32_16x16x32_bf16 v[240:243], v[72:75], v[32:35], v[240:243]
    v_mfma_f32_16x16x32_bf16 v[244:247], v[76:79], v[32:35], v[244:247]
    v_mfma_f32_16x16x32_bf16 v[248:251], v[72:75], v[36:39], v[248:251]
    v_mfma_f32_16x16x32_bf16 v[252:255], v[76:79], v[36:39], v[252:255]
    s_add_u32 s7, s93, s49
    buffer_load_dwordx4 v[40:43], v7, s[28:31], s7 offen offset:1024 sc1
    s_add_u32 s7, s94, s49
    buffer_load_dwordx4 v[44:47], v7, s[28:31], s7 offen offset:1024 sc1
    s_add_u32 s7, s93, s49
    buffer_load_dwordx4 v[48:51], v7, s[28:31], s7 offen offset:2048 sc1
    s_add_u32 s7, s94, s49
    buffer_load_dwordx4 v[52:55], v7, s[28:31], s7 offen offset:2048 sc1
    s_waitcnt lgkmcnt(4) vmcnt(34)
    s_nop 0
    v_mfma_f32_16x16x32_bf16 v[224:227], v[80:83], v[208:211], v[224:227]
    ds_read_b128 v[24:27], v2 offset:25600
    v_mfma_f32_16x16x32_bf16 v[228:231], v[84:87], v[208:211], v[228:231]
    ds_read_b128 v[28:31], v2 offset:26624
    v_mfma_f32_16x16x32_bf16 v[232:235], v[80:83], v[212:215], v[232:235]
    ds_read_b128 v[32:35], v2 offset:34816
    v_mfma_f32_16x16x32_bf16 v[236:239], v[84:87], v[212:215], v[236:239]
    ds_read_b128 v[36:39], v2 offset:35840
    v_mfma_f32_16x16x32_bf16 v[240:243], v[80:83], v[216:219], v[240:243]
    v_mfma_f32_16x16x32_bf16 v[244:247], v[84:87], v[216:219], v[244:247]
    v_mfma_f32_16x16x32_bf16 v[248:251], v[80:83], v[220:223], v[248:251]
    v_mfma_f32_16x16x32_bf16 v[252:255], v[84:87], v[220:223], v[252:255]
    s_add_u32 s7, s93, s49
    buffer_load_dwordx4 v[56:59], v7, s[28:31], s7 offen offset:3072 sc1
    s_add_u32 s7, s94, s49
    buffer_load_dwordx4 v[60:63], v7, s[28:31], s7 offen offset:3072 sc1
    s_add_u32 s7, s93, 24576
    buffer_load_dwordx4 v[64:67], v7, s[28:31], s7 offen offset:0 sc1
    s_add_u32 s7, s94, 24576
    buffer_load_dwordx4 v[68:71], v7, s[28:31], s7 offen offset:0 sc1
    s_waitcnt lgkmcnt(4) vmcnt(36)
    s_nop 0
    v_mfma_f32_16x16x32_bf16 v[224:227], v[88:91], v[8:11], v[224:227]
    ds_read_b128 v[208:211], v2 offset:36864
    v_mfma_f32_16x16x32_bf16 v[228:231], v[92:95], v[8:11], v[228:231]
    ds_read_b128 v[212:215], v2 offset:37888
    v_mfma_f32_16x16x32_bf16 v[232:235], v[88:91], v[12:15], v[232:235]
    ds_read_b128 v[216:219], v2 offset:46080
    v_mfma_f32_16x16x32_bf16 v[236:239], v[92:95], v[12:15], v[236:239]
    ds_read_b128 v[220:223], v2 offset:47104
    v_mfma_f32_16x16x32_bf16 v[240:243], v[88:91], v[16:19], v[240:243]
    v_mfma_f32_16x16x32_bf16 v[244:247], v[92:95], v[16:19], v[244:247]
    v_mfma_f32_16x16x32_bf16 v[248:251], v[88:91], v[20:23], v[248:251]
    v_mfma_f32_16x16x32_bf16 v[252:255], v[92:95], v[20:23], v[252:255]
    s_add_u32 s7, s93, 24576
    buffer_load_dwordx4 v[72:75], v7, s[28:31], s7 offen offset:1024 sc1
    s_add_u32 s7, s94, 24576
    buffer_load_dwordx4 v[76:79], v7, s[28:31], s7 offen offset:1024 sc1
    s_add_u32 s7, s93, 24576
    buffer_load_dwordx4 v[80:83], v7, s[28:31], s7 offen offset:2048 sc1
    s_add_u32 s7, s94, 24576
    buffer_load_dwordx4 v[84:87], v7, s[28:31], s7 offen offset:2048 sc1
    s_waitcnt lgkmcnt(4) vmcnt(38)
    s_nop 0
    v_mfma_f32_16x16x32_bf16 v[224:227], v[96:99], v[24:27], v[224:227]
    ds_read_b128 v[8:11], v2 offset:38912
    v_mfma_f32_16x16x32_bf16 v[228:231], v[100:103], v[24:27], v[228:231]
    ds_read_b128 v[12:15], v2 offset:39936
    v_mfma_f32_16x16x32_bf16 v[232:235], v[96:99], v[28:31], v[232:235]
    ds_read_b128 v[16:19], v2 offset:48128
    v_mfma_f32_16x16x32_bf16 v[236:239], v[100:103], v[28:31], v[236:239]
    ds_read_b128 v[20:23], v2 offset:49152
    v_mfma_f32_16x16x32_bf16 v[240:243], v[96:99], v[32:35], v[240:243]
    v_mfma_f32_16x16x32_bf16 v[244:247], v[100:103], v[32:35], v[244:247]
    v_mfma_f32_16x16x32_bf16 v[248:251], v[96:99], v[36:39], v[248:251]
    v_mfma_f32_16x16x32_bf16 v[252:255], v[100:103], v[36:39], v[252:255]
    s_waitcnt lgkmcnt(4) vmcnt(36)
    s_nop 0
    v_mfma_f32_16x16x32_bf16 v[224:227], v[104:107], v[208:211], v[224:227]
    ds_read_b128 v[24:27], v2 offset:41984
    v_mfma_f32_16x16x32_bf16 v[228:231], v[108:111], v[208:211], v[228:231]
    ds_read_b128 v[28:31], v2 offset:43008
    v_mfma_f32_16x16x32_bf16 v[232:235], v[104:107], v[212:215], v[232:235]
    ds_read_b128 v[32:35], v2 offset:51200
    v_mfma_f32_16x16x32_bf16 v[236:239], v[108:111], v[212:215], v[236:239]
    ds_read_b128 v[36:39], v2 offset:52224
    v_mfma_f32_16x16x32_bf16 v[240:243], v[104:107], v[216:219], v[240:243]
    v_mfma_f32_16x16x32_bf16 v[244:247], v[108:111], v[216:219], v[244:247]
    v_mfma_f32_16x16x32_bf16 v[248:251], v[104:107], v[220:223], v[248:251]
    v_mfma_f32_16x16x32_bf16 v[252:255], v[108:111], v[220:223], v[252:255]
    s_waitcnt lgkmcnt(4) vmcnt(34)
    s_nop 0
    v_mfma_f32_16x16x32_bf16 v[224:227], v[112:115], v[8:11], v[224:227]
    ds_read_b128 v[208:211], v2 offset:44032
    v_mfma_f32_16x16x32_bf16 v[228:231], v[116:119], v[8:11], v[228:231]
    ds_read_b128 v[212:215], v2 offset:45056
    v_mfma_f32_16x16x32_bf16 v[232:235], v[112:115], v[12:15], v[232:235]
    ds_read_b128 v[216:219], v2 offset:53248
    v_mfma_f32_16x16x32_bf16 v[236:239], v[116:119], v[12:15], v[236:239]
    ds_read_b128 v[220:223], v2 offset:54272
    v_mfma_f32_16x16x32_bf16 v[240:243], v[112:115], v[16:19], v[240:243]
    v_mfma_f32_16x16x32_bf16 v[244:247], v[116:119], v[16:19], v[244:247]
    v_mfma_f32_16x16x32_bf16 v[248:251], v[112:115], v[20:23], v[248:251]
    v_mfma_f32_16x16x32_bf16 v[252:255], v[116:119], v[20:23], v[252:255]
    s_barrier
    s_waitcnt lgkmcnt(4) vmcnt(32)
    v_mfma_f32_16x16x32_bf16 v[224:227], v[120:123], v[24:27], v[224:227]
    ds_read_b128 v[8:11], v2 offset:55296
    v_mfma_f32_16x16x32_bf16 v[228:231], v[124:127], v[24:27], v[228:231]
    ds_read_b128 v[12:15], v2 offset:56320
    v_mfma_f32_16x16x32_bf16 v[232:235], v[120:123], v[28:31], v[232:235]
    ds_read_b128 v[16:19], v2 offset:64512
    v_mfma_f32_16x16x32_bf16 v[236:239], v[124:127], v[28:31], v[236:239]
    ds_read_b128 v[20:23], v3 offset:0
    v_mfma_f32_16x16x32_bf16 v[240:243], v[120:123], v[32:35], v[240:243]
    v_mfma_f32_16x16x32_bf16 v[244:247], v[124:127], v[32:35], v[244:247]
    v_mfma_f32_16x16x32_bf16 v[248:251], v[120:123], v[36:39], v[248:251]
    v_mfma_f32_16x16x32_bf16 v[252:255], v[124:127], v[36:39], v[252:255]
    s_waitcnt lgkmcnt(4) vmcnt(30)
    s_nop 0
    v_mfma_f32_16x16x32_bf16 v[224:227], v[128:131], v[208:211], v[224:227]
    ds_read_b128 v[24:27], v2 offset:57344
    v_mfma_f32_16x16x32_bf16 v[228:231], v[132:135], v[208:211], v[228:231]
    ds_read_b128 v[28:31], v2 offset:58368
    v_mfma_f32_16x16x32_bf16 v[232:235], v[128:131], v[212:215], v[232:235]
    ds_read_b128 v[32:35], v3 offset:1024
    v_mfma_f32_16x16x32_bf16 v[236:239], v[132:135], v[212:215], v[236:239]
    ds_read_b128 v[36:39], v3 offset:2048
    v_mfma_f32_16x16x32_bf16 v[240:243], v[128:131], v[216:219], v[240:243]
    v_mfma_f32_16x16x32_bf16 v[244:247], v[132:135], v[216:219], v[244:247]
    v_mfma_f32_16x16x32_bf16 v[248:251], v[128:131], v[220:223], v[248:251]
    v_mfma_f32_16x16x32_bf16 v[252:255], v[132:135], v[220:223], v[252:255]
    v_and_b32 v122, 15, v1
    v_lshrrev_b32 v123, 5, v1
    s_lshl_b32 s80, s66, 2
    v_add_u32 v123, s80, v123
    v_xor_b32 v123, v123, v122
    v_lshlrev_b32 v123, 4, v123
    v_lshl_add_u32 v120, v122, 8, v123
    v_bfe_u32 v123, v1, 4, 1
    v_lshl_add_u32 v120, v123, 3, v120
    v_add_u32 v120, 32768, v120
    v_xor_b32 v121, 32, v120
    s_waitcnt lgkmcnt(4) vmcnt(28)
    v_mfma_f32_16x16x32_bf16 v[224:227], v[136:139], v[8:11], v[224:227]
    ds_read_b128 v[208:211], v2 offset:60416
    v_mfma_f32_16x16x32_bf16 v[228:231], v[140:143], v[8:11], v[228:231]
    ds_read_b128 v[212:215], v2 offset:61440
    v_mfma_f32_16x16x32_bf16 v[232:235], v[136:139], v[12:15], v[232:235]
    ds_read_b128 v[216:219], v3 offset:4096
    v_mfma_f32_16x16x32_bf16 v[236:239], v[140:143], v[12:15], v[236:239]
    ds_read_b128 v[220:223], v3 offset:5120
    v_mfma_f32_16x16x32_bf16 v[240:243], v[136:139], v[16:19], v[240:243]
    v_mfma_f32_16x16x32_bf16 v[244:247], v[140:143], v[16:19], v[244:247]
    v_mfma_f32_16x16x32_bf16 v[248:251], v[136:139], v[20:23], v[248:251]
    v_mfma_f32_16x16x32_bf16 v[252:255], v[140:143], v[20:23], v[252:255]
    s_waitcnt lgkmcnt(4) vmcnt(26)
    s_nop 0
    v_mfma_f32_16x16x32_bf16 v[224:227], v[144:147], v[24:27], v[224:227]
    ds_read_b128 v[8:11], v2 offset:62464
    v_mfma_f32_16x16x32_bf16 v[228:231], v[148:151], v[24:27], v[228:231]
    ds_read_b128 v[12:15], v2 offset:63488
    v_mfma_f32_16x16x32_bf16 v[232:235], v[144:147], v[28:31], v[232:235]
    ds_read_b128 v[16:19], v3 offset:6144
    v_mfma_f32_16x16x32_bf16 v[236:239], v[148:151], v[28:31], v[236:239]
    ds_read_b128 v[20:23], v3 offset:7168
    v_mfma_f32_16x16x32_bf16 v[240:243], v[144:147], v[32:35], v[240:243]
    v_mfma_f32_16x16x32_bf16 v[244:247], v[148:151], v[32:35], v[244:247]
    v_mfma_f32_16x16x32_bf16 v[248:251], v[144:147], v[36:39], v[248:251]
    v_mfma_f32_16x16x32_bf16 v[252:255], v[148:151], v[36:39], v[252:255]
    s_barrier
    s_waitcnt lgkmcnt(4) vmcnt(24)
    v_mfma_f32_16x16x32_bf16 v[224:227], v[152:155], v[208:211], v[224:227]
    ds_read_b128 v[24:27], v3 offset:8192
    v_mfma_f32_16x16x32_bf16 v[228:231], v[156:159], v[208:211], v[228:231]
    ds_read_b128 v[28:31], v3 offset:9216
    v_mfma_f32_16x16x32_bf16 v[232:235], v[152:155], v[212:215], v[232:235]
    ds_read_b128 v[32:35], v3 offset:17408
    v_mfma_f32_16x16x32_bf16 v[236:239], v[156:159], v[212:215], v[236:239]
    ds_read_b128 v[36:39], v3 offset:18432
    v_mfma_f32_16x16x32_bf16 v[240:243], v[152:155], v[216:219], v[240:243]
    v_mfma_f32_16x16x32_bf16 v[244:247], v[156:159], v[216:219], v[244:247]
    v_mfma_f32_16x16x32_bf16 v[248:251], v[152:155], v[220:223], v[248:251]
    v_mfma_f32_16x16x32_bf16 v[252:255], v[156:159], v[220:223], v[252:255]
    s_waitcnt lgkmcnt(4) vmcnt(22)
    s_nop 0
    v_mfma_f32_16x16x32_bf16 v[224:227], v[160:163], v[8:11], v[224:227]
    ds_read_b128 v[208:211], v3 offset:10240
    v_mfma_f32_16x16x32_bf16 v[228:231], v[164:167], v[8:11], v[228:231]
    ds_read_b128 v[212:215], v3 offset:11264
    v_mfma_f32_16x16x32_bf16 v[232:235], v[160:163], v[12:15], v[232:235]
    ds_read_b128 v[216:219], v3 offset:19456
    v_mfma_f32_16x16x32_bf16 v[236:239], v[164:167], v[12:15], v[236:239]
    ds_read_b128 v[220:223], v3 offset:20480
    v_mfma_f32_16x16x32_bf16 v[240:243], v[160:163], v[16:19], v[240:243]
    v_mfma_f32_16x16x32_bf16 v[244:247], v[164:167], v[16:19], v[244:247]
    v_mfma_f32_16x16x32_bf16 v[248:251], v[160:163], v[20:23], v[248:251]
    v_mfma_f32_16x16x32_bf16 v[252:255], v[164:167], v[20:23], v[252:255]
    s_waitcnt lgkmcnt(4) vmcnt(20)
    s_nop 0
    v_mfma_f32_16x16x32_bf16 v[224:227], v[168:171], v[24:27], v[224:227]
    ds_read_b128 v[8:11], v3 offset:13312
    v_mfma_f32_16x16x32_bf16 v[228:231], v[172:175], v[24:27], v[228:231]
    ds_read_b128 v[12:15], v3 offset:14336
    v_mfma_f32_16x16x32_bf16 v[232:235], v[168:171], v[28:31], v[232:235]
    ds_read_b128 v[16:19], v3 offset:22528
    v_mfma_f32_16x16x32_bf16 v[236:239], v[172:175], v[28:31], v[236:239]
    ds_read_b128 v[20:23], v3 offset:23552
    v_mfma_f32_16x16x32_bf16 v[240:243], v[168:171], v[32:35], v[240:243]
    v_mfma_f32_16x16x32_bf16 v[244:247], v[172:175], v[32:35], v[244:247]
    v_mfma_f32_16x16x32_bf16 v[248:251], v[168:171], v[36:39], v[248:251]
    v_mfma_f32_16x16x32_bf16 v[252:255], v[172:175], v[36:39], v[252:255]
    s_waitcnt lgkmcnt(4) vmcnt(18)
    s_nop 0
    v_mfma_f32_16x16x32_bf16 v[224:227], v[176:179], v[208:211], v[224:227]
    ds_read_b128 v[24:27], v3 offset:15360
    v_mfma_f32_16x16x32_bf16 v[228:231], v[180:183], v[208:211], v[228:231]
    ds_read_b128 v[28:31], v3 offset:16384
    v_mfma_f32_16x16x32_bf16 v[232:235], v[176:179], v[212:215], v[232:235]
    ds_read_b128 v[32:35], v3 offset:24576
    v_mfma_f32_16x16x32_bf16 v[236:239], v[180:183], v[212:215], v[236:239]
    ds_read_b128 v[36:39], v3 offset:25600
    v_mfma_f32_16x16x32_bf16 v[240:243], v[176:179], v[216:219], v[240:243]
    v_mfma_f32_16x16x32_bf16 v[244:247], v[180:183], v[216:219], v[244:247]
    v_mfma_f32_16x16x32_bf16 v[248:251], v[176:179], v[220:223], v[248:251]
    v_mfma_f32_16x16x32_bf16 v[252:255], v[180:183], v[220:223], v[252:255]
    s_barrier
    s_waitcnt lgkmcnt(4) vmcnt(16)
    v_mfma_f32_16x16x32_bf16 v[224:227], v[184:187], v[8:11], v[224:227]
    ds_read_b128 v[208:211], v3 offset:26624
    v_mfma_f32_16x16x32_bf16 v[228:231], v[188:191], v[8:11], v[228:231]
    ds_read_b128 v[212:215], v3 offset:27648
    v_mfma_f32_16x16x32_bf16 v[232:235], v[184:187], v[12:15], v[232:235]
    ds_read_b128 v[216:219], v3 offset:35840
    v_mfma_f32_16x16x32_bf16 v[236:239], v[188:191], v[12:15], v[236:239]
    ds_read_b128 v[220:223], v3 offset:36864
    v_mfma_f32_16x16x32_bf16 v[240:243], v[184:187], v[16:19], v[240:243]
    v_mfma_f32_16x16x32_bf16 v[244:247], v[188:191], v[16:19], v[244:247]
    v_mfma_f32_16x16x32_bf16 v[248:251], v[184:187], v[20:23], v[248:251]
    v_mfma_f32_16x16x32_bf16 v[252:255], v[188:191], v[20:23], v[252:255]
    s_waitcnt lgkmcnt(4) vmcnt(14)
    s_nop 0
    v_mfma_f32_16x16x32_bf16 v[224:227], v[192:195], v[24:27], v[224:227]
    ds_read_b128 v[8:11], v3 offset:28672
    v_mfma_f32_16x16x32_bf16 v[228:231], v[196:199], v[24:27], v[228:231]
    ds_read_b128 v[12:15], v3 offset:29696
    v_mfma_f32_16x16x32_bf16 v[232:235], v[192:195], v[28:31], v[232:235]
    ds_read_b128 v[16:19], v3 offset:37888
    v_mfma_f32_16x16x32_bf16 v[236:239], v[196:199], v[28:31], v[236:239]
    ds_read_b128 v[20:23], v3 offset:38912
    v_mfma_f32_16x16x32_bf16 v[240:243], v[192:195], v[32:35], v[240:243]
    v_mfma_f32_16x16x32_bf16 v[244:247], v[196:199], v[32:35], v[244:247]
    v_mfma_f32_16x16x32_bf16 v[248:251], v[192:195], v[36:39], v[248:251]
    v_mfma_f32_16x16x32_bf16 v[252:255], v[196:199], v[36:39], v[252:255]
    s_waitcnt lgkmcnt(4) vmcnt(12)
    s_nop 0
    v_mfma_f32_16x16x32_bf16 v[224:227], v[200:203], v[208:211], v[224:227]
    ds_read_b128 v[24:27], v3 offset:31744
    v_mfma_f32_16x16x32_bf16 v[228:231], v[204:207], v[208:211], v[228:231]
    ds_read_b128 v[28:31], v3 offset:32768
    v_mfma_f32_16x16x32_bf16 v[232:235], v[200:203], v[212:215], v[232:235]
    ds_read_b128 v[32:35], v3 offset:40960
    v_mfma_f32_16x16x32_bf16 v[236:239], v[204:207], v[212:215], v[236:239]
    ds_read_b128 v[36:39], v3 offset:41984
    v_mfma_f32_16x16x32_bf16 v[240:243], v[200:203], v[216:219], v[240:243]
    v_mfma_f32_16x16x32_bf16 v[244:247], v[204:207], v[216:219], v[244:247]
    v_mfma_f32_16x16x32_bf16 v[248:251], v[200:203], v[220:223], v[248:251]
    v_mfma_f32_16x16x32_bf16 v[252:255], v[204:207], v[220:223], v[252:255]
    ds_read_b64 v[88:89], v120 offset:0
    ds_read_b64 v[90:91], v121 offset:0
    ds_read_b64 v[92:93], v120 offset:4096
    ds_read_b64 v[94:95], v121 offset:4096
    ds_read_b64 v[96:97], v120 offset:8192
    ds_read_b64 v[98:99], v121 offset:8192
    ds_read_b64 v[100:101], v120 offset:12288
    ds_read_b64 v[102:103], v121 offset:12288
    s_waitcnt lgkmcnt(12) vmcnt(10)
    s_nop 0
    v_mfma_f32_16x16x32_bf16 v[224:227], v[40:43], v[8:11], v[224:227]
    ds_read_b128 v[208:211], v3 offset:33792
    v_mfma_f32_16x16x32_bf16 v[228:231], v[44:47], v[8:11], v[228:231]
    ds_read_b128 v[212:215], v3 offset:34816
    v_mfma_f32_16x16x32_bf16 v[232:235], v[40:43], v[12:15], v[232:235]
    ds_read_b128 v[216:219], v3 offset:43008
    v_mfma_f32_16x16x32_bf16 v[236:239], v[44:47], v[12:15], v[236:239]
    ds_read_b128 v[220:223], v3 offset:44032
    v_mfma_f32_16x16x32_bf16 v[240:243], v[40:43], v[16:19], v[240:243]
    v_mfma_f32_16x16x32_bf16 v[244:247], v[44:47], v[16:19], v[244:247]
    v_mfma_f32_16x16x32_bf16 v[248:251], v[40:43], v[20:23], v[248:251]
    v_mfma_f32_16x16x32_bf16 v[252:255], v[44:47], v[20:23], v[252:255]
    ds_read_b64_tr_b16 v[104:105], v5 offset:0
    ds_read_b64_tr_b16 v[106:107], v5 offset:2048
    ds_read_b64_tr_b16 v[108:109], v5 offset:32
    ds_read_b64_tr_b16 v[110:111], v5 offset:2080
    ds_read_b64_tr_b16 v[112:113], v5 offset:64
    ds_read_b64_tr_b16 v[114:115], v5 offset:2112
    ds_read_b64_tr_b16 v[116:117], v5 offset:96
    ds_read_b64_tr_b16 v[118:119], v5 offset:2144
    s_waitcnt lgkmcnt(12) vmcnt(8)
    v_mfma_f32_16x16x32_bf16 v[224:227], v[48:51], v[24:27], v[224:227]
    s_bfe_u32 s7, s50, 262144
    s_mul_i32 s7, s7, 18432
    s_add_u32 s7, s7, 53248
    v_add_u32 v2, s7, v4
    ds_read_b64 v[8:9], v2 offset:0
    v_mfma_f32_16x16x32_bf16 v[228:231], v[52:55], v[24:27], v[228:231]
    ds_read_b64 v[12:13], v2 offset:512
    v_mfma_f32_16x16x32_bf16 v[232:235], v[48:51], v[28:31], v[232:235]
    ds_read_b64 v[16:17], v2 offset:9216
    v_mfma_f32_16x16x32_bf16 v[236:239], v[52:55], v[28:31], v[236:239]
    ds_read_b64 v[20:21], v2 offset:9728
    v_mfma_f32_16x16x32_bf16 v[240:243], v[48:51], v[32:35], v[240:243]
    s_bfe_u32 s7, s50, 262148
    s_mul_i32 s7, s7, 18432
    s_add_u32 s7, s7, 53248
    v_add_u32_e64 v3, s7, v4
    ds_read_b64 v[10:11], v3 offset:0
    v_mfma_f32_16x16x32_bf16 v[244:247], v[52:55], v[32:35], v[244:247]
    ds_read_b64 v[14:15], v3 offset:512
    v_mfma_f32_16x16x32_bf16 v[248:251], v[48:51], v[36:39], v[248:251]
    ds_read_b64 v[18:19], v3 offset:9216
    v_mfma_f32_16x16x32_bf16 v[252:255], v[52:55], v[36:39], v[252:255]
    ds_read_b64 v[22:23], v3 offset:9728
    s_waitcnt lgkmcnt(8) vmcnt(6)
    v_mfma_f32_16x16x32_bf16 v[224:227], v[56:59], v[208:211], v[224:227]
    s_bfe_u32 s7, s50, 262152
    s_mul_i32 s7, s7, 18432
    s_add_u32 s7, s7, 53248
    v_add_u32 v2, s7, v4
    ds_read_b64 v[24:25], v2 offset:0
    ds_read_b64 v[28:29], v2 offset:512
    v_mfma_f32_16x16x32_bf16 v[228:231], v[60:63], v[208:211], v[228:231]
    ds_read_b64 v[32:33], v2 offset:9216
    ds_read_b64 v[36:37], v2 offset:9728
    v_mfma_f32_16x16x32_bf16 v[232:235], v[56:59], v[212:215], v[232:235]
    s_bfe_u32 s7, s50, 262156
    s_mul_i32 s7, s7, 18432
    s_add_u32 s7, s7, 53248
    v_add_u32_e64 v3, s7, v4
    ds_read_b64 v[26:27], v3 offset:0
    ds_read_b64 v[30:31], v3 offset:512
    v_mfma_f32_16x16x32_bf16 v[236:239], v[60:63], v[212:215], v[236:239]
    ds_read_b64 v[34:35], v3 offset:9216
    ds_read_b64 v[38:39], v3 offset:9728
    v_mfma_f32_16x16x32_bf16 v[240:243], v[56:59], v[216:219], v[240:243]
    v_lshlrev_b32 v128, 16, v88
    v_and_b32 v129, s79, v88
    v_lshlrev_b32 v124, 16, v104
    v_and_b32 v125, s79, v104
    v_pk_add_f32 v[128:129], v[128:129], v[124:125]
    v_mfma_f32_16x16x32_bf16 v[244:247], v[60:63], v[216:219], v[244:247]
    v_lshlrev_b32 v130, 16, v89
    v_and_b32 v131, s79, v89
    v_lshlrev_b32 v126, 16, v105
    v_and_b32 v127, s79, v105
    v_pk_add_f32 v[130:131], v[130:131], v[126:127]
    v_mfma_f32_16x16x32_bf16 v[248:251], v[56:59], v[220:223], v[248:251]
    v_lshlrev_b32 v132, 16, v90
    v_and_b32 v133, s79, v90
    v_lshlrev_b32 v124, 16, v106
    v_and_b32 v125, s79, v106
    v_pk_add_f32 v[132:133], v[132:133], v[124:125]
    v_mfma_f32_16x16x32_bf16 v[252:255], v[60:63], v[220:223], v[252:255]
    v_lshlrev_b32 v134, 16, v91
    v_and_b32 v135, s79, v91
    v_lshlrev_b32 v126, 16, v107
    v_and_b32 v127, s79, v107
    v_pk_add_f32 v[134:135], v[134:135], v[126:127]
    s_waitcnt lgkmcnt(8) vmcnt(4)
    v_mfma_f32_16x16x32_bf16 v[224:227], v[64:67], v[8:11], v[224:227]
    s_bfe_u32 s7, s50, 262160
    s_mul_i32 s7, s7, 18432
    s_add_u32 s7, s7, 53248
    v_add_u32 v2, s7, v4
    ds_read_b64 v[208:209], v2 offset:0
    ds_read_b64 v[212:213], v2 offset:512
    v_mfma_f32_16x16x32_bf16 v[228:231], v[68:71], v[8:11], v[228:231]
    ds_read_b64 v[216:217], v2 offset:9216
    ds_read_b64 v[220:221], v2 offset:9728
    v_mfma_f32_16x16x32_bf16 v[232:235], v[64:67], v[12:15], v[232:235]
    s_bfe_u32 s7, s50, 262164
    s_mul_i32 s7, s7, 18432
    s_add_u32 s7, s7, 53248
    v_add_u32_e64 v3, s7, v4
    ds_read_b64 v[210:211], v3 offset:0
    ds_read_b64 v[214:215], v3 offset:512
    v_mfma_f32_16x16x32_bf16 v[236:239], v[68:71], v[12:15], v[236:239]
    ds_read_b64 v[218:219], v3 offset:9216
    ds_read_b64 v[222:223], v3 offset:9728
    v_mfma_f32_16x16x32_bf16 v[240:243], v[64:67], v[16:19], v[240:243]
    v_lshlrev_b32 v136, 16, v92
    v_and_b32 v137, s79, v92
    v_lshlrev_b32 v124, 16, v108
    v_and_b32 v125, s79, v108
    v_pk_add_f32 v[136:137], v[136:137], v[124:125]
    v_mfma_f32_16x16x32_bf16 v[244:247], v[68:71], v[16:19], v[244:247]
    v_lshlrev_b32 v138, 16, v93
    v_and_b32 v139, s79, v93
    v_lshlrev_b32 v126, 16, v109
    v_and_b32 v127, s79, v109
    v_pk_add_f32 v[138:139], v[138:139], v[126:127]
    v_mfma_f32_16x16x32_bf16 v[248:251], v[64:67], v[20:23], v[248:251]
    v_lshlrev_b32 v140, 16, v94
    v_and_b32 v141, s79, v94
    v_lshlrev_b32 v124, 16, v110
    v_and_b32 v125, s79, v110
    v_pk_add_f32 v[140:141], v[140:141], v[124:125]
    v_mfma_f32_16x16x32_bf16 v[252:255], v[68:71], v[20:23], v[252:255]
    v_lshlrev_b32 v142, 16, v95
    v_and_b32 v143, s79, v95
    v_lshlrev_b32 v126, 16, v111
    v_and_b32 v127, s79, v111
    v_pk_add_f32 v[142:143], v[142:143], v[126:127]
    s_waitcnt lgkmcnt(8) vmcnt(2)
    v_mfma_f32_16x16x32_bf16 v[224:227], v[72:75], v[24:27], v[224:227]
    v_lshlrev_b32 v144, 16, v96
    v_and_b32 v145, s79, v96
    v_mfma_f32_16x16x32_bf16 v[228:231], v[76:79], v[24:27], v[228:231]
    v_lshlrev_b32 v124, 16, v112
    v_and_b32 v125, s79, v112
    v_pk_add_f32 v[144:145], v[144:145], v[124:125]
    v_mfma_f32_16x16x32_bf16 v[232:235], v[72:75], v[28:31], v[232:235]
    v_lshlrev_b32 v146, 16, v97
    v_and_b32 v147, s79, v97
    v_mfma_f32_16x16x32_bf16 v[236:239], v[76:79], v[28:31], v[236:239]
    v_lshlrev_b32 v126, 16, v113
    v_and_b32 v127, s79, v113
    v_pk_add_f32 v[146:147], v[146:147], v[126:127]
    v_mfma_f32_16x16x32_bf16 v[240:243], v[72:75], v[32:35], v[240:243]
    v_lshlrev_b32 v148, 16, v98
    v_and_b32 v149, s79, v98
    v_mfma_f32_16x16x32_bf16 v[244:247], v[76:79], v[32:35], v[244:247]
    v_lshlrev_b32 v124, 16, v114
    v_and_b32 v125, s79, v114
    v_pk_add_f32 v[148:149], v[148:149], v[124:125]
    v_mfma_f32_16x16x32_bf16 v[248:251], v[72:75], v[36:39], v[248:251]
    v_lshlrev_b32 v150, 16, v99
    v_and_b32 v151, s79, v99
    v_mfma_f32_16x16x32_bf16 v[252:255], v[76:79], v[36:39], v[252:255]
    v_lshlrev_b32 v126, 16, v115
    v_and_b32 v127, s79, v115
    v_pk_add_f32 v[150:151], v[150:151], v[126:127]
    s_waitcnt lgkmcnt(0) vmcnt(0)
    v_mfma_f32_16x16x32_bf16 v[224:227], v[80:83], v[208:211], v[224:227]
    v_lshlrev_b32 v152, 16, v100
    v_and_b32 v153, s79, v100
    v_mfma_f32_16x16x32_bf16 v[228:231], v[84:87], v[208:211], v[228:231]
    v_lshlrev_b32 v124, 16, v116
    v_and_b32 v125, s79, v116
    v_pk_add_f32 v[152:153], v[152:153], v[124:125]
    v_mfma_f32_16x16x32_bf16 v[232:235], v[80:83], v[212:215], v[232:235]
    v_lshlrev_b32 v154, 16, v101
    v_and_b32 v155, s79, v101
    v_mfma_f32_16x16x32_bf16 v[236:239], v[84:87], v[212:215], v[236:239]
    v_lshlrev_b32 v126, 16, v117
    v_and_b32 v127, s79, v117
    v_pk_add_f32 v[154:155], v[154:155], v[126:127]
    v_mfma_f32_16x16x32_bf16 v[240:243], v[80:83], v[216:219], v[240:243]
    v_lshlrev_b32 v156, 16, v102
    v_and_b32 v157, s79, v102
    v_mfma_f32_16x16x32_bf16 v[244:247], v[84:87], v[216:219], v[244:247]
    v_lshlrev_b32 v124, 16, v118
    v_and_b32 v125, s79, v118
    v_pk_add_f32 v[156:157], v[156:157], v[124:125]
    v_mfma_f32_16x16x32_bf16 v[248:251], v[80:83], v[220:223], v[248:251]
    v_lshlrev_b32 v158, 16, v103
    v_and_b32 v159, s79, v103
    v_mfma_f32_16x16x32_bf16 v[252:255], v[84:87], v[220:223], v[252:255]
    v_lshlrev_b32 v126, 16, v119
    v_and_b32 v127, s79, v119
    v_pk_add_f32 v[158:159], v[158:159], v[126:127]
    v_pk_add_f32 v[224:225], v[224:225], v[128:129]
    v_pk_add_f32 v[226:227], v[226:227], v[130:131]
    v_pk_add_f32 v[228:229], v[228:229], v[132:133]
    v_pk_add_f32 v[230:231], v[230:231], v[134:135]
    v_pk_add_f32 v[232:233], v[232:233], v[136:137]
    v_pk_add_f32 v[234:235], v[234:235], v[138:139]
    v_pk_add_f32 v[236:237], v[236:237], v[140:141]
    v_pk_add_f32 v[238:239], v[238:239], v[142:143]
    v_pk_add_f32 v[240:241], v[240:241], v[144:145]
    v_pk_add_f32 v[242:243], v[242:243], v[146:147]
    v_pk_add_f32 v[244:245], v[244:245], v[148:149]
    v_pk_add_f32 v[246:247], v[246:247], v[150:151]
    v_pk_add_f32 v[248:249], v[248:249], v[152:153]
    v_pk_add_f32 v[250:251], v[250:251], v[154:155]
    v_pk_add_f32 v[252:253], v[252:253], v[156:157]
    v_pk_add_f32 v[254:255], v[254:255], v[158:159]
    v_cvt_pk_bf16_f32 v40, v224, v225
    v_cvt_pk_bf16_f32 v41, v226, v227
    v_cvt_pk_bf16_f32 v42, v228, v229
    v_cvt_pk_bf16_f32 v43, v230, v231
    s_nop 0
    v_permlane16_swap_b32 v40, v42
    v_permlane16_swap_b32 v41, v43
    s_add_u32 s7, s78, 0
    buffer_store_dwordx4 v[40:43], v6, s[24:27], s7 offen
    v_cvt_pk_bf16_f32 v44, v232, v233
    v_cvt_pk_bf16_f32 v45, v234, v235
    v_cvt_pk_bf16_f32 v46, v236, v237
    v_cvt_pk_bf16_f32 v47, v238, v239
    s_nop 0
    v_permlane16_swap_b32 v44, v46
    v_permlane16_swap_b32 v45, v47
    s_add_u32 s7, s78, 20480
    buffer_store_dwordx4 v[44:47], v6, s[24:27], s7 offen
    v_cvt_pk_bf16_f32 v48, v240, v241
    v_cvt_pk_bf16_f32 v49, v242, v243
    v_cvt_pk_bf16_f32 v50, v244, v245
    v_cvt_pk_bf16_f32 v51, v246, v247
    s_nop 0
    v_permlane16_swap_b32 v48, v50
    v_permlane16_swap_b32 v49, v51
    s_add_u32 s7, s78, 40960
    buffer_store_dwordx4 v[48:51], v6, s[24:27], s7 offen
    v_cvt_pk_bf16_f32 v52, v248, v249
    v_cvt_pk_bf16_f32 v53, v250, v251
    v_cvt_pk_bf16_f32 v54, v252, v253
    v_cvt_pk_bf16_f32 v55, v254, v255
    s_nop 0
    v_permlane16_swap_b32 v52, v54
    v_permlane16_swap_b32 v53, v55
    s_add_u32 s7, s78, 61440
    buffer_store_dwordx4 v[52:55], v6, s[24:27], s7 offen
    s_cmp_lg_u32 s2, 0
    s_cbranch_scc1 L_end
    s_cmp_lg_u32 s66, 0
    s_cbranch_scc1 L_end
    v_lshlrev_b32 v8, 7, v1
    s_mov_b32 s81, 393216
    s_mov_b32 s78, 0
    s_mov_b32 s82, 200000
Lpoll_36:
    buffer_load_dword v9, v8, s[28:31], s81 offen sc1
    s_waitcnt vmcnt(0)
    v_cmp_ne_u32 vcc, s6, v9
    s_cbranch_vccz Lpolld_37
    s_mov_b64 exec, vcc
    s_sleep 8
    s_sub_u32 s82, s82, 1
    s_cmp_lg_u32 s82, 0
    s_cbranch_scc1 Lpoll_36
Lpolld_37:
    s_mov_b64 exec, -1
    v_mov_b32 v8, s6
    v_lshlrev_b32 v9, 2, v1
    s_mov_b32 exec_hi, 0
    buffer_store_dword v8, v9, s[28:31], s78 offen sc1
    s_mov_b64 exec, -1
Lp3idle_35:
    s_branch L_end
L_Y:
    s_setprio 0
    s_add_u32 s69, s69, 40960
    s_add_u32 s70, s70, 442368
    s_mov_b32 m0, s69
    s_nop 0
    s_add_u32 s69, s69, 20480
    buffer_load_dwordx4 v2, s[12:15], s70 offen lds
    buffer_load_dwordx4 v3, s[12:15], s70 offen offset:1024 lds
    buffer_load_dwordx4 v4, s[12:15], s70 offen offset:2048 lds
    buffer_load_dwordx4 v5, s[12:15], s70 offen offset:3072 lds
    s_add_u32 m0, m0, 4096
    s_cmp_ge_u32 s69, 163840
    buffer_load_dwordx4 v6, s[12:15], s70 offen lds
    s_cselect_b32 s69, s83, s69
    s_add_u32 s70, s70, 221184
    s_cmp_ge_u32 s70, 2211840
    s_cselect_b32 s70, s71, s70
    s_barrier
    s_mov_b32 m0, s69
    s_add_u32 s69, s69, 20480
    buffer_load_dwordx4 v2, s[12:15], s70 offen lds
    buffer_load_dwordx4 v3, s[12:15], s70 offen offset:1024 lds
    buffer_load_dwordx4 v4, s[12:15], s70 offen offset:2048 lds
    buffer_load_dwordx4 v5, s[12:15], s70 offen offset:3072 lds
    s_add_u32 m0, m0, 4096
    s_cmp_ge_u32 s69, 163840
    buffer_load_dwordx4 v6, s[12:15], s70 offen lds
    s_cselect_b32 s69, s83, s69
    s_add_u32 s70, s70, 221184
    s_cmp_ge_u32 s70, 2211840
    s_cselect_b32 s70, s71, s70
    s_barrier
    s_mov_b32 m0, s69
    s_add_u32 s69, s69, 20480
    buffer_load_dwordx4 v2, s[12:15], s70 offen lds
    buffer_load_dwordx4 v3, s[12:15], s70 offen offset:1024 lds
    buffer_load_dwordx4 v4, s[12:15], s70 offen offset:2048 lds
    buffer_load_dwordx4 v5, s[12:15], s70 offen offset:3072 lds
    s_add_u32 m0, m0, 4096
    s_cmp_ge_u32 s69, 163840
    buffer_load_dwordx4 v6, s[12:15], s70 offen lds
    s_cselect_b32 s69, s83, s69
    s_add_u32 s70, s70, 221184
    s_cmp_ge_u32 s70, 2211840
    s_cselect_b32 s70, s71, s70
    s_waitcnt vmcnt(10)
    s_mov_b32 s74, 2
Ly1_38:
    s_barrier
    s_cmp_lg_u32 s74, 7
    s_cbranch_scc1 Lcol_39
    s_sub_u32 s70, s70, 1728
    s_sub_u32 s71, s71, 1728
Lcol_39:
    s_mov_b32 m0, s69
    s_add_u32 s69, s69, 20480
    buffer_load_dwordx4 v2, s[12:15], s70 offen lds
    buffer_load_dwordx4 v3, s[12:15], s70 offen offset:1024 lds
    buffer_load_dwordx4 v4, s[12:15], s70 offen offset:2048 lds
    buffer_load_dwordx4 v5, s[12:15], s70 offen offset:3072 lds
    s_add_u32 m0, m0, 4096
    s_cmp_ge_u32 s69, 163840
    buffer_load_dwordx4 v6, s[12:15], s70 offen lds
    s_cselect_b32 s69, s83, s69
    s_add_u32 s70, s70, 221184
    s_cmp_ge_u32 s70, 2211840
    s_cselect_b32 s70, s71, s70
    s_waitcnt vmcnt(10)
    s_add_u32 s74, s74, 1
    s_cmp_lt_u32 s74, 10
    s_cbranch_scc1 Ly1_38
    s_mul_i32 s44, s5, 18432
    s_lshr_b32 s7, s2, 6
    s_sub_u32 s51, s5, s7
    s_mov_b32 s50, 0
    s_add_u32 s7, s7, 1
    s_cmp_ge_u32 s7, 3
    s_cselect_b32 s7, 0, s7
    s_add_u32 s92, s7, s51
    s_mul_i32 s45, s92, 18432
    s_lshl_b32 s92, s92, 2
    s_lshl_b32 s92, 1, s92
    s_or_b32 s50, s50, s92
    s_add_u32 s7, s7, 1
    s_cmp_ge_u32 s7, 3
    s_cselect_b32 s7, 0, s7
    s_add_u32 s92, s7, s51
    s_mul_i32 s46, s92, 18432
    s_lshl_b32 s92, s92, 2
    s_lshl_b32 s92, 2, s92
    s_or_b32 s50, s50, s92
    s_sub_u32 s51, 3, s51
    s_add_u32 s7, s7, 1
    s_cmp_ge_u32 s7, 3
    s_cselect_b32 s7, 0, s7
    s_add_u32 s92, s7, s51
    s_mul_i32 s47, s92, 18432
    s_lshl_b32 s92, s92, 2
    s_lshl_b32 s92, 3, s92
    s_or_b32 s50, s50, s92
    s_add_u32 s7, s7, 1
    s_cmp_ge_u32 s7, 3
    s_cselect_b32 s7, 0, s7
    s_add_u32 s92, s7, s51
    s_mul_i32 s48, s92, 18432
    s_lshl_b32 s92, s92, 2
    s_lshl_b32 s92, 4, s92
    s_or_b32 s50, s50, s92
    s_add_u32 s7, s7, 1
    s_cmp_ge_u32 s7, 3
    s_cselect_b32 s7, 0, s7
    s_add_u32 s92, s7, s51
    s_mul_i32 s49, s92, 18432
    s_lshl_b32 s92, s92, 2
    s_lshl_b32 s92, 5, s92
    s_or_b32 s50, s50, s92
    s_lshl_b32 s81, s4, 2
    s_add_u32 s81, s81, s66
    s_lshl_b32 s81, s81, 10
    s_add_u32 s81, s81, 262144
    s_lshl_b32 s85, s5, 7
    s_add_u32 s85, s85, s81
    v_min_u32 v6, 5, v1
    v_lshlrev_b32 v6, 7, v6
    v_add_u32 v6, s81, v6
    s_min_u32 s80, s5, 4
    s_mul_i32 s78, s80, 51
    s_lshr_b32 s78, s78, 2
    v_and_b32 v19, 15, v1
    v_add_u32 v19, s78, v19
    v_min_u32 v19, 63, v19
    v_lshlrev_b32 v19, 7, v19
    v_add_u32 v19, 393216, v19
    v_cmp_lt_u32 vcc, 15, v1
    s_nop 1
    v_cndmask_b32 v6, v6, v19, vcc
    s_mul_i32 s93, s67, 9216
    s_mul_i32 s78, s68, 5120
    s_add_u32 s93, s93, s78
    s_mul_i32 s94, s4, 110592
    s_add_u32 s94, s94, s93
    s_add_u32 s94, s94, 8388608
    s_add_u32 s93, s93, 49152
    s_mul_i32 s91, s4, 81920
    s_lshl_b32 s78, s80, 8
    s_add_u32 s91, s91, s78
    s_mul_i32 s78, s66, 20480
    s_add_u32 s91, s91, s78
    s_mul_i32 s84, s4, 81920
    s_lshl_b32 s78, s80, 14
    s_add_u32 s84, s84, s78
    s_lshl_b32 s78, s66, 12
    s_add_u32 s84, s84, s78
    s_add_u32 s84, s84, 12582912
    v_lshrrev_b32 v20, 4, v1
    v_add_u32 v20, 0, v20
    v_and_b32 v21, 15, v1
    v_xor_b32 v21, v21, v20
    v_mul_u32_u24 v20, 1280, v20
    v_lshl_add_u32 v28, v21, 4, v20
    v_lshrrev_b32 v20, 4, v1
    v_add_u32 v20, 4, v20
    v_and_b32 v21, 15, v1
    v_xor_b32 v21, v21, v20
    v_mul_u32_u24 v20, 1280, v20
    v_lshl_add_u32 v29, v21, 4, v20
    v_subrev_u32 v29, 1024, v29
    v_lshrrev_b32 v20, 4, v1
    v_add_u32 v20, 8, v20
    v_and_b32 v21, 15, v1
    v_xor_b32 v21, v21, v20
    v_mul_u32_u24 v20, 1280, v20
    v_lshl_add_u32 v30, v21, 4, v20
    v_subrev_u32 v30, 2048, v30
    v_lshrrev_b32 v20, 4, v1
    v_add_u32 v20, 12, v20
    v_and_b32 v21, 15, v1
    v_xor_b32 v21, v21, v20
    v_mul_u32_u24 v20, 1280, v20
    v_lshl_add_u32 v31, v21, 4, v20
    v_subrev_u32 v31, 3072, v31
    s_mov_b32 s73, 122880
    v_and_b32 v16, 15, v1
    v_lshlrev_b32 v16, 1, v16
    s_lshl_b32 s78, s4, 7
    s_lshl_b32 s79, s67, 6
    s_add_u32 s78, s78, s79
    buffer_load_ushort v34, v16, s[32:35], s78 offen
    buffer_load_ushort v36, v16, s[32:35], s78 offen offset:32
    s_cmp_eq_u32 s68, 0
    s_cbranch_scc1 Lnh5_40
    v_add_u32 v39, s73, v38
    v_add_u32 v12, s72, v8
    v_add_u32 v13, s72, v9
    v_add_u32 v14, s73, v10
    v_add_u32 v15, s73, v11
    s_add_u32 s72, s72, 8192
    s_cmp_ge_u32 s72, 81920
    s_cselect_b32 s72, 0, s72
    s_add_u32 s73, s73, 20480
    s_cmp_ge_u32 s73, 163840
    s_cselect_b32 s73, 81920, s73
    s_barrier
    ds_read_b128 v[40:43], v12 offset:0
    ds_read_b128 v[44:47], v12 offset:2048
    ds_read_b64_tr_b16 v[48:49], v14 offset:0
    ds_read_b64_tr_b16 v[50:51], v14 offset:1280
    ds_read_b64_tr_b16 v[52:53], v39 offset:0
    ds_read_b64_tr_b16 v[54:55], v39 offset:1280
    ds_read_b64_tr_b16 v[56:57], v14 offset:64
    ds_read_b64_tr_b16 v[58:59], v14 offset:1344
    ds_read_b64_tr_b16 v[60:61], v39 offset:64
    ds_read_b64_tr_b16 v[62:63], v39 offset:1344
    ds_read_b128 v[68:71], v13 offset:0
    ds_read_b128 v[72:75], v13 offset:2048
    ds_read_b64_tr_b16 v[76:77], v14 offset:10240
    ds_read_b64_tr_b16 v[78:79], v14 offset:11520
    ds_read_b64_tr_b16 v[80:81], v39 offset:10240
    ds_read_b64_tr_b16 v[82:83], v39 offset:11520
    ds_read_b64_tr_b16 v[84:85], v14 offset:10304
    ds_read_b64_tr_b16 v[86:87], v14 offset:11584
    ds_read_b64_tr_b16 v[88:89], v39 offset:10304
    ds_read_b64_tr_b16 v[90:91], v39 offset:11584
    v_add_u32 v39, s73, v38
    v_add_u32 v12, s72, v8
    v_add_u32 v13, s72, v9
    v_add_u32 v14, s73, v10
    v_add_u32 v15, s73, v11
    s_add_u32 s72, s72, 8192
    s_cmp_ge_u32 s72, 81920
    s_cselect_b32 s72, 0, s72
    s_add_u32 s73, s73, 20480
    s_cmp_ge_u32 s73, 163840
    s_cselect_b32 s73, 81920, s73
    s_waitcnt vmcnt(0) lgkmcnt(0)
    s_barrier
    v_mfma_f32_16x16x32_bf16 v[152:155], v[48:51], v[40:43], 0
    ds_read_b128 v[96:99], v12 offset:0
    ds_read_b128 v[100:103], v12 offset:2048
    v_mfma_f32_16x16x32_bf16 v[156:159], v[48:51], v[44:47], 0
    ds_read_b64_tr_b16 v[104:105], v14 offset:0
    ds_read_b64_tr_b16 v[106:107], v14 offset:1280
    v_mfma_f32_16x16x32_bf16 v[160:163], v[52:55], v[40:43], 0
    ds_read_b64_tr_b16 v[108:109], v39 offset:0
    ds_read_b64_tr_b16 v[110:111], v39 offset:1280
    v_mfma_f32_16x16x32_bf16 v[164:167], v[52:55], v[44:47], 0
    ds_read_b64_tr_b16 v[112:113], v14 offset:64
    ds_read_b64_tr_b16 v[114:115], v14 offset:1344
    v_mfma_f32_16x16x32_bf16 v[168:171], v[56:59], v[40:43], 0
    ds_read_b64_tr_b16 v[116:117], v39 offset:64
    ds_read_b64_tr_b16 v[118:119], v39 offset:1344
    v_mfma_f32_16x16x32_bf16 v[172:175], v[56:59], v[44:47], 0
    ds_read_b128 v[124:127], v13 offset:0
    ds_read_b128 v[128:131], v13 offset:2048
    v_mfma_f32_16x16x32_bf16 v[176:179], v[60:63], v[40:43], 0
    ds_read_b64_tr_b16 v[132:133], v14 offset:10240
    ds_read_b64_tr_b16 v[134:135], v14 offset:11520
    v_mfma_f32_16x16x32_bf16 v[180:183], v[60:63], v[44:47], 0
    ds_read_b64_tr_b16 v[136:137], v39 offset:10240
    ds_read_b64_tr_b16 v[138:139], v39 offset:11520
    v_mfma_f32_16x16x32_bf16 v[152:155], v[76:79], v[68:71], v[152:155]
    ds_read_b64_tr_b16 v[140:141], v14 offset:10304
    ds_read_b64_tr_b16 v[142:143], v14 offset:11584
    v_mfma_f32_16x16x32_bf16 v[156:159], v[76:79], v[72:75], v[156:159]
    ds_read_b64_tr_b16 v[144:145], v39 offset:10304
    ds_read_b64_tr_b16 v[146:147], v39 offset:11584
    v_mfma_f32_16x16x32_bf16 v[160:163], v[80:83], v[68:71], v[160:163]
    v_add_u32 v39, s73, v38
    v_add_u32 v12, s72, v8
    v_add_u32 v13, s72, v9
    v_mfma_f32_16x16x32_bf16 v[164:167], v[80:83], v[72:75], v[164:167]
    v_add_u32 v14, s73, v10
    v_add_u32 v15, s73, v11
    s_add_u32 s72, s72, 8192
    v_mfma_f32_16x16x32_bf16 v[168:171], v[84:87], v[68:71], v[168:171]
    s_cmp_ge_u32 s72, 81920
    s_cselect_b32 s72, 0, s72
    s_add_u32 s73, s73, 20480
    v_mfma_f32_16x16x32_bf16 v[172:175], v[84:87], v[72:75], v[172:175]
    s_cmp_ge_u32 s73, 163840
    s_cselect_b32 s73, 81920, s73
    s_mov_b32 s74, 4
    v_mfma_f32_16x16x32_bf16 v[176:179], v[88:91], v[68:71], v[176:179]
    v_mfma_f32_16x16x32_bf16 v[180:183], v[88:91], v[72:75], v[180:183]
    s_waitcnt vmcnt(0) lgkmcnt(0)
Lcp1b_42:
    s_barrier
    s_nop 0
    v_mfma_f32_16x16x32_bf16 v[152:155], v[104:107], v[96:99], v[152:155]
    ds_read_b128 v[40:43], v12 offset:0
    ds_read_b128 v[44:47], v12 offset:2048
    v_mfma_f32_16x16x32_bf16 v[156:159], v[104:107], v[100:103], v[156:159]
    ds_read_b64_tr_b16 v[48:49], v14 offset:0
    ds_read_b64_tr_b16 v[50:51], v14 offset:1280
    v_mfma_f32_16x16x32_bf16 v[160:163], v[108:111], v[96:99], v[160:163]
    ds_read_b64_tr_b16 v[52:53], v39 offset:0
    ds_read_b64_tr_b16 v[54:55], v39 offset:1280
    v_mfma_f32_16x16x32_bf16 v[164:167], v[108:111], v[100:103], v[164:167]
    ds_read_b64_tr_b16 v[56:57], v14 offset:64
    ds_read_b64_tr_b16 v[58:59], v14 offset:1344
    v_mfma_f32_16x16x32_bf16 v[168:171], v[112:115], v[96:99], v[168:171]
    ds_read_b64_tr_b16 v[60:61], v39 offset:64
    ds_read_b64_tr_b16 v[62:63], v39 offset:1344
    v_mfma_f32_16x16x32_bf16 v[172:175], v[112:115], v[100:103], v[172:175]
    ds_read_b128 v[68:71], v13 offset:0
    ds_read_b128 v[72:75], v13 offset:2048
    v_mfma_f32_16x16x32_bf16 v[176:179], v[116:119], v[96:99], v[176:179]
    ds_read_b64_tr_b16 v[76:77], v14 offset:10240
    ds_read_b64_tr_b16 v[78:79], v14 offset:11520
    v_mfma_f32_16x16x32_bf16 v[180:183], v[116:119], v[100:103], v[180:183]
    ds_read_b64_tr_b16 v[80:81], v39 offset:10240
    ds_read_b64_tr_b16 v[82:83], v39 offset:11520
    v_mfma_f32_16x16x32_bf16 v[152:155], v[132:135], v[124:127], v[152:155]
    ds_read_b64_tr_b16 v[84:85], v14 offset:10304
    ds_read_b64_tr_b16 v[86:87], v14 offset:11584
    v_mfma_f32_16x16x32_bf16 v[156:159], v[132:135], v[128:131], v[156:159]
    ds_read_b64_tr_b16 v[88:89], v39 offset:10304
    ds_read_b64_tr_b16 v[90:91], v39 offset:11584
    v_mfma_f32_16x16x32_bf16 v[160:163], v[136:139], v[124:127], v[160:163]
    v_add_u32 v39, s73, v38
    v_add_u32 v12, s72, v8
    v_mfma_f32_16x16x32_bf16 v[164:167], v[136:139], v[128:131], v[164:167]
    v_add_u32 v13, s72, v9
    v_add_u32 v14, s73, v10
    v_mfma_f32_16x16x32_bf16 v[168:171], v[140:143], v[124:127], v[168:171]
    v_add_u32 v15, s73, v11
    s_add_u32 s72, s72, 8192
    v_mfma_f32_16x16x32_bf16 v[172:175], v[140:143], v[128:131], v[172:175]
    s_cmp_ge_u32 s72, 81920
    s_cselect_b32 s72, 0, s72
    v_mfma_f32_16x16x32_bf16 v[176:179], v[144:147], v[124:127], v[176:179]
    s_add_u32 s73, s73, 20480
    s_cmp_ge_u32 s73, 163840
    v_mfma_f32_16x16x32_bf16 v[180:183], v[144:147], v[128:131], v[180:183]
    s_cselect_b32 s73, 81920, s73
    s_waitcnt vmcnt(0) lgkmcnt(0)
    s_barrier
    v_mfma_f32_16x16x32_bf16 v[152:155], v[48:51], v[40:43], v[152:155]
    ds_read_b128 v[96:99], v12 offset:0
    ds_read_b128 v[100:103], v12 offset:2048
    v_mfma_f32_16x16x32_bf16 v[156:159], v[48:51], v[44:47], v[156:159]
    ds_read_b64_tr_b16 v[104:105], v14 offset:0
    ds_read_b64_tr_b16 v[106:107], v14 offset:1280
    v_mfma_f32_16x16x32_bf16 v[160:163], v[52:55], v[40:43], v[160:163]
    ds_read_b64_tr_b16 v[108:109], v39 offset:0
    ds_read_b64_tr_b16 v[110:111], v39 offset:1280
    v_mfma_f32_16x16x32_bf16 v[164:167], v[52:55], v[44:47], v[164:167]
    ds_read_b64_tr_b16 v[112:113], v14 offset:64
    ds_read_b64_tr_b16 v[114:115], v14 offset:1344
    v_mfma_f32_16x16x32_bf16 v[168:171], v[56:59], v[40:43], v[168:171]
    ds_read_b64_tr_b16 v[116:117], v39 offset:64
    ds_read_b64_tr_b16 v[118:119], v39 offset:1344
    v_mfma_f32_16x16x32_bf16 v[172:175], v[56:59], v[44:47], v[172:175]
    ds_read_b128 v[124:127], v13 offset:0
    ds_read_b128 v[128:131], v13 offset:2048
    v_mfma_f32_16x16x32_bf16 v[176:179], v[60:63], v[40:43], v[176:179]
    ds_read_b64_tr_b16 v[132:133], v14 offset:10240
    ds_read_b64_tr_b16 v[134:135], v14 offset:11520
    v_mfma_f32_16x16x32_bf16 v[180:183], v[60:63], v[44:47], v[180:183]
    ds_read_b64_tr_b16 v[136:137], v39 offset:10240
    ds_read_b64_tr_b16 v[138:139], v39 offset:11520
    v_mfma_f32_16x16x32_bf16 v[152:155], v[76:79], v[68:71], v[152:155]
    ds_read_b64_tr_b16 v[140:141], v14 offset:10304
    ds_read_b64_tr_b16 v[142:143], v14 offset:11584
    v_mfma_f32_16x16x32_bf16 v[156:159], v[76:79], v[72:75], v[156:159]
    ds_read_b64_tr_b16 v[144:145], v39 offset:10304
    ds_read_b64_tr_b16 v[146:147], v39 offset:11584
    v_mfma_f32_16x16x32_bf16 v[160:163], v[80:83], v[68:71], v[160:163]
    v_add_u32 v39, s73, v38
    v_add_u32 v12, s72, v8
    v_mfma_f32_16x16x32_bf16 v[164:167], v[80:83], v[72:75], v[164:167]
    v_add_u32 v13, s72, v9
    v_add_u32 v14, s73, v10
    v_mfma_f32_16x16x32_bf16 v[168:171], v[84:87], v[68:71], v[168:171]
    v_add_u32 v15, s73, v11
    s_add_u32 s72, s72, 8192
    v_mfma_f32_16x16x32_bf16 v[172:175], v[84:87], v[72:75], v[172:175]
    s_cmp_ge_u32 s72, 81920
    s_cselect_b32 s72, 0, s72
    v_mfma_f32_16x16x32_bf16 v[176:179], v[88:91], v[68:71], v[176:179]
    s_add_u32 s73, s73, 20480
    s_cmp_ge_u32 s73, 163840
    v_mfma_f32_16x16x32_bf16 v[180:183], v[88:91], v[72:75], v[180:183]
    s_cselect_b32 s73, 81920, s73
    s_sub_u32 s74, s74, 1
    s_cmp_lg_u32 s74, 0
    s_waitcnt vmcnt(0) lgkmcnt(0)
    s_cbranch_scc1 Lcp1b_42
    s_branch Lnhj_41
Lnh5_40:
    v_add_u32 v39, s73, v38
    v_add_u32 v12, s72, v8
    v_add_u32 v13, s72, v9
    v_add_u32 v14, s73, v10
    v_add_u32 v15, s73, v11
    s_add_u32 s72, s72, 8192
    s_cmp_ge_u32 s72, 81920
    s_cselect_b32 s72, 0, s72
    s_add_u32 s73, s73, 20480
    s_cmp_ge_u32 s73, 163840
    s_cselect_b32 s73, 81920, s73
    s_barrier
    ds_read_b128 v[40:43], v12 offset:0
    ds_read_b128 v[44:47], v12 offset:2048
    ds_read_b64_tr_b16 v[48:49], v14 offset:0
    ds_read_b64_tr_b16 v[50:51], v14 offset:1280
    ds_read_b64_tr_b16 v[52:53], v39 offset:0
    ds_read_b64_tr_b16 v[54:55], v39 offset:1280
    ds_read_b64_tr_b16 v[56:57], v14 offset:64
    ds_read_b64_tr_b16 v[58:59], v14 offset:1344
    ds_read_b64_tr_b16 v[60:61], v39 offset:64
    ds_read_b64_tr_b16 v[62:63], v39 offset:1344
    ds_read_b64_tr_b16 v[64:65], v15 offset:0
    ds_read_b64_tr_b16 v[66:67], v15 offset:1280
    ds_read_b128 v[68:71], v13 offset:0
    ds_read_b128 v[72:75], v13 offset:2048
    ds_read_b64_tr_b16 v[76:77], v14 offset:10240
    ds_read_b64_tr_b16 v[78:79], v14 offset:11520
    ds_read_b64_tr_b16 v[80:81], v39 offset:10240
    ds_read_b64_tr_b16 v[82:83], v39 offset:11520
    ds_read_b64_tr_b16 v[84:85], v14 offset:10304
    ds_read_b64_tr_b16 v[86:87], v14 offset:11584
    ds_read_b64_tr_b16 v[88:89], v39 offset:10304
    ds_read_b64_tr_b16 v[90:91], v39 offset:11584
    ds_read_b64_tr_b16 v[92:93], v15 offset:10240
    ds_read_b64_tr_b16 v[94:95], v15 offset:11520
    v_add_u32 v39, s73, v38
    v_add_u32 v12, s72, v8
    v_add_u32 v13, s72, v9
    v_add_u32 v14, s73, v10
    v_add_u32 v15, s73, v11
    s_add_u32 s72, s72, 8192
    s_cmp_ge_u32 s72, 81920
    s_cselect_b32 s72, 0, s72
    s_add_u32 s73, s73, 20480
    s_cmp_ge_u32 s73, 163840
    s_cselect_b32 s73, 81920, s73
    s_waitcnt vmcnt(0) lgkmcnt(0)
    s_barrier
    v_mfma_f32_16x16x32_bf16 v[152:155], v[48:51], v[40:43], 0
    ds_read_b128 v[96:99], v12 offset:0
    ds_read_b128 v[100:103], v12 offset:2048
    v_mfma_f32_16x16x32_bf16 v[156:159], v[48:51], v[44:47], 0
    ds_read_b64_tr_b16 v[104:105], v14 offset:0
    ds_read_b64_tr_b16 v[106:107], v14 offset:1280
    v_mfma_f32_16x16x32_bf16 v[160:163], v[52:55], v[40:43], 0
    ds_read_b64_tr_b16 v[108:109], v39 offset:0
    ds_read_b64_tr_b16 v[110:111], v39 offset:1280
    v_mfma_f32_16x16x32_bf16 v[164:167], v[52:55], v[44:47], 0
    ds_read_b64_tr_b16 v[112:113], v14 offset:64
    ds_read_b64_tr_b16 v[114:115], v14 offset:1344
    v_mfma_f32_16x16x32_bf16 v[168:171], v[56:59], v[40:43], 0
    ds_read_b64_tr_b16 v[116:117], v39 offset:64
    ds_read_b64_tr_b16 v[118:119], v39 offset:1344
    v_mfma_f32_16x16x32_bf16 v[172:175], v[56:59], v[44:47], 0
    ds_read_b64_tr_b16 v[120:121], v15 offset:0
    ds_read_b64_tr_b16 v[122:123], v15 offset:1280
    v_mfma_f32_16x16x32_bf16 v[176:179], v[60:63], v[40:43], 0
    ds_read_b128 v[124:127], v13 offset:0
    ds_read_b128 v[128:131], v13 offset:2048
    v_mfma_f32_16x16x32_bf16 v[180:183], v[60:63], v[44:47], 0
    ds_read_b64_tr_b16 v[132:133], v14 offset:10240
    ds_read_b64_tr_b16 v[134:135], v14 offset:11520
    v_mfma_f32_16x16x32_bf16 v[184:187], v[64:67], v[40:43], 0
    ds_read_b64_tr_b16 v[136:137], v39 offset:10240
    ds_read_b64_tr_b16 v[138:139], v39 offset:11520
    v_mfma_f32_16x16x32_bf16 v[188:191], v[64:67], v[44:47], 0
    ds_read_b64_tr_b16 v[140:141], v14 offset:10304
    ds_read_b64_tr_b16 v[142:143], v14 offset:11584
    v_mfma_f32_16x16x32_bf16 v[152:155], v[76:79], v[68:71], v[152:155]
    ds_read_b64_tr_b16 v[144:145], v39 offset:10304
    ds_read_b64_tr_b16 v[146:147], v39 offset:11584
    v_mfma_f32_16x16x32_bf16 v[156:159], v[76:79], v[72:75], v[156:159]
    ds_read_b64_tr_b16 v[148:149], v15 offset:10240
    ds_read_b64_tr_b16 v[150:151], v15 offset:11520
    v_mfma_f32_16x16x32_bf16 v[160:163], v[80:83], v[68:71], v[160:163]
    v_add_u32 v39, s73, v38
    v_add_u32 v12, s72, v8
    v_add_u32 v13, s72, v9
    v_mfma_f32_16x16x32_bf16 v[164:167], v[80:83], v[72:75], v[164:167]
    v_add_u32 v14, s73, v10
    v_add_u32 v15, s73, v11
    s_add_u32 s72, s72, 8192
    v_mfma_f32_16x16x32_bf16 v[168:171], v[84:87], v[68:71], v[168:171]
    s_cmp_ge_u32 s72, 81920
    s_cselect_b32 s72, 0, s72
    s_add_u32 s73, s73, 20480
    v_mfma_f32_16x16x32_bf16 v[172:175], v[84:87], v[72:75], v[172:175]
    s_cmp_ge_u32 s73, 163840
    s_cselect_b32 s73, 81920, s73
    s_mov_b32 s74, 4
    v_mfma_f32_16x16x32_bf16 v[176:179], v[88:91], v[68:71], v[176:179]
    v_mfma_f32_16x16x32_bf16 v[180:183], v[88:91], v[72:75], v[180:183]
    v_mfma_f32_16x16x32_bf16 v[184:187], v[92:95], v[68:71], v[184:187]
    v_mfma_f32_16x16x32_bf16 v[188:191], v[92:95], v[72:75], v[188:191]
    s_waitcnt vmcnt(0) lgkmcnt(0)
Lcp1b_43:
    s_barrier
    s_nop 0
    v_mfma_f32_16x16x32_bf16 v[152:155], v[104:107], v[96:99], v[152:155]
    ds_read_b128 v[40:43], v12 offset:0
    ds_read_b128 v[44:47], v12 offset:2048
    v_mfma_f32_16x16x32_bf16 v[156:159], v[104:107], v[100:103], v[156:159]
    ds_read_b64_tr_b16 v[48:49], v14 offset:0
    ds_read_b64_tr_b16 v[50:51], v14 offset:1280
    v_mfma_f32_16x16x32_bf16 v[160:163], v[108:111], v[96:99], v[160:163]
    ds_read_b64_tr_b16 v[52:53], v39 offset:0
    ds_read_b64_tr_b16 v[54:55], v39 offset:1280
    v_mfma_f32_16x16x32_bf16 v[164:167], v[108:111], v[100:103], v[164:167]
    ds_read_b64_tr_b16 v[56:57], v14 offset:64
    ds_read_b64_tr_b16 v[58:59], v14 offset:1344
    v_mfma_f32_16x16x32_bf16 v[168:171], v[112:115], v[96:99], v[168:171]
    ds_read_b64_tr_b16 v[60:61], v39 offset:64
    ds_read_b64_tr_b16 v[62:63], v39 offset:1344
    v_mfma_f32_16x16x32_bf16 v[172:175], v[112:115], v[100:103], v[172:175]
    ds_read_b64_tr_b16 v[64:65], v15 offset:0
    ds_read_b64_tr_b16 v[66:67], v15 offset:1280
    v_mfma_f32_16x16x32_bf16 v[176:179], v[116:119], v[96:99], v[176:179]
    ds_read_b128 v[68:71], v13 offset:0
    ds_read_b128 v[72:75], v13 offset:2048
    v_mfma_f32_16x16x32_bf16 v[180:183], v[116:119], v[100:103], v[180:183]
    ds_read_b64_tr_b16 v[76:77], v14 offset:10240
    ds_read_b64_tr_b16 v[78:79], v14 offset:11520
    v_mfma_f32_16x16x32_bf16 v[184:187], v[120:123], v[96:99], v[184:187]
    ds_read_b64_tr_b16 v[80:81], v39 offset:10240
    ds_read_b64_tr_b16 v[82:83], v39 offset:11520
    v_mfma_f32_16x16x32_bf16 v[188:191], v[120:123], v[100:103], v[188:191]
    ds_read_b64_tr_b16 v[84:85], v14 offset:10304
    ds_read_b64_tr_b16 v[86:87], v14 offset:11584
    v_mfma_f32_16x16x32_bf16 v[152:155], v[132:135], v[124:127], v[152:155]
    ds_read_b64_tr_b16 v[88:89], v39 offset:10304
    ds_read_b64_tr_b16 v[90:91], v39 offset:11584
    v_mfma_f32_16x16x32_bf16 v[156:159], v[132:135], v[128:131], v[156:159]
    ds_read_b64_tr_b16 v[92:93], v15 offset:10240
    ds_read_b64_tr_b16 v[94:95], v15 offset:11520
    v_mfma_f32_16x16x32_bf16 v[160:163], v[136:139], v[124:127], v[160:163]
    v_add_u32 v39, s73, v38
    v_add_u32 v12, s72, v8
    v_mfma_f32_16x16x32_bf16 v[164:167], v[136:139], v[128:131], v[164:167]
    v_add_u32 v13, s72, v9
    v_add_u32 v14, s73, v10
    v_mfma_f32_16x16x32_bf16 v[168:171], v[140:143], v[124:127], v[168:171]
    v_add_u32 v15, s73, v11
    s_add_u32 s72, s72, 8192
    v_mfma_f32_16x16x32_bf16 v[172:175], v[140:143], v[128:131], v[172:175]
    s_cmp_ge_u32 s72, 81920
    s_cselect_b32 s72, 0, s72
    v_mfma_f32_16x16x32_bf16 v[176:179], v[144:147], v[124:127], v[176:179]
    s_add_u32 s73, s73, 20480
    s_cmp_ge_u32 s73, 163840
    v_mfma_f32_16x16x32_bf16 v[180:183], v[144:147], v[128:131], v[180:183]
    s_cselect_b32 s73, 81920, s73
    v_mfma_f32_16x16x32_bf16 v[184:187], v[148:151], v[124:127], v[184:187]
    v_mfma_f32_16x16x32_bf16 v[188:191], v[148:151], v[128:131], v[188:191]
    s_waitcnt vmcnt(0) lgkmcnt(0)
    s_barrier
    v_mfma_f32_16x16x32_bf16 v[152:155], v[48:51], v[40:43], v[152:155]
    ds_read_b128 v[96:99], v12 offset:0
    ds_read_b128 v[100:103], v12 offset:2048
    v_mfma_f32_16x16x32_bf16 v[156:159], v[48:51], v[44:47], v[156:159]
    ds_read_b64_tr_b16 v[104:105], v14 offset:0
    ds_read_b64_tr_b16 v[106:107], v14 offset:1280
    v_mfma_f32_16x16x32_bf16 v[160:163], v[52:55], v[40:43], v[160:163]
    ds_read_b64_tr_b16 v[108:109], v39 offset:0
    ds_read_b64_tr_b16 v[110:111], v39 offset:1280
    v_mfma_f32_16x16x32_bf16 v[164:167], v[52:55], v[44:47], v[164:167]
    ds_read_b64_tr_b16 v[112:113], v14 offset:64
    ds_read_b64_tr_b16 v[114:115], v14 offset:1344
    v_mfma_f32_16x16x32_bf16 v[168:171], v[56:59], v[40:43], v[168:171]
    ds_read_b64_tr_b16 v[116:117], v39 offset:64
    ds_read_b64_tr_b16 v[118:119], v39 offset:1344
    v_mfma_f32_16x16x32_bf16 v[172:175], v[56:59], v[44:47], v[172:175]
    ds_read_b64_tr_b16 v[120:121], v15 offset:0
    ds_read_b64_tr_b16 v[122:123], v15 offset:1280
    v_mfma_f32_16x16x32_bf16 v[176:179], v[60:63], v[40:43], v[176:179]
    ds_read_b128 v[124:127], v13 offset:0
    ds_read_b128 v[128:131], v13 offset:2048
    v_mfma_f32_16x16x32_bf16 v[180:183], v[60:63], v[44:47], v[180:183]
    ds_read_b64_tr_b16 v[132:133], v14 offset:10240
    ds_read_b64_tr_b16 v[134:135], v14 offset:11520
    v_mfma_f32_16x16x32_bf16 v[184:187], v[64:67], v[40:43], v[184:187]
    ds_read_b64_tr_b16 v[136:137], v39 offset:10240
    ds_read_b64_tr_b16 v[138:139], v39 offset:11520
    v_mfma_f32_16x16x32_bf16 v[188:191], v[64:67], v[44:47], v[188:191]
    ds_read_b64_tr_b16 v[140:141], v14 offset:10304
    ds_read_b64_tr_b16 v[142:143], v14 offset:11584
    v_mfma_f32_16x16x32_bf16 v[152:155], v[76:79], v[68:71], v[152:155]
    ds_read_b64_tr_b16 v[144:145], v39 offset:10304
    ds_read_b64_tr_b16 v[146:147], v39 offset:11584
    v_mfma_f32_16x16x32_bf16 v[156:159], v[76:79], v[72:75], v[156:159]
    ds_read_b64_tr_b16 v[148:149], v15 offset:10240
    ds_read_b64_tr_b16 v[150:151], v15 offset:11520
    v_mfma_f32_16x16x32_bf16 v[160:163], v[80:83], v[68:71], v[160:163]
    v_add_u32 v39, s73, v38
    v_add_u32 v12, s72, v8
    v_mfma_f32_16x16x32_bf16 v[164:167], v[80:83], v[72:75], v[164:167]
    v_add_u32 v13, s72, v9
    v_add_u32 v14, s73, v10
    v_mfma_f32_16x16x32_bf16 v[168:171], v[84:87], v[68:71], v[168:171]
    v_add_u32 v15, s73, v11
    s_add_u32 s72, s72, 8192
    v_mfma_f32_16x16x32_bf16 v[172:175], v[84:87], v[72:75], v[172:175]
    s_cmp_ge_u32 s72, 81920
    s_cselect_b32 s72, 0, s72
    v_mfma_f32_16x16x32_bf16 v[176:179], v[88:91], v[68:71], v[176:179]
    s_add_u32 s73, s73, 20480
    s_cmp_ge_u32 s73, 163840
    v_mfma_f32_16x16x32_bf16 v[180:183], v[88:91], v[72:75], v[180:183]
    s_cselect_b32 s73, 81920, s73
    s_sub_u32 s74, s74, 1
    v_mfma_f32_16x16x32_bf16 v[184:187], v[92:95], v[68:71], v[184:187]
    s_cmp_lg_u32 s74, 0
    v_mfma_f32_16x16x32_bf16 v[188:191], v[92:95], v[72:75], v[188:191]
    s_waitcnt vmcnt(0) lgkmcnt(0)
    s_cbranch_scc1 Lcp1b_43
Lnhj_41:
    v_mfma_f32_16x16x32_bf16 v[152:155], v[104:107], v[96:99], v[152:155]
    v_mfma_f32_16x16x32_bf16 v[156:159], v[104:107], v[100:103], v[156:159]
    v_mfma_f32_16x16x32_bf16 v[160:163], v[108:111], v[96:99], v[160:163]
    v_mfma_f32_16x16x32_bf16 v[164:167], v[108:111], v[100:103], v[164:167]
    v_mfma_f32_16x16x32_bf16 v[168:171], v[112:115], v[96:99], v[168:171]
    v_mfma_f32_16x16x32_bf16 v[172:175], v[112:115], v[100:103], v[172:175]
    v_mfma_f32_16x16x32_bf16 v[176:179], v[116:119], v[96:99], v[176:179]
    v_mfma_f32_16x16x32_bf16 v[180:183], v[116:119], v[100:103], v[180:183]
    v_mfma_f32_16x16x32_bf16 v[184:187], v[120:123], v[96:99], v[184:187]
    v_mfma_f32_16x16x32_bf16 v[188:191], v[120:123], v[100:103], v[188:191]
    v_mfma_f32_16x16x32_bf16 v[152:155], v[132:135], v[124:127], v[152:155]
    v_mfma_f32_16x16x32_bf16 v[156:159], v[132:135], v[128:131], v[156:159]
    v_mfma_f32_16x16x32_bf16 v[160:163], v[136:139], v[124:127], v[160:163]
    v_mfma_f32_16x16x32_bf16 v[164:167], v[136:139], v[128:131], v[164:167]
    v_mfma_f32_16x16x32_bf16 v[168:171], v[140:143], v[124:127], v[168:171]
    v_mfma_f32_16x16x32_bf16 v[172:175], v[140:143], v[128:131], v[172:175]
    v_mfma_f32_16x16x32_bf16 v[176:179], v[144:147], v[124:127], v[176:179]
    v_mfma_f32_16x16x32_bf16 v[180:183], v[144:147], v[128:131], v[180:183]
    v_mfma_f32_16x16x32_bf16 v[184:187], v[148:151], v[124:127], v[184:187]
    v_mfma_f32_16x16x32_bf16 v[188:191], v[148:151], v[128:131], v[188:191]
    s_barrier
    s_nop 0
    v_pk_mul_f32 v[16:17], v[152:153], v[152:153]
    v_pk_mul_f32 v[18:19], v[154:155], v[154:155]
    v_pk_mul_f32 v[20:21], v[156:157], v[156:157]
    v_pk_mul_f32 v[22:23], v[158:159], v[158:159]
    v_pk_fma_f32 v[16:17], v[16:17], s[76:77], v[32:33]
    v_pk_fma_f32 v[18:19], v[18:19], s[76:77], v[32:33]
    v_pk_fma_f32 v[20:21], v[20:21], s[76:77], v[32:33]
    v_pk_fma_f32 v[22:23], v[22:23], s[76:77], v[32:33]
    v_pk_mul_f32 v[16:17], v[16:17], v[152:153]
    v_pk_mul_f32 v[18:19], v[18:19], v[154:155]
    v_pk_mul_f32 v[20:21], v[20:21], v[156:157]
    v_pk_mul_f32 v[22:23], v[22:23], v[158:159]
    v_exp_f32 v16, v16
    v_exp_f32 v18, v18
    v_exp_f32 v20, v20
    v_exp_f32 v22, v22
    v_exp_f32 v17, v17
    v_exp_f32 v19, v19
    v_exp_f32 v21, v21
    v_exp_f32 v23, v23
    v_pk_add_f32 v[16:17], v[16:17], 1.0 op_sel_hi:[1,0]
    v_pk_add_f32 v[18:19], v[18:19], 1.0 op_sel_hi:[1,0]
    v_pk_add_f32 v[20:21], v[20:21], 1.0 op_sel_hi:[1,0]
    v_pk_add_f32 v[22:23], v[22:23], 1.0 op_sel_hi:[1,0]
    v_rcp_f32 v16, v16
    v_rcp_f32 v18, v18
    v_rcp_f32 v20, v20
    v_rcp_f32 v22, v22
    v_rcp_f32 v17, v17
    v_rcp_f32 v19, v19
    v_rcp_f32 v21, v21
    v_rcp_f32 v23, v23
    v_pk_mul_f32 v[192:193], v[16:17], v[152:153]
    v_pk_mul_f32 v[194:195], v[18:19], v[154:155]
    v_pk_mul_f32 v[196:197], v[20:21], v[156:157]
    v_pk_mul_f32 v[198:199], v[22:23], v[158:159]
    v_pk_mul_f32 v[16:17], v[160:161], v[160:161]
    v_pk_mul_f32 v[18:19], v[162:163], v[162:163]
    v_pk_mul_f32 v[20:21], v[164:165], v[164:165]
    v_pk_mul_f32 v[22:23], v[166:167], v[166:167]
    v_pk_fma_f32 v[16:17], v[16:17], s[76:77], v[32:33]
    v_pk_fma_f32 v[18:19], v[18:19], s[76:77], v[32:33]
    v_pk_fma_f32 v[20:21], v[20:21], s[76:77], v[32:33]
    v_pk_fma_f32 v[22:23], v[22:23], s[76:77], v[32:33]
    v_pk_mul_f32 v[16:17], v[16:17], v[160:161]
    v_pk_mul_f32 v[18:19], v[18:19], v[162:163]
    v_pk_mul_f32 v[20:21], v[20:21], v[164:165]
    v_pk_mul_f32 v[22:23], v[22:23], v[166:167]
    v_exp_f32 v16, v16
    v_exp_f32 v18, v18
    v_exp_f32 v20, v20
    v_exp_f32 v22, v22
    v_exp_f32 v17, v17
    v_exp_f32 v19, v19
    v_exp_f32 v21, v21
    v_exp_f32 v23, v23
    v_pk_add_f32 v[16:17], v[16:17], 1.0 op_sel_hi:[1,0]
    v_pk_add_f32 v[18:19], v[18:19], 1.0 op_sel_hi:[1,0]
    v_pk_add_f32 v[20:21], v[20:21], 1.0 op_sel_hi:[1,0]
    v_pk_add_f32 v[22:23], v[22:23], 1.0 op_sel_hi:[1,0]
    v_rcp_f32 v16, v16
    v_rcp_f32 v18, v18
    v_rcp_f32 v20, v20
    v_rcp_f32 v22, v22
    v_rcp_f32 v17, v17
    v_rcp_f32 v19, v19
    v_rcp_f32 v21, v21
    v_rcp_f32 v23, v23
    v_pk_mul_f32 v[200:201], v[16:17], v[160:161]
    v_pk_mul_f32 v[202:203], v[18:19], v[162:163]
    v_pk_mul_f32 v[204:205], v[20:21], v[164:165]
    v_pk_mul_f32 v[206:207], v[22:23], v[166:167]
    v_pk_mul_f32 v[16:17], v[168:169], v[168:169]
    v_pk_mul_f32 v[18:19], v[170:171], v[170:171]
    v_pk_mul_f32 v[20:21], v[172:173], v[172:173]
    v_pk_mul_f32 v[22:23], v[174:175], v[174:175]
    v_pk_fma_f32 v[16:17], v[16:17], s[76:77], v[32:33]
    v_pk_fma_f32 v[18:19], v[18:19], s[76:77], v[32:33]
    v_pk_fma_f32 v[20:21], v[20:21], s[76:77], v[32:33]
    v_pk_fma_f32 v[22:23], v[22:23], s[76:77], v[32:33]
    v_pk_mul_f32 v[16:17], v[16:17], v[168:169]
    v_pk_mul_f32 v[18:19], v[18:19], v[170:171]
    v_pk_mul_f32 v[20:21], v[20:21], v[172:173]
    v_pk_mul_f32 v[22:23], v[22:23], v[174:175]
    v_exp_f32 v16, v16
    v_exp_f32 v18, v18
    v_exp_f32 v20, v20
    v_exp_f32 v22, v22
    v_exp_f32 v17, v17
    v_exp_f32 v19, v19
    v_exp_f32 v21, v21
    v_exp_f32 v23, v23
    v_pk_add_f32 v[16:17], v[16:17], 1.0 op_sel_hi:[1,0]
    v_pk_add_f32 v[18:19], v[18:19], 1.0 op_sel_hi:[1,0]
    v_pk_add_f32 v[20:21], v[20:21], 1.0 op_sel_hi:[1,0]
    v_pk_add_f32 v[22:23], v[22:23], 1.0 op_sel_hi:[1,0]
    v_rcp_f32 v16, v16
    v_rcp_f32 v18, v18
    v_rcp_f32 v20, v20
    v_rcp_f32 v22, v22
    v_rcp_f32 v17, v17
    v_rcp_f32 v19, v19
    v_rcp_f32 v21, v21
    v_rcp_f32 v23, v23
    v_pk_mul_f32 v[208:209], v[16:17], v[168:169]
    v_pk_mul_f32 v[210:211], v[18:19], v[170:171]
    v_pk_mul_f32 v[212:213], v[20:21], v[172:173]
    v_pk_mul_f32 v[214:215], v[22:23], v[174:175]
    v_pk_mul_f32 v[16:17], v[176:177], v[176:177]
    v_pk_mul_f32 v[18:19], v[178:179], v[178:179]
    v_pk_mul_f32 v[20:21], v[180:181], v[180:181]
    v_pk_mul_f32 v[22:23], v[182:183], v[182:183]
    v_pk_fma_f32 v[16:17], v[16:17], s[76:77], v[32:33]
    v_pk_fma_f32 v[18:19], v[18:19], s[76:77], v[32:33]
    v_pk_fma_f32 v[20:21], v[20:21], s[76:77], v[32:33]
    v_pk_fma_f32 v[22:23], v[22:23], s[76:77], v[32:33]
    v_pk_mul_f32 v[16:17], v[16:17], v[176:177]
    v_pk_mul_f32 v[18:19], v[18:19], v[178:179]
    v_pk_mul_f32 v[20:21], v[20:21], v[180:181]
    v_pk_mul_f32 v[22:23], v[22:23], v[182:183]
    v_exp_f32 v16, v16
    v_exp_f32 v18, v18
    v_exp_f32 v20, v20
    v_exp_f32 v22, v22
    v_exp_f32 v17, v17
    v_exp_f32 v19, v19
    v_exp_f32 v21, v21
    v_exp_f32 v23, v23
    v_pk_add_f32 v[16:17], v[16:17], 1.0 op_sel_hi:[1,0]
    v_pk_add_f32 v[18:19], v[18:19], 1.0 op_sel_hi:[1,0]
    v_pk_add_f32 v[20:21], v[20:21], 1.0 op_sel_hi:[1,0]
    v_pk_add_f32 v[22:23], v[22:23], 1.0 op_sel_hi:[1,0]
    v_rcp_f32 v16, v16
    v_rcp_f32 v18, v18
    v_rcp_f32 v20, v20
    v_rcp_f32 v22, v22
    v_rcp_f32 v17, v17
    v_rcp_f32 v19, v19
    v_rcp_f32 v21, v21
    v_rcp_f32 v23, v23
    v_pk_mul_f32 v[216:217], v[16:17], v[176:177]
    v_pk_mul_f32 v[218:219], v[18:19], v[178:179]
    v_pk_mul_f32 v[220:221], v[20:21], v[180:181]
    v_pk_mul_f32 v[222:223], v[22:23], v[182:183]
    s_cmp_eq_u32 s68, 1
    s_cbranch_scc1 L_g4
    v_pk_mul_f32 v[16:17], v[184:185], v[184:185]
    v_pk_mul_f32 v[18:19], v[186:187], v[186:187]
    v_pk_mul_f32 v[20:21], v[188:189], v[188:189]
    v_pk_mul_f32 v[22:23], v[190:191], v[190:191]
    v_pk_fma_f32 v[16:17], v[16:17], s[76:77], v[32:33]
    v_pk_fma_f32 v[18:19], v[18:19], s[76:77], v[32:33]
    v_pk_fma_f32 v[20:21], v[20:21], s[76:77], v[32:33]
    v_pk_fma_f32 v[22:23], v[22:23], s[76:77], v[32:33]
    v_pk_mul_f32 v[16:17], v[16:17], v[184:185]
    v_pk_mul_f32 v[18:19], v[18:19], v[186:187]
    v_pk_mul_f32 v[20:21], v[20:21], v[188:189]
    v_pk_mul_f32 v[22:23], v[22:23], v[190:191]
    v_exp_f32 v16, v16
    v_exp_f32 v18, v18
    v_exp_f32 v20, v20
    v_exp_f32 v22, v22
    v_exp_f32 v17, v17
    v_exp_f32 v19, v19
    v_exp_f32 v21, v21
    v_exp_f32 v23, v23
    v_pk_add_f32 v[16:17], v[16:17], 1.0 op_sel_hi:[1,0]
    v_pk_add_f32 v[18:19], v[18:19], 1.0 op_sel_hi:[1,0]
    v_pk_add_f32 v[20:21], v[20:21], 1.0 op_sel_hi:[1,0]
    v_pk_add_f32 v[22:23], v[22:23], 1.0 op_sel_hi:[1,0]
    v_rcp_f32 v16, v16
    v_rcp_f32 v18, v18
    v_rcp_f32 v20, v20
    v_rcp_f32 v22, v22
    v_rcp_f32 v17, v17
    v_rcp_f32 v19, v19
    v_rcp_f32 v21, v21
    v_rcp_f32 v23, v23
    v_pk_mul_f32 v[224:225], v[16:17], v[184:185]
    v_pk_mul_f32 v[226:227], v[18:19], v[186:187]
    v_pk_mul_f32 v[228:229], v[20:21], v[188:189]
    v_pk_mul_f32 v[230:231], v[22:23], v[190:191]
L_g4:
    v_lshlrev_b32 v34, 16, v34
    v_lshlrev_b32 v36, 16, v36
    v_mov_b32 v35, v34
    v_mov_b32 v37, v36
    v_lshlrev_b32 v11, 4, v1
    s_mul_i32 s78, s68, 5120
    v_add_u32 v10, s78, v11
    v_add_u32 v11, 4096, v11
    v_add_u32 v8, 81920, v8
    v_add_u32 v9, 81920, v9
    s_mov_b32 s73, 0
    s_mov_b32 s72, 0
    s_waitcnt vmcnt(12)
    v_min_u32 v4, 8, v1
    v_lshlrev_b32 v4, 7, v4
    s_and_b32 s78, s4, 7
    s_lshl_b32 s78, s78, 2
    s_add_u32 s78, s78, s66
    s_mul_i32 s71, s78, 1152
    s_mul_i32 s80, s5, 589824
    s_add_u32 s71, s71, s80
    s_add_u32 s71, s71, 4194304
    s_min_u32 s80, s5, 4
    s_mul_i32 s80, s80, 221184
    s_mul_i32 s78, s78, 6912
    s_add_u32 s83, s80, s78
    s_add_u32 s83, s83, 15597568
    v_min_u32 v7, 53, v1
    v_lshlrev_b32 v7, 7, v7
    v_lshlrev_b32 v24, 4, v1
    v_lshlrev_b32 v25, 3, v1
    s_mul_i32 s78, s4, 6
    s_add_u32 s78, s78, s5
    s_mul_i32 s78, s78, 18432
    s_mul_i32 s80, s67, 9216
    s_mul_i32 s81, s68, 5120
    s_add_u32 s80, s80, s81
    s_add_u32 s78, s78, s80
    s_add_u32 s78, s78, 8388608
    s_add_u32 s80, s80, 49152
    v_add_u32 v26, s80, v24
    v_add_u32 v27, s80, v25
    s_add_u32 s80, s78, 4096
    s_cmp_eq_u32 s68, 0
    s_cbranch_scc1 L_p2five
    v_add_u32 v12, s72, v8
    v_add_u32 v13, s72, v9
    v_add_u32 v14, s73, v10
    v_add_u32 v15, s73, v11
    s_add_u32 s72, s72, 8192
    s_cmp_ge_u32 s72, 65536
    s_cselect_b32 s72, 0, s72
    s_add_u32 s73, s73, 18432
    s_cmp_ge_u32 s73, 73728
    s_cselect_b32 s73, 0, s73
    s_barrier
    ds_read_b128 v[40:43], v12 offset:0
    ds_read_b128 v[44:47], v12 offset:2048
    ds_read_b128 v[48:51], v14 offset:0
    ds_read_b128 v[52:55], v14 offset:1024
    ds_read_b128 v[56:59], v14 offset:2048
    ds_read_b128 v[60:63], v14 offset:3072
    ds_read_b128 v[68:71], v13 offset:0
    ds_read_b128 v[72:75], v13 offset:2048
    ds_read_b128 v[76:79], v14 offset:9216
    ds_read_b128 v[80:83], v14 offset:10240
    ds_read_b128 v[84:87], v14 offset:11264
    ds_read_b128 v[88:91], v14 offset:12288
    v_add_u32 v12, s72, v8
    v_add_u32 v13, s72, v9
    v_add_u32 v14, s73, v10
    v_add_u32 v15, s73, v11
    s_add_u32 s72, s72, 8192
    s_cmp_ge_u32 s72, 65536
    s_cselect_b32 s72, 0, s72
    s_add_u32 s73, s73, 18432
    s_cmp_ge_u32 s73, 73728
    s_cselect_b32 s73, 0, s73
    s_waitcnt lgkmcnt(0)
    s_barrier
    v_mfma_f32_16x16x32_bf16 v[152:155], v[48:51], v[40:43], 0
    ds_read_b128 v[96:99], v12 offset:0
    v_mfma_f32_16x16x32_bf16 v[156:159], v[48:51], v[44:47], 0
    ds_read_b128 v[100:103], v12 offset:2048
    v_mfma_f32_16x16x32_bf16 v[160:163], v[52:55], v[40:43], 0
    ds_read_b128 v[104:107], v14 offset:0
    v_mfma_f32_16x16x32_bf16 v[164:167], v[52:55], v[44:47], 0
    ds_read_b128 v[108:111], v14 offset:1024
    v_mfma_f32_16x16x32_bf16 v[168:171], v[56:59], v[40:43], 0
    ds_read_b128 v[112:115], v14 offset:2048
    v_mfma_f32_16x16x32_bf16 v[172:175], v[56:59], v[44:47], 0
    ds_read_b128 v[116:119], v14 offset:3072
    v_mfma_f32_16x16x32_bf16 v[176:179], v[60:63], v[40:43], 0
    ds_read_b128 v[124:127], v13 offset:0
    v_mfma_f32_16x16x32_bf16 v[180:183], v[60:63], v[44:47], 0
    ds_read_b128 v[128:131], v13 offset:2048
    v_mfma_f32_16x16x32_bf16 v[152:155], v[76:79], v[68:71], v[152:155]
    ds_read_b128 v[132:135], v14 offset:9216
    v_mfma_f32_16x16x32_bf16 v[156:159], v[76:79], v[72:75], v[156:159]
    ds_read_b128 v[136:139], v14 offset:10240
    v_mfma_f32_16x16x32_bf16 v[160:163], v[80:83], v[68:71], v[160:163]
    ds_read_b128 v[140:143], v14 offset:11264
    v_mfma_f32_16x16x32_bf16 v[164:167], v[80:83], v[72:75], v[164:167]
    ds_read_b128 v[144:147], v14 offset:12288
    v_mfma_f32_16x16x32_bf16 v[168:171], v[84:87], v[68:71], v[168:171]
    v_add_u32 v12, s72, v8
    v_add_u32 v13, s72, v9
    v_mfma_f32_16x16x32_bf16 v[172:175], v[84:87], v[72:75], v[172:175]
    v_add_u32 v14, s73, v10
    v_add_u32 v15, s73, v11
    v_mfma_f32_16x16x32_bf16 v[176:179], v[88:91], v[68:71], v[176:179]
    s_add_u32 s72, s72, 8192
    s_cmp_ge_u32 s72, 65536
    v_mfma_f32_16x16x32_bf16 v[180:183], v[88:91], v[72:75], v[180:183]
    s_cselect_b32 s72, 0, s72
    s_add_u32 s73, s73, 18432
    s_cmp_ge_u32 s73, 73728
    s_cselect_b32 s73, 0, s73
    s_mov_b32 s74, 15
    s_waitcnt lgkmcnt(0)
    s_waitcnt vmcnt(0)
Lcp2_44:
    s_barrier
    v_mfma_f32_16x16x32_bf16 v[152:155], v[104:107], v[96:99], v[152:155]
    ds_read_b128 v[40:43], v12 offset:0
    v_mfma_f32_16x16x32_bf16 v[156:159], v[104:107], v[100:103], v[156:159]
    ds_read_b128 v[44:47], v12 offset:2048
    v_mfma_f32_16x16x32_bf16 v[160:163], v[108:111], v[96:99], v[160:163]
    ds_read_b128 v[48:51], v14 offset:0
    v_mfma_f32_16x16x32_bf16 v[164:167], v[108:111], v[100:103], v[164:167]
    ds_read_b128 v[52:55], v14 offset:1024
    v_mfma_f32_16x16x32_bf16 v[168:171], v[112:115], v[96:99], v[168:171]
    ds_read_b128 v[56:59], v14 offset:2048
    v_mfma_f32_16x16x32_bf16 v[172:175], v[112:115], v[100:103], v[172:175]
    ds_read_b128 v[60:63], v14 offset:3072
    v_mfma_f32_16x16x32_bf16 v[176:179], v[116:119], v[96:99], v[176:179]
    ds_read_b128 v[68:71], v13 offset:0
    v_mfma_f32_16x16x32_bf16 v[180:183], v[116:119], v[100:103], v[180:183]
    ds_read_b128 v[72:75], v13 offset:2048
    v_mfma_f32_16x16x32_bf16 v[152:155], v[132:135], v[124:127], v[152:155]
    ds_read_b128 v[76:79], v14 offset:9216
    v_mfma_f32_16x16x32_bf16 v[156:159], v[132:135], v[128:131], v[156:159]
    ds_read_b128 v[80:83], v14 offset:10240
    v_mfma_f32_16x16x32_bf16 v[160:163], v[136:139], v[124:127], v[160:163]
    ds_read_b128 v[84:87], v14 offset:11264
    v_mfma_f32_16x16x32_bf16 v[164:167], v[136:139], v[128:131], v[164:167]
    ds_read_b128 v[88:91], v14 offset:12288
    v_mfma_f32_16x16x32_bf16 v[168:171], v[140:143], v[124:127], v[168:171]
    v_add_u32 v12, s72, v8
    v_add_u32 v13, s72, v9
    v_mfma_f32_16x16x32_bf16 v[172:175], v[140:143], v[128:131], v[172:175]
    v_add_u32 v14, s73, v10
    v_add_u32 v15, s73, v11
    v_mfma_f32_16x16x32_bf16 v[176:179], v[144:147], v[124:127], v[176:179]
    s_add_u32 s72, s72, 8192
    s_cmp_ge_u32 s72, 65536
    v_mfma_f32_16x16x32_bf16 v[180:183], v[144:147], v[128:131], v[180:183]
    s_cselect_b32 s72, 0, s72
    s_add_u32 s73, s73, 18432
    s_cmp_ge_u32 s73, 73728
    s_cselect_b32 s73, 0, s73
    s_waitcnt lgkmcnt(0)
    s_barrier
    v_mfma_f32_16x16x32_bf16 v[152:155], v[48:51], v[40:43], v[152:155]
    ds_read_b128 v[96:99], v12 offset:0
    v_mfma_f32_16x16x32_bf16 v[156:159], v[48:51], v[44:47], v[156:159]
    ds_read_b128 v[100:103], v12 offset:2048
    v_mfma_f32_16x16x32_bf16 v[160:163], v[52:55], v[40:43], v[160:163]
    ds_read_b128 v[104:107], v14 offset:0
    v_mfma_f32_16x16x32_bf16 v[164:167], v[52:55], v[44:47], v[164:167]
    ds_read_b128 v[108:111], v14 offset:1024
    v_mfma_f32_16x16x32_bf16 v[168:171], v[56:59], v[40:43], v[168:171]
    ds_read_b128 v[112:115], v14 offset:2048
    v_mfma_f32_16x16x32_bf16 v[172:175], v[56:59], v[44:47], v[172:175]
    ds_read_b128 v[116:119], v14 offset:3072
    v_mfma_f32_16x16x32_bf16 v[176:179], v[60:63], v[40:43], v[176:179]
    ds_read_b128 v[124:127], v13 offset:0
    v_mfma_f32_16x16x32_bf16 v[180:183], v[60:63], v[44:47], v[180:183]
    ds_read_b128 v[128:131], v13 offset:2048
    v_mfma_f32_16x16x32_bf16 v[152:155], v[76:79], v[68:71], v[152:155]
    ds_read_b128 v[132:135], v14 offset:9216
    v_mfma_f32_16x16x32_bf16 v[156:159], v[76:79], v[72:75], v[156:159]
    ds_read_b128 v[136:139], v14 offset:10240
    v_mfma_f32_16x16x32_bf16 v[160:163], v[80:83], v[68:71], v[160:163]
    ds_read_b128 v[140:143], v14 offset:11264
    v_mfma_f32_16x16x32_bf16 v[164:167], v[80:83], v[72:75], v[164:167]
    ds_read_b128 v[144:147], v14 offset:12288
    v_mfma_f32_16x16x32_bf16 v[168:171], v[84:87], v[68:71], v[168:171]
    v_add_u32 v12, s72, v8
    v_add_u32 v13, s72, v9
    v_mfma_f32_16x16x32_bf16 v[172:175], v[84:87], v[72:75], v[172:175]
    v_add_u32 v14, s73, v10
    v_add_u32 v15, s73, v11
    v_mfma_f32_16x16x32_bf16 v[176:179], v[88:91], v[68:71], v[176:179]
    s_add_u32 s72, s72, 8192
    s_cmp_ge_u32 s72, 65536
    v_mfma_f32_16x16x32_bf16 v[180:183], v[88:91], v[72:75], v[180:183]
    s_cselect_b32 s72, 0, s72
    s_add_u32 s73, s73, 18432
    s_cmp_ge_u32 s73, 73728
    s_cselect_b32 s73, 0, s73
    s_sub_u32 s74, s74, 1
    s_cmp_lg_u32 s74, 0
    s_waitcnt lgkmcnt(0)
    s_cbranch_scc1 Lcp2_44
    s_branch L_p2join
L_p2five:
    v_add_u32 v12, s72, v8
    v_add_u32 v13, s72, v9
    v_add_u32 v14, s73, v10
    v_add_u32 v15, s73, v11
    s_add_u32 s72, s72, 8192
    s_cmp_ge_u32 s72, 65536
    s_cselect_b32 s72, 0, s72
    s_add_u32 s73, s73, 18432
    s_cmp_ge_u32 s73, 73728
    s_cselect_b32 s73, 0, s73
    s_barrier
    ds_read_b128 v[40:43], v12 offset:0
    ds_read_b128 v[44:47], v12 offset:2048
    ds_read_b128 v[48:51], v14 offset:0
    ds_read_b128 v[52:55], v14 offset:1024
    ds_read_b128 v[56:59], v14 offset:2048
    ds_read_b128 v[60:63], v14 offset:3072
    ds_read_b128 v[64:67], v15 offset:0
    ds_read_b128 v[68:71], v13 offset:0
    ds_read_b128 v[72:75], v13 offset:2048
    ds_read_b128 v[76:79], v14 offset:9216
    ds_read_b128 v[80:83], v14 offset:10240
    ds_read_b128 v[84:87], v14 offset:11264
    ds_read_b128 v[88:91], v14 offset:12288
    ds_read_b128 v[92:95], v15 offset:9216
    v_add_u32 v12, s72, v8
    v_add_u32 v13, s72, v9
    v_add_u32 v14, s73, v10
    v_add_u32 v15, s73, v11
    s_add_u32 s72, s72, 8192
    s_cmp_ge_u32 s72, 65536
    s_cselect_b32 s72, 0, s72
    s_add_u32 s73, s73, 18432
    s_cmp_ge_u32 s73, 73728
    s_cselect_b32 s73, 0, s73
    s_waitcnt lgkmcnt(0)
    s_barrier
    v_mfma_f32_16x16x32_bf16 v[152:155], v[48:51], v[40:43], 0
    ds_read_b128 v[96:99], v12 offset:0
    v_mfma_f32_16x16x32_bf16 v[156:159], v[48:51], v[44:47], 0
    ds_read_b128 v[100:103], v12 offset:2048
    v_mfma_f32_16x16x32_bf16 v[160:163], v[52:55], v[40:43], 0
    ds_read_b128 v[104:107], v14 offset:0
    v_mfma_f32_16x16x32_bf16 v[164:167], v[52:55], v[44:47], 0
    ds_read_b128 v[108:111], v14 offset:1024
    v_mfma_f32_16x16x32_bf16 v[168:171], v[56:59], v[40:43], 0
    ds_read_b128 v[112:115], v14 offset:2048
    v_mfma_f32_16x16x32_bf16 v[172:175], v[56:59], v[44:47], 0
    ds_read_b128 v[116:119], v14 offset:3072
    v_mfma_f32_16x16x32_bf16 v[176:179], v[60:63], v[40:43], 0
    ds_read_b128 v[120:123], v15 offset:0
    v_mfma_f32_16x16x32_bf16 v[180:183], v[60:63], v[44:47], 0
    ds_read_b128 v[124:127], v13 offset:0
    v_mfma_f32_16x16x32_bf16 v[184:187], v[64:67], v[40:43], 0
    ds_read_b128 v[128:131], v13 offset:2048
    v_mfma_f32_16x16x32_bf16 v[188:191], v[64:67], v[44:47], 0
    ds_read_b128 v[132:135], v14 offset:9216
    v_mfma_f32_16x16x32_bf16 v[152:155], v[76:79], v[68:71], v[152:155]
    ds_read_b128 v[136:139], v14 offset:10240
    v_mfma_f32_16x16x32_bf16 v[156:159], v[76:79], v[72:75], v[156:159]
    ds_read_b128 v[140:143], v14 offset:11264
    v_mfma_f32_16x16x32_bf16 v[160:163], v[80:83], v[68:71], v[160:163]
    ds_read_b128 v[144:147], v14 offset:12288
    v_mfma_f32_16x16x32_bf16 v[164:167], v[80:83], v[72:75], v[164:167]
    ds_read_b128 v[148:151], v15 offset:9216
    v_mfma_f32_16x16x32_bf16 v[168:171], v[84:87], v[68:71], v[168:171]
    v_add_u32 v12, s72, v8
    v_add_u32 v13, s72, v9
    v_mfma_f32_16x16x32_bf16 v[172:175], v[84:87], v[72:75], v[172:175]
    v_add_u32 v14, s73, v10
    v_add_u32 v15, s73, v11
    v_mfma_f32_16x16x32_bf16 v[176:179], v[88:91], v[68:71], v[176:179]
    s_add_u32 s72, s72, 8192
    s_cmp_ge_u32 s72, 65536
    v_mfma_f32_16x16x32_bf16 v[180:183], v[88:91], v[72:75], v[180:183]
    s_cselect_b32 s72, 0, s72
    s_add_u32 s73, s73, 18432
    v_mfma_f32_16x16x32_bf16 v[184:187], v[92:95], v[68:71], v[184:187]
    s_cmp_ge_u32 s73, 73728
    s_cselect_b32 s73, 0, s73
    v_mfma_f32_16x16x32_bf16 v[188:191], v[92:95], v[72:75], v[188:191]
    s_mov_b32 s74, 15
    s_waitcnt lgkmcnt(0)
    s_waitcnt vmcnt(0)
Lcp2_45:
    s_barrier
    v_mfma_f32_16x16x32_bf16 v[152:155], v[104:107], v[96:99], v[152:155]
    ds_read_b128 v[40:43], v12 offset:0
    v_mfma_f32_16x16x32_bf16 v[156:159], v[104:107], v[100:103], v[156:159]
    ds_read_b128 v[44:47], v12 offset:2048
    v_mfma_f32_16x16x32_bf16 v[160:163], v[108:111], v[96:99], v[160:163]
    ds_read_b128 v[48:51], v14 offset:0
    v_mfma_f32_16x16x32_bf16 v[164:167], v[108:111], v[100:103], v[164:167]
    ds_read_b128 v[52:55], v14 offset:1024
    v_mfma_f32_16x16x32_bf16 v[168:171], v[112:115], v[96:99], v[168:171]
    ds_read_b128 v[56:59], v14 offset:2048
    v_mfma_f32_16x16x32_bf16 v[172:175], v[112:115], v[100:103], v[172:175]
    ds_read_b128 v[60:63], v14 offset:3072
    v_mfma_f32_16x16x32_bf16 v[176:179], v[116:119], v[96:99], v[176:179]
    ds_read_b128 v[64:67], v15 offset:0
    v_mfma_f32_16x16x32_bf16 v[180:183], v[116:119], v[100:103], v[180:183]
    ds_read_b128 v[68:71], v13 offset:0
    v_mfma_f32_16x16x32_bf16 v[184:187], v[120:123], v[96:99], v[184:187]
    ds_read_b128 v[72:75], v13 offset:2048
    v_mfma_f32_16x16x32_bf16 v[188:191], v[120:123], v[100:103], v[188:191]
    ds_read_b128 v[76:79], v14 offset:9216
    v_mfma_f32_16x16x32_bf16 v[152:155], v[132:135], v[124:127], v[152:155]
    ds_read_b128 v[80:83], v14 offset:10240
    v_mfma_f32_16x16x32_bf16 v[156:159], v[132:135], v[128:131], v[156:159]
    ds_read_b128 v[84:87], v14 offset:11264
    v_mfma_f32_16x16x32_bf16 v[160:163], v[136:139], v[124:127], v[160:163]
    ds_read_b128 v[88:91], v14 offset:12288
    v_mfma_f32_16x16x32_bf16 v[164:167], v[136:139], v[128:131], v[164:167]
    ds_read_b128 v[92:95], v15 offset:9216
    v_mfma_f32_16x16x32_bf16 v[168:171], v[140:143], v[124:127], v[168:171]
    v_add_u32 v12, s72, v8
    v_add_u32 v13, s72, v9
    v_mfma_f32_16x16x32_bf16 v[172:175], v[140:143], v[128:131], v[172:175]
    v_add_u32 v14, s73, v10
    v_add_u32 v15, s73, v11
    v_mfma_f32_16x16x32_bf16 v[176:179], v[144:147], v[124:127], v[176:179]
    s_add_u32 s72, s72, 8192
    s_cmp_ge_u32 s72, 65536
    v_mfma_f32_16x16x32_bf16 v[180:183], v[144:147], v[128:131], v[180:183]
    s_cselect_b32 s72, 0, s72
    s_add_u32 s73, s73, 18432
    v_mfma_f32_16x16x32_bf16 v[184:187], v[148:151], v[124:127], v[184:187]
    s_cmp_ge_u32 s73, 73728
    s_cselect_b32 s73, 0, s73
    v_mfma_f32_16x16x32_bf16 v[188:191], v[148:151], v[128:131], v[188:191]
    s_waitcnt lgkmcnt(0)
    s_barrier
    v_mfma_f32_16x16x32_bf16 v[152:155], v[48:51], v[40:43], v[152:155]
    ds_read_b128 v[96:99], v12 offset:0
    v_mfma_f32_16x16x32_bf16 v[156:159], v[48:51], v[44:47], v[156:159]
    ds_read_b128 v[100:103], v12 offset:2048
    v_mfma_f32_16x16x32_bf16 v[160:163], v[52:55], v[40:43], v[160:163]
    ds_read_b128 v[104:107], v14 offset:0
    v_mfma_f32_16x16x32_bf16 v[164:167], v[52:55], v[44:47], v[164:167]
    ds_read_b128 v[108:111], v14 offset:1024
    v_mfma_f32_16x16x32_bf16 v[168:171], v[56:59], v[40:43], v[168:171]
    ds_read_b128 v[112:115], v14 offset:2048
    v_mfma_f32_16x16x32_bf16 v[172:175], v[56:59], v[44:47], v[172:175]
    ds_read_b128 v[116:119], v14 offset:3072
    v_mfma_f32_16x16x32_bf16 v[176:179], v[60:63], v[40:43], v[176:179]
    ds_read_b128 v[120:123], v15 offset:0
    v_mfma_f32_16x16x32_bf16 v[180:183], v[60:63], v[44:47], v[180:183]
    ds_read_b128 v[124:127], v13 offset:0
    v_mfma_f32_16x16x32_bf16 v[184:187], v[64:67], v[40:43], v[184:187]
    ds_read_b128 v[128:131], v13 offset:2048
    v_mfma_f32_16x16x32_bf16 v[188:191], v[64:67], v[44:47], v[188:191]
    ds_read_b128 v[132:135], v14 offset:9216
    v_mfma_f32_16x16x32_bf16 v[152:155], v[76:79], v[68:71], v[152:155]
    ds_read_b128 v[136:139], v14 offset:10240
    v_mfma_f32_16x16x32_bf16 v[156:159], v[76:79], v[72:75], v[156:159]
    ds_read_b128 v[140:143], v14 offset:11264
    v_mfma_f32_16x16x32_bf16 v[160:163], v[80:83], v[68:71], v[160:163]
    ds_read_b128 v[144:147], v14 offset:12288
    v_mfma_f32_16x16x32_bf16 v[164:167], v[80:83], v[72:75], v[164:167]
    ds_read_b128 v[148:151], v15 offset:9216
    v_mfma_f32_16x16x32_bf16 v[168:171], v[84:87], v[68:71], v[168:171]
    v_add_u32 v12, s72, v8
    v_add_u32 v13, s72, v9
    v_mfma_f32_16x16x32_bf16 v[172:175], v[84:87], v[72:75], v[172:175]
    v_add_u32 v14, s73, v10
    v_add_u32 v15, s73, v11
    v_mfma_f32_16x16x32_bf16 v[176:179], v[88:91], v[68:71], v[176:179]
    s_add_u32 s72, s72, 8192
    s_cmp_ge_u32 s72, 65536
    v_mfma_f32_16x16x32_bf16 v[180:183], v[88:91], v[72:75], v[180:183]
    s_cselect_b32 s72, 0, s72
    s_add_u32 s73, s73, 18432
    v_mfma_f32_16x16x32_bf16 v[184:187], v[92:95], v[68:71], v[184:187]
    s_cmp_ge_u32 s73, 73728
    s_cselect_b32 s73, 0, s73
    v_mfma_f32_16x16x32_bf16 v[188:191], v[92:95], v[72:75], v[188:191]
    s_sub_u32 s74, s74, 1
    s_cmp_lg_u32 s74, 0
    s_waitcnt lgkmcnt(0)
    s_cbranch_scc1 Lcp2_45
L_p2join:
    s_barrier
    s_nop 0
    v_mfma_f32_16x16x32_bf16 v[152:155], v[104:107], v[96:99], v[152:155]
    v_mfma_f32_16x16x32_bf16 v[156:159], v[104:107], v[100:103], v[156:159]
    v_mfma_f32_16x16x32_bf16 v[152:155], v[132:135], v[124:127], v[152:155]
    v_mfma_f32_16x16x32_bf16 v[156:159], v[132:135], v[128:131], v[156:159]
    v_mfma_f32_16x16x32_bf16 v[160:163], v[108:111], v[96:99], v[160:163]
    v_mfma_f32_16x16x32_bf16 v[164:167], v[108:111], v[100:103], v[164:167]
    v_mfma_f32_16x16x32_bf16 v[160:163], v[136:139], v[124:127], v[160:163]
    v_mfma_f32_16x16x32_bf16 v[164:167], v[136:139], v[128:131], v[164:167]
    v_mfma_f32_16x16x32_bf16 v[168:171], v[112:115], v[96:99], v[168:171]
    v_mfma_f32_16x16x32_bf16 v[172:175], v[112:115], v[100:103], v[172:175]
    v_mfma_f32_16x16x32_bf16 v[168:171], v[140:143], v[124:127], v[168:171]
    v_pk_add_f32 v[152:153], v[152:153], v[34:35]
    v_pk_add_f32 v[154:155], v[154:155], v[34:35]
    v_mfma_f32_16x16x32_bf16 v[172:175], v[140:143], v[128:131], v[172:175]
    s_nop 0
    s_nop 0
    v_pk_add_f32 v[160:161], v[160:161], v[34:35]
    v_pk_add_f32 v[162:163], v[162:163], v[34:35]
    v_mfma_f32_16x16x32_bf16 v[176:179], v[116:119], v[96:99], v[176:179]
    v_pk_mul_f32 v[152:153], v[152:153], v[192:193]
    v_pk_mul_f32 v[154:155], v[154:155], v[194:195]
    v_mfma_f32_16x16x32_bf16 v[180:183], v[116:119], v[100:103], v[180:183]
    v_pk_mul_f32 v[160:161], v[160:161], v[200:201]
    v_pk_mul_f32 v[162:163], v[162:163], v[202:203]
    v_mfma_f32_16x16x32_bf16 v[176:179], v[144:147], v[124:127], v[176:179]
    v_cvt_pk_bf16_f32 v40, v152, v153
    v_cvt_pk_bf16_f32 v41, v154, v155
    v_cvt_pk_bf16_f32 v42, v160, v161
    v_cvt_pk_bf16_f32 v43, v162, v163
    buffer_store_dwordx4 v[40:43], v24, s[28:31], s78 offen offset:0 sc1
    ds_write_b128 v26, v[40:43] offset:0
    v_mfma_f32_16x16x32_bf16 v[180:183], v[144:147], v[128:131], v[180:183]
    v_pk_add_f32 v[156:157], v[156:157], v[36:37]
    v_pk_add_f32 v[158:159], v[158:159], v[36:37]
    v_mfma_f32_16x16x32_bf16 v[184:187], v[120:123], v[96:99], v[184:187]
    v_pk_add_f32 v[164:165], v[164:165], v[36:37]
    v_pk_add_f32 v[166:167], v[166:167], v[36:37]
    v_mfma_f32_16x16x32_bf16 v[188:191], v[120:123], v[100:103], v[188:191]
    v_pk_mul_f32 v[156:157], v[156:157], v[196:197]
    v_pk_mul_f32 v[158:159], v[158:159], v[198:199]
    v_mfma_f32_16x16x32_bf16 v[184:187], v[148:151], v[124:127], v[184:187]
    v_pk_mul_f32 v[164:165], v[164:165], v[204:205]
    v_pk_mul_f32 v[166:167], v[166:167], v[206:207]
    v_mfma_f32_16x16x32_bf16 v[188:191], v[148:151], v[128:131], v[188:191]
    v_cvt_pk_bf16_f32 v44, v156, v157
    v_cvt_pk_bf16_f32 v45, v158, v159
    v_cvt_pk_bf16_f32 v46, v164, v165
    v_cvt_pk_bf16_f32 v47, v166, v167
    buffer_store_dwordx4 v[44:47], v24, s[28:31], s78 offen offset:1024 sc1
    ds_write_b128 v26, v[44:47] offset:1024
    v_pk_add_f32 v[168:169], v[168:169], v[34:35]
    v_pk_add_f32 v[170:171], v[170:171], v[34:35]
    v_pk_add_f32 v[176:177], v[176:177], v[34:35]
    v_pk_add_f32 v[178:179], v[178:179], v[34:35]
    v_pk_mul_f32 v[168:169], v[168:169], v[208:209]
    v_pk_mul_f32 v[170:171], v[170:171], v[210:211]
    v_pk_mul_f32 v[176:177], v[176:177], v[216:217]
    v_pk_mul_f32 v[178:179], v[178:179], v[218:219]
    v_cvt_pk_bf16_f32 v48, v168, v169
    v_cvt_pk_bf16_f32 v49, v170, v171
    v_cvt_pk_bf16_f32 v50, v176, v177
    v_cvt_pk_bf16_f32 v51, v178, v179
    buffer_store_dwordx4 v[48:51], v24, s[28:31], s78 offen offset:2048 sc1
    ds_write_b128 v26, v[48:51] offset:2048
    v_pk_add_f32 v[172:173], v[172:173], v[36:37]
    v_pk_add_f32 v[174:175], v[174:175], v[36:37]
    v_pk_add_f32 v[180:181], v[180:181], v[36:37]
    v_pk_add_f32 v[182:183], v[182:183], v[36:37]
    v_pk_mul_f32 v[172:173], v[172:173], v[212:213]
    v_pk_mul_f32 v[174:175], v[174:175], v[214:215]
    v_pk_mul_f32 v[180:181], v[180:181], v[220:221]
    v_pk_mul_f32 v[182:183], v[182:183], v[222:223]
    v_cvt_pk_bf16_f32 v52, v172, v173
    v_cvt_pk_bf16_f32 v53, v174, v175
    v_cvt_pk_bf16_f32 v54, v180, v181
    v_cvt_pk_bf16_f32 v55, v182, v183
    buffer_store_dwordx4 v[52:55], v24, s[28:31], s78 offen offset:3072 sc1
    ds_write_b128 v26, v[52:55] offset:3072
    s_cmp_eq_u32 s68, 1
    s_cbranch_scc1 Lh4_46
    v_pk_add_f32 v[184:185], v[184:185], v[34:35]
    v_pk_add_f32 v[186:187], v[186:187], v[34:35]
    v_pk_add_f32 v[188:189], v[188:189], v[36:37]
    v_pk_add_f32 v[190:191], v[190:191], v[36:37]
    v_pk_mul_f32 v[184:185], v[184:185], v[224:225]
    v_pk_mul_f32 v[186:187], v[186:187], v[226:227]
    v_pk_mul_f32 v[188:189], v[188:189], v[228:229]
    v_pk_mul_f32 v[190:191], v[190:191], v[230:231]
    v_cvt_pk_bf16_f32 v56, v184, v185
    v_cvt_pk_bf16_f32 v57, v186, v187
    v_cvt_pk_bf16_f32 v58, v188, v189
    v_cvt_pk_bf16_f32 v59, v190, v191
    buffer_store_dwordx2 v[56:57], v25, s[28:31], s80 offen offset:0 sc1
    ds_write_b64 v27, v[56:57] offset:4096
    buffer_store_dwordx2 v[58:59], v25, s[28:31], s80 offen offset:512 sc1
    ds_write_b64 v27, v[58:59] offset:4608
Lh4_46:
    s_waitcnt lgkmcnt(0)
    s_barrier
    s_lshl_b32 s79, s66, 12
    s_mov_b32 s81, s84
    s_add_u32 m0, s79, 32768
    s_nop 0
    buffer_load_dwordx4 v28, s[8:11], s91 offen offset:0 lds
    buffer_load_dwordx4 v29, s[8:11], s91 offen offset:1024 lds
    buffer_load_dwordx4 v30, s[8:11], s91 offen offset:2048 lds
    buffer_load_dwordx4 v31, s[8:11], s91 offen offset:3072 lds
    s_waitcnt vmcnt(4)
    v_mov_b32 v16, s6
    v_lshlrev_b32 v17, 2, v1
    s_mov_b32 exec_hi, 0
    buffer_store_dword v16, v17, s[28:31], s85 offen sc1
    s_mov_b64 exec, -1
    s_lshl_b32 s7, s68, 3
    s_sub_u32 s7, 39, s7
    v_min_u32 v20, s7, v1
    v_lshlrev_b32 v20, 7, v20
    buffer_load_dword v21, v20, s[28:31], s78 offen sc1
    s_waitcnt vmcnt(1)
    s_cmp_eq_u32 s5, 5
    s_cbranch_scc1 Lc5_47
    buffer_load_dword v19, v6, s[28:31], 0 offen sc1
    s_and_b32 s7, s2, 1
    s_mul_i32 s7, s7, 3
    s_lshl_b32 s92, 7, s7
    s_waitcnt vmcnt(0)
    v_cmp_ne_u32 vcc, s6, v19
    s_cbranch_vccz Lhall_48
    s_and_b32 s7, vcc_lo, s92
    s_cbranch_scc0 Lhj_50
    s_mov_b32 exec_lo, s92
    s_mov_b32 exec_hi, 0
    s_mov_b32 s82, 200000
Lpoll_51:
    buffer_load_dword v19, v6, s[28:31], 0 offen sc1
    s_waitcnt vmcnt(0)
    v_cmp_ne_u32 vcc, s6, v19
    s_cbranch_vccz Lpolld_52
    s_mov_b64 exec, vcc
    s_sleep 8
    s_sub_u32 s82, s82, 1
    s_cmp_lg_u32 s82, 0
    s_cbranch_scc1 Lpoll_51
Lpolld_52:
    s_mov_b64 exec, -1
Lhj_50:
    s_add_u32 m0, s93, 18432
    s_add_u32 s7, s94, s45
    buffer_load_dwordx4 v24, s[28:31], s7 offen offset:0 sc1 lds
    buffer_load_dwordx4 v24, s[28:31], s7 offen offset:1024 sc1 lds
    buffer_load_dwordx4 v24, s[28:31], s7 offen offset:2048 sc1 lds
    buffer_load_dwordx4 v24, s[28:31], s7 offen offset:3072 sc1 lds
    s_cmp_eq_u32 s68, 1
    s_cbranch_scc1 Lhk_53
    s_add_u32 m0, m0, 4096
    s_add_u32 s7, s7, 4096
    buffer_load_dwordx4 v24, s[28:31], s7 offen sc1 lds
Lhk_53:
    s_add_u32 m0, s93, 36864
    s_add_u32 s7, s94, s46
    buffer_load_dwordx4 v24, s[28:31], s7 offen offset:0 sc1 lds
    buffer_load_dwordx4 v24, s[28:31], s7 offen offset:1024 sc1 lds
    buffer_load_dwordx4 v24, s[28:31], s7 offen offset:2048 sc1 lds
    buffer_load_dwordx4 v24, s[28:31], s7 offen offset:3072 sc1 lds
    s_cmp_eq_u32 s68, 1
    s_cbranch_scc1 Lhk_54
    s_add_u32 m0, m0, 4096
    s_add_u32 s7, s7, 4096
    buffer_load_dwordx4 v24, s[28:31], s7 offen sc1 lds
Lhk_54:
    buffer_load_dword v19, v6, s[28:31], 0 offen sc1
    s_waitcnt vmcnt(0)
    s_barrier
    v_cmp_ne_u32 vcc, s6, v19
    s_cbranch_vccz Lhok_49
Lc5_47:
    s_mov_b32 s82, 200000
Lpoll_55:
    buffer_load_dword v19, v6, s[28:31], 0 offen sc1
    s_waitcnt vmcnt(0)
    v_cmp_ne_u32 vcc, s6, v19
    s_cbranch_vccz Lpolld_56
    s_mov_b64 exec, vcc
    s_sleep 8
    s_sub_u32 s82, s82, 1
    s_cmp_lg_u32 s82, 0
    s_cbranch_scc1 Lpoll_55
Lpolld_56:
    s_mov_b64 exec, -1
Lhok_49:
    s_add_u32 m0, s93, 55296
    s_add_u32 s7, s94, s47
    buffer_load_dwordx4 v24, s[28:31], s7 offen offset:0 sc1 lds
    buffer_load_dwordx4 v24, s[28:31], s7 offen offset:1024 sc1 lds
    buffer_load_dwordx4 v24, s[28:31], s7 offen offset:2048 sc1 lds
    buffer_load_dwordx4 v24, s[28:31], s7 offen offset:3072 sc1 lds
    s_cmp_eq_u32 s68, 1
    s_cbranch_scc1 Lhk_57
    s_add_u32 m0, m0, 4096
    s_add_u32 s7, s7, 4096
    buffer_load_dwordx4 v24, s[28:31], s7 offen sc1 lds
Lhk_57:
    s_cmp_eq_u32 s5, 5
    s_cbranch_scc1 L_end
    s_add_u32 m0, s93, 73728
    s_add_u32 s7, s94, s48
    buffer_load_dwordx4 v24, s[28:31], s7 offen offset:0 sc1 lds
    buffer_load_dwordx4 v24, s[28:31], s7 offen offset:1024 sc1 lds
    buffer_load_dwordx4 v24, s[28:31], s7 offen offset:2048 sc1 lds
    buffer_load_dwordx4 v24, s[28:31], s7 offen offset:3072 sc1 lds
    s_cmp_eq_u32 s68, 1
    s_cbranch_scc1 Lhk_58
    s_add_u32 m0, m0, 4096
    s_add_u32 s7, s7, 4096
    buffer_load_dwordx4 v24, s[28:31], s7 offen sc1 lds
Lhk_58:
    s_add_u32 m0, s93, 92160
    s_add_u32 s7, s94, s49
    buffer_load_dwordx4 v24, s[28:31], s7 offen offset:0 sc1 lds
    buffer_load_dwordx4 v24, s[28:31], s7 offen offset:1024 sc1 lds
    buffer_load_dwordx4 v24, s[28:31], s7 offen offset:2048 sc1 lds
    buffer_load_dwordx4 v24, s[28:31], s7 offen offset:3072 sc1 lds
    s_cmp_eq_u32 s68, 1
    s_cbranch_scc1 Lhk_59
    s_add_u32 m0, m0, 4096
    s_add_u32 s7, s7, 4096
    buffer_load_dwordx4 v24, s[28:31], s7 offen sc1 lds
Lhk_59:
    s_add_u32 m0, s79, 16384
    s_nop 0
    buffer_load_dwordx4 v24, s[28:31], s81 offen offset:0 sc1 lds
    buffer_load_dwordx4 v24, s[28:31], s81 offen offset:1024 sc1 lds
    buffer_load_dwordx4 v24, s[28:31], s81 offen offset:2048 sc1 lds
    buffer_load_dwordx4 v24, s[28:31], s81 offen offset:3072 sc1 lds
    s_waitcnt vmcnt(12)
    s_barrier
    s_waitcnt vmcnt(8)
    s_barrier
    s_waitcnt vmcnt(0)
    s_barrier
    s_branch L_end
Lhall_48:
    s_add_u32 m0, s93, 18432
    s_add_u32 s7, s94, s45
    buffer_load_dwordx4 v24, s[28:31], s7 offen offset:0 sc1 lds
    buffer_load_dwordx4 v24, s[28:31], s7 offen offset:1024 sc1 lds
    buffer_load_dwordx4 v24, s[28:31], s7 offen offset:2048 sc1 lds
    buffer_load_dwordx4 v24, s[28:31], s7 offen offset:3072 sc1 lds
    s_cmp_eq_u32 s68, 1
    s_cbranch_scc1 Lhk_60
    s_add_u32 m0, m0, 4096
    s_add_u32 s7, s7, 4096
    buffer_load_dwordx4 v24, s[28:31], s7 offen sc1 lds
Lhk_60:
    s_add_u32 m0, s93, 36864
    s_add_u32 s7, s94, s46
    buffer_load_dwordx4 v24, s[28:31], s7 offen offset:0 sc1 lds
    buffer_load_dwordx4 v24, s[28:31], s7 offen offset:1024 sc1 lds
    buffer_load_dwordx4 v24, s[28:31], s7 offen offset:2048 sc1 lds
    buffer_load_dwordx4 v24, s[28:31], s7 offen offset:3072 sc1 lds
    s_cmp_eq_u32 s68, 1
    s_cbranch_scc1 Lhk_61
    s_add_u32 m0, m0, 4096
    s_add_u32 s7, s7, 4096
    buffer_load_dwordx4 v24, s[28:31], s7 offen sc1 lds
Lhk_61:
    s_add_u32 m0, s93, 55296
    s_add_u32 s7, s94, s47
    buffer_load_dwordx4 v24, s[28:31], s7 offen offset:0 sc1 lds
    buffer_load_dwordx4 v24, s[28:31], s7 offen offset:1024 sc1 lds
    buffer_load_dwordx4 v24, s[28:31], s7 offen offset:2048 sc1 lds
    buffer_load_dwordx4 v24, s[28:31], s7 offen offset:3072 sc1 lds
    s_cmp_eq_u32 s68, 1
    s_cbranch_scc1 Lhk_62
    s_add_u32 m0, m0, 4096
    s_add_u32 s7, s7, 4096
    buffer_load_dwordx4 v24, s[28:31], s7 offen sc1 lds
Lhk_62:
    s_waitcnt vmcnt(4)
    s_barrier
    s_add_u32 m0, s93, 73728
    s_add_u32 s7, s94, s48
    buffer_load_dwordx4 v24, s[28:31], s7 offen offset:0 sc1 lds
    buffer_load_dwordx4 v24, s[28:31], s7 offen offset:1024 sc1 lds
    buffer_load_dwordx4 v24, s[28:31], s7 offen offset:2048 sc1 lds
    buffer_load_dwordx4 v24, s[28:31], s7 offen offset:3072 sc1 lds
    s_cmp_eq_u32 s68, 1
    s_cbranch_scc1 Lhk_63
    s_add_u32 m0, m0, 4096
    s_add_u32 s7, s7, 4096
    buffer_load_dwordx4 v24, s[28:31], s7 offen sc1 lds
Lhk_63:
    s_add_u32 m0, s93, 92160
    s_add_u32 s7, s94, s49
    buffer_load_dwordx4 v24, s[28:31], s7 offen offset:0 sc1 lds
    buffer_load_dwordx4 v24, s[28:31], s7 offen offset:1024 sc1 lds
    buffer_load_dwordx4 v24, s[28:31], s7 offen offset:2048 sc1 lds
    buffer_load_dwordx4 v24, s[28:31], s7 offen offset:3072 sc1 lds
    s_cmp_eq_u32 s68, 1
    s_cbranch_scc1 Lhk_64
    s_add_u32 m0, m0, 4096
    s_add_u32 s7, s7, 4096
    buffer_load_dwordx4 v24, s[28:31], s7 offen sc1 lds
Lhk_64:
    s_add_u32 m0, s79, 16384
    s_nop 0
    buffer_load_dwordx4 v24, s[28:31], s81 offen offset:0 sc1 lds
    buffer_load_dwordx4 v24, s[28:31], s81 offen offset:1024 sc1 lds
    buffer_load_dwordx4 v24, s[28:31], s81 offen offset:2048 sc1 lds
    buffer_load_dwordx4 v24, s[28:31], s81 offen offset:3072 sc1 lds
    s_waitcnt vmcnt(12)
    s_barrier
    s_waitcnt vmcnt(8)
    s_barrier
    s_waitcnt vmcnt(0)
    s_barrier
    s_branch L_end
L_ssm:
    s_load_dwordx16 s[36:51], s[0:1], 0
    s_load_dwordx8 s[52:59], s[0:1], 64
    s_getpc_b64 s[62:63]
L_pc0:
    s_sub_u32 s62, s62, L_pc0-parallel_sum__ssm_conv_s4d__mixer_gmlp__prompt_kernel
    s_subb_u32 s63, s63, 0
    v_and_b32 v1, 63, v0
    s_sub_u32 s79, s79, 24
    s_lshl_b32 s79, s79, 3
    s_add_u32 s4, s79, s78
    s_mul_i32 s70, s4, 10
    s_add_u32 s66, s70, s3
    v_mov_b32 v10, 0
    v_min_u32 v2, 6, v1
    s_add_u32 s80, s79, s3
    s_mul_i32 s80, s80, 7
    v_add_u32 v2, s80, v2
    v_lshlrev_b32 v2, 7, v2
    v_min_u32 v2, L_tabend-4-parallel_sum__ssm_conv_s4d__mixer_gmlp__prompt_kernel, v2
    global_load_dword v219, v2, s[62:63]
    s_waitcnt lgkmcnt(0)
    s_mov_b32 s8, s38
    s_mov_b32 s9, s39
    s_mov_b32 s10, 163840
    s_mov_b32 s11, 0x20000
    s_mov_b32 s12, s40
    s_mov_b32 s13, s41
    s_mov_b32 s14, 163840
    s_mov_b32 s15, 0x20000
    s_mov_b32 s16, s42
    s_mov_b32 s17, s43
    s_mov_b32 s18, 163840
    s_mov_b32 s19, 0x20000
    s_mov_b32 s20, s44
    s_mov_b32 s21, s45
    s_mov_b32 s22, 163840
    s_mov_b32 s23, 0x20000
    s_mov_b32 s24, s46
    s_mov_b32 s25, s47
    s_mov_b32 s26, 1280
    s_mov_b32 s27, 0x20000
    v_lshlrev_b32 v12, 2, v1
    s_lshl_b32 s78, s66, 8
    s_lshl_b32 s79, s66, 1
    buffer_load_dword v16, v12, s[8:11], s78 offen
    buffer_load_dword v17, v12, s[12:15], s78 offen
    buffer_load_dword v18, v12, s[16:19], s78 offen
    buffer_load_dword v19, v12, s[20:23], s78 offen
    buffer_load_ushort v20, v10, s[24:27], s79 offen
    s_mov_b32 s40, s52
    s_mov_b32 s41, s53
    s_mov_b32 s42, 2211840
    s_mov_b32 s43, 0x20000
    s_load_dword s6, s[64:65], 0
    s_mov_b32 s28, s64
    s_mov_b32 s29, s65
    s_mov_b32 s30, 33554432
    s_mov_b32 s31, 0x20000
    s_mov_b32 s32, s48
    s_mov_b32 s33, s49
    s_mov_b32 s34, 1280
    s_mov_b32 s35, 0x20000
    s_mul_i32 s67, s3, 17600
    s_mov_b32 s69, 0
    s_cmp_lt_u32 s3, 6
    s_cbranch_scc1 L_noprio
    s_setprio 3
L_noprio:
    v_lshrrev_b32 v2, 4, v1
    v_and_b32 v3, 15, v1
    v_lshlrev_b32 v4, 3, v1
    v_add_u32 v4, s67, v4
    v_mul_u32_u24 v5, 528, v3
    v_lshl_add_u32 v5, v2, 4, v5
    v_add_u32 v5, s67, v5
    v_lshrrev_b32 v12, 1, v2
    v_lshlrev_b32 v12, 7, v12
    v_lshl_add_u32 v12, v3, 3, v12
    v_and_b32 v13, 1, v2
    v_lshl_add_u32 v12, v13, 2, v12
    v_lshlrev_b32 v6, 1, v12
    v_lshlrev_b32_e64 v12, 6, v2
    v_lshl_add_u32 v13, v3, 2, v12
    v_add_u32 v13, 256, v13
    v_lshl_add_u32 v14, v3, 1, v12
    v_add_u32 v14, 256, v14
    v_cmp_gt_u32 vcc, 2, v2
    s_nop 1
    v_cndmask_b32 v7, v14, v13, vcc
    v_mov_b32 v15, 32
    v_cndmask_b32 v15, v15, 2, vcc
    v_add_u32 v8, v7, v15
    v_lshlrev_b32 v7, 1, v7
    v_lshlrev_b32 v8, 1, v8
    v_add_u32 v12, v12, v3
    v_add_u32 v12, 512, v12
    v_lshlrev_b32 v9, 1, v12
    s_mov_b32 s36, s58
    s_mov_b32 s37, s59
    s_mov_b32 s38, 1105920
    s_mov_b32 s39, 0x20000
    s_mov_b32 s52, s54
    s_mov_b32 s53, s55
    s_mov_b32 s54, 8388608
    s_mov_b32 s55, 0x20000
    s_mov_b32 s71, 0
    s_cmp_ge_u32 s4, 54
    s_cbranch_scc1 L_wj_skip
    s_cmp_ge_u32 s3, 5
    s_cbranch_scc1 L_wj_skip
    s_mov_b32 s71, 1
    s_lshr_b32 s72, s4, 1
    s_and_b32 s73, s4, 1
    s_mul_i32 s73, s73, 5
    s_add_u32 s73, s73, s3
    s_lshr_b32 s78, s72, 2
    s_and_b32 s79, s72, 3
    s_mul_i32 s78, s78, 9
    s_lshl_b32 s80, s79, 1
    s_add_u32 s78, s78, s80
    s_lshr_b32 s80, s79, 1
    s_add_u32 s78, s78, s80
    s_add_u32 s79, s78, 1
    s_sub_u32 s80, s72, 24
    s_mul_i32 s80, s80, 18
    s_add_u32 s80, s80, 4
    s_add_u32 s81, s80, 9
    s_cmp_ge_u32 s72, 24
    s_cselect_b32 s78, s80, s78
    s_cselect_b32 s79, s81, s79
    s_mul_i32 s78, s78, 20480
    s_mul_i32 s79, s79, 20480
    s_lshl_b32 s80, s73, 7
    s_add_u32 s78, s78, s80
    s_add_u32 s79, s79, s80
    v_lshrrev_b32 v12, 3, v1
    v_mul_u32_u24 v12, 1280, v12
    v_and_b32_e64 v13, 7, v1
    v_lshl_add_u32 v12, v13, 4, v12
    s_add_u32 m0, s67, 9280
    s_add_u32 s80, s78, 10240
    buffer_load_dwordx4 v12, s[36:39], s78 offen lds
    s_add_u32 m0, m0, 1024
    s_add_u32 s81, s79, 10240
    buffer_load_dwordx4 v12, s[36:39], s80 offen lds
    s_add_u32 m0, m0, 1024
    s_nop 0
    buffer_load_dwordx4 v12, s[36:39], s79 offen lds
    s_add_u32 m0, m0, 1024
    s_nop 0
    buffer_load_dwordx4 v12, s[36:39], s81 offen lds
L_wj_skip:
    v_lshlrev_b32_e64 v12, 4, v1
    v_add_u32 v12, L_gtab-parallel_sum__ssm_conv_s4d__mixer_gmlp__prompt_kernel, v12
    global_load_dwordx4 v[220:223], v12, s[62:63] offset:0
    global_load_dwordx4 v[224:227], v12, s[62:63] offset:1024
    global_load_dwordx4 v[228:231], v12, s[62:63] offset:2048
    global_load_dwordx4 v[232:235], v12, s[62:63] offset:3072
    v_add_u32 v12, 4096, v12
    global_load_dwordx4 v[236:239], v12, s[62:63] offset:0
    global_load_dwordx4 v[240:243], v12, s[62:63] offset:1024
    global_load_dwordx4 v[244:247], v12, s[62:63] offset:2048
    global_load_dwordx4 v[248:251], v12, s[62:63] offset:3072
    v_add_u32 v12, 4096, v12
    global_load_dwordx4 v[252:255], v12, s[62:63] offset:0
    v_min_u32 v218, 33, v1
    v_lshlrev_b32 v218, 7, v218
    s_lshl_b32 s78, s4, 3
    s_add_u32 s78, s78, s3
    s_mul_i32 s78, s78, 4352
    buffer_load_dword v219, v218, s[40:43], s78 offen
    v_and_b32 v216, 3, v1
    v_lshlrev_b32 v216, 7, v216
    v_bfe_u32 v217, v1, 2, 2
    v_lshl_add_u32 v216, v217, 12, v216
    s_and_b32 s78, s2, 7
    s_lshl_b32 s78, s78, 3
    s_lshr_b32 s80, s4, 3
    s_add_u32 s78, s78, s80
    s_lshl_b32 s78, s78, 3
    s_add_u32 s78, s78, s3
    s_lshl_b32 s77, s78, 14
    s_and_b32 s83, s2, 6
    s_lshl_b32 s83, s83, 9
    s_mov_b32 s84, 8
    v_lshlrev_b32 v11, 4, v1
    s_and_b32 s91, s3, 1
    s_add_u32 s91, s91, s70
    s_add_u32 s91, s91, 8
    s_mov_b32 s93, 0
    s_lshr_b32 s78, s66, 4
    s_mov_b32 s94, 917504
    s_cmp_ge_u32 s78, 7
    s_cselect_b32 s7, 4096, 0
    s_add_u32 s94, s94, s7
    s_cmp_ge_u32 s78, 14
    s_cselect_b32 s7, 4096, 0
    s_add_u32 s94, s94, s7
    s_cmp_ge_u32 s78, 20
    s_cselect_b32 s7, 4096, 0
    s_add_u32 s94, s94, s7
    s_cmp_ge_u32 s78, 26
    s_cselect_b32 s7, 4096, 0
    s_add_u32 s94, s94, s7
    s_cmp_ge_u32 s78, 32
    s_cselect_b32 s7, 4096, 0
    s_add_u32 s94, s94, s7
    s_lshr_b32 s78, s91, 4
    s_mov_b32 s95, 917504
    s_cmp_ge_u32 s78, 7
    s_cselect_b32 s7, 4096, 0
    s_add_u32 s95, s95, s7
    s_cmp_ge_u32 s78, 14
    s_cselect_b32 s7, 4096, 0
    s_add_u32 s95, s95, s7
    s_cmp_ge_u32 s78, 20
    s_cselect_b32 s7, 4096, 0
    s_add_u32 s95, s95, s7
    s_cmp_ge_u32 s78, 26
    s_cselect_b32 s7, 4096, 0
    s_add_u32 s95, s95, s7
    s_cmp_ge_u32 s78, 32
    s_cselect_b32 s7, 4096, 0
    s_add_u32 s95, s95, s7
    s_mul_i32 s68, s3, 1568
    s_add_u32 s68, s68, 140800
    s_waitcnt vmcnt(10) lgkmcnt(0)
L_kgen:
    s_mov_b32 s79, 0xffff0000
    s_cmp_lg_u32 s69, 0
    s_cbranch_scc1 L_r0_skip
    s_mul_i32 s6, s6, 0x9E3779B1
    s_add_u32 s6, s6, 0x7F4A7C15
    s_cmp_eq_u32 s71, 0
    s_cbranch_scc1 L_wj2_skip
    v_lshrrev_b32 v160, 2, v1
    v_lshlrev_b32 v160, 7, v160
    v_and_b32 v161, 3, v1
    v_lshl_add_u32 v160, v161, 3, v160
    v_add_u32 v160, s67, v160
    v_lshlrev_b32_e64 v161, 4, v1
    ds_read_b64_tr_b16 v[144:145], v160 offset:9280
    ds_read_b64_tr_b16 v[146:147], v160 offset:11328
    ds_read_b64_tr_b16 v[148:149], v160 offset:9312
    ds_read_b64_tr_b16 v[150:151], v160 offset:11360
    ds_read_b64_tr_b16 v[152:153], v160 offset:9344
    ds_read_b64_tr_b16 v[154:155], v160 offset:11392
    ds_read_b64_tr_b16 v[156:157], v160 offset:9376
    ds_read_b64_tr_b16 v[158:159], v160 offset:11424
    s_lshl_b32 s78, s73, 2
    s_mul_i32 s78, s78, 27648
    s_lshl_b32 s80, s72, 10
    s_add_u32 s78, s78, s80
    s_add_u32 s78, s78, 15597568
    s_waitcnt lgkmcnt(0)
    buffer_store_dwordx4 v[144:147], v161, s[28:31], s78 offen sc1
    s_add_u32 s78, s78, 27648
    buffer_store_dwordx4 v[148:151], v161, s[28:31], s78 offen sc1
    s_add_u32 s78, s78, 27648
    buffer_store_dwordx4 v[152:155], v161, s[28:31], s78 offen sc1
    s_add_u32 s78, s78, 27648
    buffer_store_dwordx4 v[156:159], v161, s[28:31], s78 offen sc1
    s_add_u32 s78, s78, 27648
L_wj2_skip:
L_r0_skip:
    v_mov_b32 v215, v218
    s_sub_u32 s78, s95, s94
    v_lshrrev_b32 v218, 5, v1
    v_mul_lo_u32 v218, v218, s78
    v_and_b32 v214, 31, v1
    v_lshl_add_u32 v218, v214, 7, v218
    v_lshlrev_b32 v20, 16, v20
    v_mul_f32 v20, 0x3fb8aa3b, v20
    v_exp_f32 v20, v20
    v_lshlrev_b32 v24, 16, v16
    v_and_b32 v25, s79, v16
    v_cvt_pk_bf16_f32 v20, v20, v20
    v_mul_f32 v24, 0x3fb8aa3b, v24
    v_mul_f32 v25, 0x3fb8aa3b, v25
    v_lshlrev_b32 v20, 16, v20
    v_exp_f32 v24, v24
    v_exp_f32 v25, v25
    v_lshlrev_b32 v26, 16, v17
    v_and_b32 v27, s79, v17
    v_cvt_pk_bf16_f32 v16, v24, v25
    v_lshlrev_b32 v24, 16, v16
    v_and_b32 v25, s79, v16
    v_mul_f32 v24, v24, v20
    v_mul_f32 v25, v25, v20
    v_mul_f32 v24, 0xbfb8aa3b, v24
    v_mul_f32 v25, 0xbfb8aa3b, v25
    v_mul_f32 v26, v26, v20
    v_mul_f32 v27, v27, v20
    v_mul_f32 v26, 0x3e22f983, v26
    v_mul_f32 v27, 0x3e22f983, v27
    v_lshlrev_b32 v28, 16, v18
    v_and_b32 v29, s79, v18
    v_lshlrev_b32 v30, 16, v19
    v_and_b32 v31, s79, v19
    v_max3_f32 v12, abs(v28), abs(v29), abs(v30)
    v_max_f32 v12, abs(v31), v12
    s_nop 1
    v_max_f32_dpp v12, v12, v12 row_ror:8 row_mask:0xf bank_mask:0xf
    s_nop 1
    v_max_f32_dpp v12, v12, v12 row_ror:4 row_mask:0xf bank_mask:0xf
    s_nop 1
    v_max_f32_dpp v12, v12, v12 row_ror:2 row_mask:0xf bank_mask:0xf
    s_nop 1
    v_max_f32_dpp v12, v12, v12 row_ror:1 row_mask:0xf bank_mask:0xf
    s_nop 0
    v_readlane_b32 s78, v12, 0
    v_readlane_b32 s80, v12, 16
    v_readlane_b32 s81, v12, 32
    v_readlane_b32 s7, v12, 48
    s_max_u32 s78, s78, s80
    s_max_u32 s81, s81, s7
    s_max_u32 s78, s78, s81
    v_frexp_exp_i32_f32 v12, s78
    v_sub_u32_e64 v13, 0, v12
    v_ldexp_f32 v32, v28, v13
    v_ldexp_f32 v33, v29, v13
    v_ldexp_f32 v34, v30, v13
    v_ldexp_f32 v35, v31, v13
    v_add_f32 v23, v20, v20
    v_ldexp_f32 v23, v23, v12
    s_cmp_lg_u32 s69, 0
    s_cbranch_scc1 L_np2
    s_cmp_lt_u32 s3, 6
    s_cbranch_scc1 L_np2
    s_add_u32 s66, s66, 2
    v_lshlrev_b32 v12, 2, v1
    s_lshl_b32 s78, s66, 8
    s_lshl_b32 s79, s66, 1
    s_nop 0
    buffer_load_dword v16, v12, s[8:11], s78 offen
    buffer_load_dword v17, v12, s[12:15], s78 offen
    buffer_load_dword v18, v12, s[16:19], s78 offen
    buffer_load_dword v19, v12, s[20:23], s78 offen
    buffer_load_ushort v20, v10, s[24:27], s79 offen
    s_mov_b32 s79, 0xffff0000
L_np2:
    v_mul_f32 v176, 0x41000000, v24
    v_mul_f32 v180, 0x43000000, v24
    v_mul_f32 v177, 0x41000000, v25
    v_mul_f32 v181, 0x43000000, v25
    v_mul_f32 v178, 0x41000000, v26
    v_mul_f32 v182, 0x43000000, v26
    v_mul_f32 v179, 0x41000000, v27
    v_mul_f32 v183, 0x43000000, v27
    v_exp_f32 v176, v176
    v_exp_f32 v180, v180
    v_exp_f32 v177, v177
    v_exp_f32 v181, v181
    v_fract_f32 v178, v178
    v_fract_f32 v182, v182
    v_fract_f32 v179, v179
    v_fract_f32 v183, v183
    v_cos_f32 v64, v178
    v_cos_f32 v96, v182
    v_cos_f32 v65, v179
    v_cos_f32 v97, v183
    v_sin_f32 v66, v178
    v_sin_f32 v98, v182
    v_sin_f32 v67, v179
    v_sin_f32 v99, v183
    v_pk_mul_f32 v[64:65], v[64:65], v[176:177]
    v_pk_mul_f32 v[96:97], v[96:97], v[180:181]
    v_pk_mul_f32 v[66:67], v[66:67], v[176:177]
    v_pk_mul_f32 v[98:99], v[98:99], v[180:181]
    v_mov_b32 v144, 1.0
    v_mov_b32 v145, 1.0
    v_mov_b32 v146, 0
    v_mov_b32 v147, 0
    v_pk_mul_f32 v[176:177], v[66:67], v[66:67]
    v_pk_mul_f32 v[180:181], v[98:99], v[98:99]
    v_pk_mul_f32 v[184:185], v[34:35], v[98:99]
    v_cvt_pk_f16_f32 v198, v144, -v146
    v_pk_mul_f32 v[178:179], v[66:67], v[64:65]
    v_pk_mul_f32 v[182:183], v[98:99], v[96:97]
    v_pk_mul_f32 v[186:187], v[34:35], v[96:97]
    v_cvt_pk_f16_f32 v199, v145, -v147
    v_pk_fma_f32 v[68:69], v[64:65], v[64:65], v[176:177] neg_lo:[0,0,1] neg_hi:[0,0,1]
    v_pk_fma_f32 v[100:101], v[96:97], v[96:97], v[180:181] neg_lo:[0,0,1] neg_hi:[0,0,1]
    v_pk_fma_f32 v[36:37], v[32:33], v[96:97], v[184:185] neg_lo:[0,0,1] neg_hi:[0,0,1]
    ds_write_b64 v4, v[198:199] offset:0
    v_pk_fma_f32 v[70:71], v[64:65], v[66:67], v[178:179]
    v_pk_fma_f32 v[102:103], v[96:97], v[98:99], v[182:183]
    v_pk_fma_f32 v[38:39], v[32:33], v[98:99], v[186:187]
    v_cvt_pk_f16_f32 v192, v68, -v70
    v_cvt_pk_f16_f32 v193, v69, -v71
    ds_write_b64 v4, v[192:193] offset:1056
    v_pk_mul_f32 v[176:177], v[70:71], v[70:71]
    v_pk_mul_f32 v[180:181], v[70:71], v[66:67]
    v_pk_mul_f32 v[184:185], v[102:103], v[102:103]
    v_cvt_pk_f16_f32 v198, v64, -v66
    v_pk_mul_f32 v[178:179], v[70:71], v[68:69]
    v_pk_mul_f32 v[182:183], v[70:71], v[64:65]
    v_pk_mul_f32 v[186:187], v[102:103], v[100:101]
    v_cvt_pk_f16_f32 v199, v65, -v67
    v_pk_fma_f32 v[76:77], v[68:69], v[68:69], v[176:177] neg_lo:[0,0,1] neg_hi:[0,0,1]
    v_pk_fma_f32 v[72:73], v[68:69], v[64:65], v[180:181] neg_lo:[0,0,1] neg_hi:[0,0,1]
    v_pk_fma_f32 v[104:105], v[100:101], v[100:101], v[184:185] neg_lo:[0,0,1] neg_hi:[0,0,1]
    ds_write_b64 v4, v[198:199] offset:528
    v_pk_fma_f32 v[78:79], v[68:69], v[70:71], v[178:179]
    v_pk_fma_f32 v[74:75], v[68:69], v[66:67], v[182:183]
    v_pk_fma_f32 v[106:107], v[100:101], v[102:103], v[186:187]
    v_cvt_pk_f16_f32 v192, v76, -v78
    v_cvt_pk_f16_f32 v194, v72, -v74
    v_cvt_pk_f16_f32 v193, v77, -v79
    v_cvt_pk_f16_f32 v195, v73, -v75
    ds_write_b64 v4, v[192:193] offset:2112
    ds_write_b64 v4, v[194:195] offset:1584
    v_pk_mul_f32 v[176:177], v[78:79], v[78:79]
    v_pk_mul_f32 v[180:181], v[78:79], v[66:67]
    v_pk_mul_f32 v[184:185], v[78:79], v[70:71]
    v_pk_mul_f32 v[188:189], v[78:79], v[74:75]
    v_pk_mul_f32 v[178:179], v[78:79], v[76:77]
    v_pk_mul_f32 v[182:183], v[78:79], v[64:65]
    v_pk_mul_f32 v[186:187], v[78:79], v[68:69]
    v_pk_mul_f32 v[190:191], v[78:79], v[72:73]
    v_pk_fma_f32 v[92:93], v[76:77], v[76:77], v[176:177] neg_lo:[0,0,1] neg_hi:[0,0,1]
    v_pk_fma_f32 v[80:81], v[76:77], v[64:65], v[180:181] neg_lo:[0,0,1] neg_hi:[0,0,1]
    v_pk_fma_f32 v[84:85], v[76:77], v[68:69], v[184:185] neg_lo:[0,0,1] neg_hi:[0,0,1]
    v_pk_fma_f32 v[88:89], v[76:77], v[72:73], v[188:189] neg_lo:[0,0,1] neg_hi:[0,0,1]
    v_pk_fma_f32 v[94:95], v[76:77], v[78:79], v[178:179]
    v_pk_fma_f32 v[82:83], v[76:77], v[66:67], v[182:183]
    v_pk_fma_f32 v[86:87], v[76:77], v[70:71], v[186:187]
    v_pk_fma_f32 v[90:91], v[76:77], v[74:75], v[190:191]
    v_cvt_pk_f16_f32 v192, v92, -v94
    v_cvt_pk_f16_f32 v194, v80, -v82
    v_cvt_pk_f16_f32 v196, v84, -v86
    v_cvt_pk_f16_f32 v198, v88, -v90
    v_cvt_pk_f16_f32 v193, v93, -v95
    v_cvt_pk_f16_f32 v195, v81, -v83
    v_cvt_pk_f16_f32 v197, v85, -v87
    v_cvt_pk_f16_f32 v199, v89, -v91
    ds_write_b64 v4, v[192:193] offset:4224
    ds_write_b64 v4, v[194:195] offset:2640
    ds_write_b64 v4, v[196:197] offset:3168
    ds_write_b64 v4, v[198:199] offset:3696
    v_pk_mul_f32 v[176:177], v[94:95], v[66:67]
    v_pk_mul_f32 v[180:181], v[94:95], v[70:71]
    v_pk_mul_f32 v[184:185], v[94:95], v[74:75]
    v_pk_mul_f32 v[188:189], v[94:95], v[78:79]
    v_pk_mul_f32 v[178:179], v[94:95], v[64:65]
    v_pk_mul_f32 v[182:183], v[94:95], v[68:69]
    v_pk_mul_f32 v[186:187], v[94:95], v[72:73]
    v_pk_mul_f32 v[190:191], v[94:95], v[76:77]
    v_pk_fma_f32 v[144:145], v[92:93], v[64:65], v[176:177] neg_lo:[0,0,1] neg_hi:[0,0,1]
    v_pk_fma_f32 v[148:149], v[92:93], v[68:69], v[180:181] neg_lo:[0,0,1] neg_hi:[0,0,1]
    v_pk_fma_f32 v[152:153], v[92:93], v[72:73], v[184:185] neg_lo:[0,0,1] neg_hi:[0,0,1]
    v_pk_fma_f32 v[156:157], v[92:93], v[76:77], v[188:189] neg_lo:[0,0,1] neg_hi:[0,0,1]
    v_pk_fma_f32 v[146:147], v[92:93], v[66:67], v[178:179]
    v_pk_fma_f32 v[150:151], v[92:93], v[70:71], v[182:183]
    v_pk_fma_f32 v[154:155], v[92:93], v[74:75], v[186:187]
    v_pk_fma_f32 v[158:159], v[92:93], v[78:79], v[190:191]
    v_cvt_pk_f16_f32 v192, v144, -v146
    v_cvt_pk_f16_f32 v194, v148, -v150
    v_cvt_pk_f16_f32 v196, v152, -v154
    v_cvt_pk_f16_f32 v198, v156, -v158
    v_cvt_pk_f16_f32 v193, v145, -v147
    v_cvt_pk_f16_f32 v195, v149, -v151
    v_cvt_pk_f16_f32 v197, v153, -v155
    v_cvt_pk_f16_f32 v199, v157, -v159
    ds_write_b64 v4, v[192:193] offset:4752
    ds_write_b64 v4, v[194:195] offset:5280
    ds_write_b64 v4, v[196:197] offset:5808
    ds_write_b64 v4, v[198:199] offset:6336
    v_pk_mul_f32 v[176:177], v[94:95], v[82:83]
    v_pk_mul_f32 v[180:181], v[94:95], v[86:87]
    v_pk_mul_f32 v[184:185], v[94:95], v[90:91]
    v_pk_mul_f32 v[188:189], v[106:107], v[106:107]
    v_pk_mul_f32 v[178:179], v[94:95], v[80:81]
    v_pk_mul_f32 v[182:183], v[94:95], v[84:85]
    v_pk_mul_f32 v[186:187], v[94:95], v[88:89]
    v_pk_mul_f32 v[190:191], v[106:107], v[104:105]
    v_pk_fma_f32 v[144:145], v[92:93], v[80:81], v[176:177] neg_lo:[0,0,1] neg_hi:[0,0,1]
    v_pk_fma_f32 v[148:149], v[92:93], v[84:85], v[180:181] neg_lo:[0,0,1] neg_hi:[0,0,1]
    v_pk_fma_f32 v[152:153], v[92:93], v[88:89], v[184:185] neg_lo:[0,0,1] neg_hi:[0,0,1]
    v_pk_fma_f32 v[108:109], v[104:105], v[104:105], v[188:189] neg_lo:[0,0,1] neg_hi:[0,0,1]
    v_pk_fma_f32 v[146:147], v[92:93], v[82:83], v[178:179]
    v_pk_fma_f32 v[150:151], v[92:93], v[86:87], v[182:183]
    v_pk_fma_f32 v[154:155], v[92:93], v[90:91], v[186:187]
    v_pk_fma_f32 v[110:111], v[104:105], v[106:107], v[190:191]
    v_cvt_pk_f16_f32 v192, v144, -v146
    v_cvt_pk_f16_f32 v194, v148, -v150
    v_cvt_pk_f16_f32 v196, v152, -v154
    v_cvt_pk_f16_f32 v193, v145, -v147
    v_cvt_pk_f16_f32 v195, v149, -v151
    v_cvt_pk_f16_f32 v197, v153, -v155
    ds_write_b64 v4, v[192:193] offset:6864
    ds_write_b64 v4, v[194:195] offset:7392
    ds_write_b64 v4, v[196:197] offset:7920
    ds_read_b128 v[112:115], v5 offset:0
    ds_read_b128 v[116:119], v5 offset:64
    ds_read_b128 v[120:123], v5 offset:128
    ds_read_b128 v[124:127], v5 offset:192
    ds_read_b128 v[128:131], v5 offset:256
    ds_read_b128 v[132:135], v5 offset:320
    ds_read_b128 v[136:139], v5 offset:384
    ds_read_b128 v[140:143], v5 offset:448
    v_mul_f32 v176, 0x3f800000, v24
    v_pk_mul_f32 v[180:181], v[34:35], v[102:103]
    v_pk_mul_f32 v[184:185], v[38:39], v[102:103]
    v_mul_f32 v177, 0x3f800000, v25
    v_pk_mul_f32 v[182:183], v[34:35], v[100:101]
    v_pk_mul_f32 v[186:187], v[38:39], v[100:101]
    v_mul_f32 v178, 0x3f800000, v26
    v_pk_fma_f32 v[40:41], v[32:33], v[100:101], v[180:181] neg_lo:[0,0,1] neg_hi:[0,0,1]
    v_pk_fma_f32 v[44:45], v[36:37], v[100:101], v[184:185] neg_lo:[0,0,1] neg_hi:[0,0,1]
    v_mul_f32 v179, 0x3f800000, v27
    v_pk_fma_f32 v[42:43], v[32:33], v[102:103], v[182:183]
    v_pk_fma_f32 v[46:47], v[36:37], v[102:103], v[186:187]
    v_exp_f32 v176, v176
    v_pk_mul_f32 v[180:181], v[34:35], v[106:107]
    v_cvt_pk_f16_f32 v196, v32, v34
    v_exp_f32 v177, v177
    v_pk_mul_f32 v[182:183], v[34:35], v[104:105]
    v_cvt_pk_f16_f32 v197, v33, v35
    v_fract_f32 v178, v178
    v_pk_fma_f32 v[48:49], v[32:33], v[104:105], v[180:181] neg_lo:[0,0,1] neg_hi:[0,0,1]
    ds_write_b64 v4, v[196:197] offset:0
    v_fract_f32 v179, v179
    v_pk_fma_f32 v[50:51], v[32:33], v[106:107], v[182:183]
    v_cvt_pk_f16_f32 v196, v36, v38
    v_cos_f32 v64, v178
    v_pk_mul_f32 v[180:181], v[38:39], v[106:107]
    v_cvt_pk_f16_f32 v197, v37, v39
    v_cos_f32 v65, v179
    v_pk_mul_f32 v[182:183], v[38:39], v[104:105]
    ds_write_b64 v4, v[196:197] offset:4224
    v_sin_f32 v66, v178
    v_pk_fma_f32 v[52:53], v[36:37], v[104:105], v[180:181] neg_lo:[0,0,1] neg_hi:[0,0,1]
    v_sin_f32 v67, v179
    v_pk_fma_f32 v[54:55], v[36:37], v[106:107], v[182:183]
    v_pk_mul_f32 v[64:65], v[64:65], v[176:177]
    v_pk_mul_f32 v[66:67], v[66:67], v[176:177]
    v_pk_mul_f32 v[176:177], v[66:67], v[66:67]
    v_pk_mul_f32 v[180:181], v[42:43], v[106:107]
    v_pk_mul_f32 v[184:185], v[46:47], v[106:107]
    v_pk_mul_f32 v[188:189], v[34:35], v[66:67]
    v_pk_mul_f32 v[178:179], v[66:67], v[64:65]
    v_pk_mul_f32 v[182:183], v[42:43], v[104:105]
    v_pk_mul_f32 v[186:187], v[46:47], v[104:105]
    v_pk_mul_f32 v[190:191], v[34:35], v[64:65]
    v_pk_fma_f32 v[68:69], v[64:65], v[64:65], v[176:177] neg_lo:[0,0,1] neg_hi:[0,0,1]
    v_pk_fma_f32 v[56:57], v[40:41], v[104:105], v[180:181] neg_lo:[0,0,1] neg_hi:[0,0,1]
    v_pk_fma_f32 v[60:61], v[44:45], v[104:105], v[184:185] neg_lo:[0,0,1] neg_hi:[0,0,1]
    v_pk_fma_f32 v[144:145], v[32:33], v[64:65], v[188:189] neg_lo:[0,0,1] neg_hi:[0,0,1]
    v_pk_fma_f32 v[70:71], v[64:65], v[66:67], v[178:179]
    v_pk_fma_f32 v[58:59], v[40:41], v[106:107], v[182:183]
    v_pk_fma_f32 v[62:63], v[44:45], v[106:107], v[186:187]
    v_pk_fma_f32 v[146:147], v[32:33], v[66:67], v[190:191]
    v_cvt_pk_f16_f32 v198, v144, v146
    v_cvt_pk_f16_f32 v199, v145, v147
    ds_write_b64 v4, v[198:199] offset:528
    v_pk_mul_f32 v[176:177], v[70:71], v[70:71]
    v_pk_mul_f32 v[180:181], v[70:71], v[66:67]
    v_pk_mul_f32 v[184:185], v[38:39], v[66:67]
    v_pk_mul_f32 v[188:189], v[34:35], v[70:71]
    v_pk_mul_f32 v[178:179], v[70:71], v[68:69]
    v_pk_mul_f32 v[182:183], v[70:71], v[64:65]
    v_pk_mul_f32 v[186:187], v[38:39], v[64:65]
    v_pk_mul_f32 v[190:191], v[34:35], v[68:69]
    v_pk_fma_f32 v[76:77], v[68:69], v[68:69], v[176:177] neg_lo:[0,0,1] neg_hi:[0,0,1]
    v_pk_fma_f32 v[72:73], v[68:69], v[64:65], v[180:181] neg_lo:[0,0,1] neg_hi:[0,0,1]
    v_pk_fma_f32 v[148:149], v[36:37], v[64:65], v[184:185] neg_lo:[0,0,1] neg_hi:[0,0,1]
    v_pk_fma_f32 v[152:153], v[32:33], v[68:69], v[188:189] neg_lo:[0,0,1] neg_hi:[0,0,1]
    v_pk_fma_f32 v[78:79], v[68:69], v[70:71], v[178:179]
    v_pk_fma_f32 v[74:75], v[68:69], v[66:67], v[182:183]
    v_pk_fma_f32 v[150:151], v[36:37], v[66:67], v[186:187]
    v_pk_fma_f32 v[154:155], v[32:33], v[70:71], v[190:191]
    v_cvt_pk_f16_f32 v196, v148, v150
    v_cvt_pk_f16_f32 v198, v152, v154
    v_cvt_pk_f16_f32 v197, v149, v151
    v_cvt_pk_f16_f32 v199, v153, v155
    ds_write_b64 v4, v[196:197] offset:4752
    ds_write_b64 v4, v[198:199] offset:1056
    v_pk_mul_f32 v[176:177], v[78:79], v[66:67]
    v_pk_mul_f32 v[180:181], v[78:79], v[70:71]
    v_pk_mul_f32 v[184:185], v[78:79], v[74:75]
    v_pk_mul_f32 v[188:189], v[38:39], v[70:71]
    v_pk_mul_f32 v[178:179], v[78:79], v[64:65]
    v_pk_mul_f32 v[182:183], v[78:79], v[68:69]
    v_pk_mul_f32 v[186:187], v[78:79], v[72:73]
    v_pk_mul_f32 v[190:191], v[38:39], v[68:69]
    v_pk_fma_f32 v[80:81], v[76:77], v[64:65], v[176:177] neg_lo:[0,0,1] neg_hi:[0,0,1]
    v_pk_fma_f32 v[84:85], v[76:77], v[68:69], v[180:181] neg_lo:[0,0,1] neg_hi:[0,0,1]
    v_pk_fma_f32 v[88:89], v[76:77], v[72:73], v[184:185] neg_lo:[0,0,1] neg_hi:[0,0,1]
    v_pk_fma_f32 v[156:157], v[36:37], v[68:69], v[188:189] neg_lo:[0,0,1] neg_hi:[0,0,1]
    v_pk_fma_f32 v[82:83], v[76:77], v[66:67], v[178:179]
    v_pk_fma_f32 v[86:87], v[76:77], v[70:71], v[182:183]
    v_pk_fma_f32 v[90:91], v[76:77], v[74:75], v[186:187]
    v_pk_fma_f32 v[158:159], v[36:37], v[70:71], v[190:191]
    v_cvt_pk_f16_f32 v198, v156, v158
    v_cvt_pk_f16_f32 v199, v157, v159
    ds_write_b64 v4, v[198:199] offset:5280
    v_pk_mul_f32 v[176:177], v[34:35], v[74:75]
    v_pk_mul_f32 v[180:181], v[38:39], v[74:75]
    v_pk_mul_f32 v[184:185], v[34:35], v[78:79]
    v_pk_mul_f32 v[188:189], v[38:39], v[78:79]
    v_pk_mul_f32 v[178:179], v[34:35], v[72:73]
    v_pk_mul_f32 v[182:183], v[38:39], v[72:73]
    v_pk_mul_f32 v[186:187], v[34:35], v[76:77]
    v_pk_mul_f32 v[190:191], v[38:39], v[76:77]
    v_pk_fma_f32 v[144:145], v[32:33], v[72:73], v[176:177] neg_lo:[0,0,1] neg_hi:[0,0,1]
    v_pk_fma_f32 v[148:149], v[36:37], v[72:73], v[180:181] neg_lo:[0,0,1] neg_hi:[0,0,1]
    v_pk_fma_f32 v[152:153], v[32:33], v[76:77], v[184:185] neg_lo:[0,0,1] neg_hi:[0,0,1]
    v_pk_fma_f32 v[156:157], v[36:37], v[76:77], v[188:189] neg_lo:[0,0,1] neg_hi:[0,0,1]
    v_pk_fma_f32 v[146:147], v[32:33], v[74:75], v[178:179]
    v_pk_fma_f32 v[150:151], v[36:37], v[74:75], v[182:183]
    v_pk_fma_f32 v[154:155], v[32:33], v[78:79], v[186:187]
    v_pk_fma_f32 v[158:159], v[36:37], v[78:79], v[190:191]
    v_cvt_pk_f16_f32 v192, v144, v146
    v_cvt_pk_f16_f32 v194, v148, v150
    v_cvt_pk_f16_f32 v196, v152, v154
    v_cvt_pk_f16_f32 v198, v156, v158
    v_cvt_pk_f16_f32 v193, v145, v147
    v_cvt_pk_f16_f32 v195, v149, v151
    v_cvt_pk_f16_f32 v197, v153, v155
    v_cvt_pk_f16_f32 v199, v157, v159
    ds_write_b64 v4, v[192:193] offset:1584
    ds_write_b64 v4, v[194:195] offset:5808
    ds_write_b64 v4, v[196:197] offset:2112
    ds_write_b64 v4, v[198:199] offset:6336
    v_pk_mul_f32 v[176:177], v[34:35], v[82:83]
    v_pk_mul_f32 v[180:181], v[38:39], v[82:83]
    v_pk_mul_f32 v[184:185], v[34:35], v[86:87]
    v_pk_mul_f32 v[188:189], v[38:39], v[86:87]
    v_pk_mul_f32 v[178:179], v[34:35], v[80:81]
    v_pk_mul_f32 v[182:183], v[38:39], v[80:81]
    v_pk_mul_f32 v[186:187], v[34:35], v[84:85]
    v_pk_mul_f32 v[190:191], v[38:39], v[84:85]
    v_pk_fma_f32 v[144:145], v[32:33], v[80:81], v[176:177] neg_lo:[0,0,1] neg_hi:[0,0,1]
    v_pk_fma_f32 v[148:149], v[36:37], v[80:81], v[180:181] neg_lo:[0,0,1] neg_hi:[0,0,1]
    v_pk_fma_f32 v[152:153], v[32:33], v[84:85], v[184:185] neg_lo:[0,0,1] neg_hi:[0,0,1]
    v_pk_fma_f32 v[156:157], v[36:37], v[84:85], v[188:189] neg_lo:[0,0,1] neg_hi:[0,0,1]
    v_pk_fma_f32 v[146:147], v[32:33], v[82:83], v[178:179]
    v_pk_fma_f32 v[150:151], v[36:37], v[82:83], v[182:183]
    v_pk_fma_f32 v[154:155], v[32:33], v[86:87], v[186:187]
    v_pk_fma_f32 v[158:159], v[36:37], v[86:87], v[190:191]
    v_cvt_pk_f16_f32 v192, v144, v146
    v_cvt_pk_f16_f32 v194, v148, v150
    v_cvt_pk_f16_f32 v196, v152, v154
    v_cvt_pk_f16_f32 v198, v156, v158
    v_cvt_pk_f16_f32 v193, v145, v147
    v_cvt_pk_f16_f32 v195, v149, v151
    v_cvt_pk_f16_f32 v197, v153, v155
    v_cvt_pk_f16_f32 v199, v157, v159
    ds_write_b64 v4, v[192:193] offset:2640
    ds_write_b64 v4, v[194:195] offset:6864
    ds_write_b64 v4, v[196:197] offset:3168
    ds_write_b64 v4, v[198:199] offset:7392
    v_pk_mul_f32 v[176:177], v[34:35], v[90:91]
    v_pk_mul_f32 v[180:181], v[38:39], v[90:91]
    v_pk_mul_f32 v[178:179], v[34:35], v[88:89]
    v_pk_mul_f32 v[182:183], v[38:39], v[88:89]
    v_pk_fma_f32 v[144:145], v[32:33], v[88:89], v[176:177] neg_lo:[0,0,1] neg_hi:[0,0,1]
    v_pk_fma_f32 v[148:149], v[36:37], v[88:89], v[180:181] neg_lo:[0,0,1] neg_hi:[0,0,1]
    v_pk_fma_f32 v[146:147], v[32:33], v[90:91], v[178:179]
    v_pk_fma_f32 v[150:151], v[36:37], v[90:91], v[182:183]
    v_cvt_pk_f16_f32 v192, v144, v146
    v_cvt_pk_f16_f32 v194, v148, v150
    v_cvt_pk_f16_f32 v193, v145, v147
    v_cvt_pk_f16_f32 v195, v149, v151
    ds_write_b64 v4, v[192:193] offset:3696
    ds_write_b64 v4, v[194:195] offset:7920
    ds_read_b128 v[144:147], v5 offset:0
    ds_read_b128 v[148:151], v5 offset:64
    ds_read_b128 v[152:155], v5 offset:128
    ds_read_b128 v[156:159], v5 offset:192
    ds_read_b128 v[160:163], v5 offset:256
    ds_read_b128 v[164:167], v5 offset:320
    ds_read_b128 v[168:171], v5 offset:384
    ds_read_b128 v[172:175], v5 offset:448
    s_waitcnt lgkmcnt(7)
    v_mfma_f32_16x16x32_f16 v[12:15], v[144:147], v[112:115], 0
    s_waitcnt lgkmcnt(6)
    v_mfma_f32_16x16x32_f16 v[12:15], v[148:151], v[116:119], v[12:15]
    s_waitcnt lgkmcnt(5)
    v_mfma_f32_16x16x32_f16 v[12:15], v[152:155], v[120:123], v[12:15]
    s_waitcnt lgkmcnt(4)
    v_mfma_f32_16x16x32_f16 v[12:15], v[156:159], v[124:127], v[12:15]
    s_waitcnt lgkmcnt(3)
    v_mfma_f32_16x16x32_f16 v[12:15], v[160:163], v[128:131], v[12:15]
    s_waitcnt lgkmcnt(2)
    v_mfma_f32_16x16x32_f16 v[12:15], v[164:167], v[132:135], v[12:15]
    s_waitcnt lgkmcnt(1)
    v_mfma_f32_16x16x32_f16 v[12:15], v[168:171], v[136:139], v[12:15]
    s_waitcnt lgkmcnt(0)
    v_mfma_f32_16x16x32_f16 v[12:15], v[172:175], v[140:143], v[12:15]
    v_cvt_pk_f16_f32 v192, v40, v42
    v_pk_mul_f32 v[180:181], v[42:43], v[70:71]
    v_pk_mul_f32 v[184:185], v[42:43], v[78:79]
    v_pk_mul_f32 v[188:189], v[42:43], v[86:87]
    v_cvt_pk_f16_f32 v193, v41, v43
    v_pk_mul_f32 v[182:183], v[42:43], v[68:69]
    v_pk_mul_f32 v[186:187], v[42:43], v[76:77]
    v_pk_mul_f32 v[190:191], v[42:43], v[84:85]
    ds_write_b64 v4, v[192:193] offset:0
    v_pk_fma_f32 v[204:205], v[40:41], v[68:69], v[180:181] neg_lo:[0,0,1] neg_hi:[0,0,1]
    v_pk_fma_f32 v[208:209], v[40:41], v[76:77], v[184:185] neg_lo:[0,0,1] neg_hi:[0,0,1]
    v_pk_fma_f32 v[212:213], v[40:41], v[84:85], v[188:189] neg_lo:[0,0,1] neg_hi:[0,0,1]
    v_pk_fma_f32 v[206:207], v[40:41], v[70:71], v[182:183]
    v_pk_fma_f32 v[210:211], v[40:41], v[78:79], v[186:187]
    v_pk_fma_f32 v[214:215], v[40:41], v[86:87], v[190:191]
    v_cvt_pk_f16_f32 v194, v204, v206
    v_cvt_pk_f16_f32 v196, v208, v210
    v_cvt_pk_f16_f32 v198, v212, v214
    v_cvt_pk_f16_f32 v195, v205, v207
    v_cvt_pk_f16_f32 v197, v209, v211
    v_cvt_pk_f16_f32 v199, v213, v215
    ds_write_b64 v4, v[194:195] offset:528
    ds_write_b64 v4, v[196:197] offset:1056
    ds_write_b64 v4, v[198:199] offset:1584
    v_mul_f32 v12, v12, v23
    v_mul_f32 v13, v13, v23
    v_mul_f32 v14, v14, v23
    v_mul_f32 v15, v15, v23
    v_cvt_pk_bf16_f32 v12, v12, v13
    v_cvt_pk_bf16_f32 v13, v14, v15
    v_add_u32_e64 v14, s68, v6
    ds_write_b64 v14, v[12:13]
    v_cvt_pk_f16_f32 v192, v44, v46
    v_pk_mul_f32 v[180:181], v[46:47], v[70:71]
    v_pk_mul_f32 v[184:185], v[46:47], v[78:79]
    v_pk_mul_f32 v[188:189], v[46:47], v[86:87]
    v_cvt_pk_f16_f32 v193, v45, v47
    v_pk_mul_f32 v[182:183], v[46:47], v[68:69]
    v_pk_mul_f32 v[186:187], v[46:47], v[76:77]
    v_pk_mul_f32 v[190:191], v[46:47], v[84:85]
    ds_write_b64 v4, v[192:193] offset:2112
    v_pk_fma_f32 v[204:205], v[44:45], v[68:69], v[180:181] neg_lo:[0,0,1] neg_hi:[0,0,1]
    v_pk_fma_f32 v[208:209], v[44:45], v[76:77], v[184:185] neg_lo:[0,0,1] neg_hi:[0,0,1]
    v_pk_fma_f32 v[212:213], v[44:45], v[84:85], v[188:189] neg_lo:[0,0,1] neg_hi:[0,0,1]
    v_pk_fma_f32 v[206:207], v[44:45], v[70:71], v[182:183]
    v_pk_fma_f32 v[210:211], v[44:45], v[78:79], v[186:187]
    v_pk_fma_f32 v[214:215], v[44:45], v[86:87], v[190:191]
    v_cvt_pk_f16_f32 v194, v204, v206
    v_cvt_pk_f16_f32 v196, v208, v210
    v_cvt_pk_f16_f32 v198, v212, v214
    v_cvt_pk_f16_f32 v195, v205, v207
    v_cvt_pk_f16_f32 v197, v209, v211
    v_cvt_pk_f16_f32 v199, v213, v215
    ds_write_b64 v4, v[194:195] offset:2640
    ds_write_b64 v4, v[196:197] offset:3168
    ds_write_b64 v4, v[198:199] offset:3696
    v_cvt_pk_f16_f32 v192, v48, v50
    v_pk_mul_f32 v[180:181], v[50:51], v[78:79]
    v_cvt_pk_f16_f32 v196, v52, v54
    v_pk_mul_f32 v[188:189], v[54:55], v[78:79]
    v_cvt_pk_f16_f32 v193, v49, v51
    v_pk_mul_f32 v[182:183], v[50:51], v[76:77]
    v_cvt_pk_f16_f32 v197, v53, v55
    v_pk_mul_f32 v[190:191], v[54:55], v[76:77]
    ds_write_b64 v4, v[192:193] offset:4224
    v_pk_fma_f32 v[204:205], v[48:49], v[76:77], v[180:181] neg_lo:[0,0,1] neg_hi:[0,0,1]
    ds_write_b64 v4, v[196:197] offset:5280
    v_pk_fma_f32 v[212:213], v[52:53], v[76:77], v[188:189] neg_lo:[0,0,1] neg_hi:[0,0,1]
    v_pk_fma_f32 v[206:207], v[48:49], v[78:79], v[182:183]
    v_pk_fma_f32 v[214:215], v[52:53], v[78:79], v[190:191]
    v_cvt_pk_f16_f32 v194, v204, v206
    v_cvt_pk_f16_f32 v198, v212, v214
    v_cvt_pk_f16_f32 v195, v205, v207
    v_cvt_pk_f16_f32 v199, v213, v215
    ds_write_b64 v4, v[194:195] offset:4752
    ds_write_b64 v4, v[198:199] offset:5808
    v_cvt_pk_f16_f32 v192, v56, v58
    v_pk_mul_f32 v[180:181], v[58:59], v[78:79]
    v_cvt_pk_f16_f32 v196, v60, v62
    v_pk_mul_f32 v[188:189], v[62:63], v[78:79]
    v_cvt_pk_f16_f32 v193, v57, v59
    v_pk_mul_f32 v[182:183], v[58:59], v[76:77]
    v_cvt_pk_f16_f32 v197, v61, v63
    v_pk_mul_f32 v[190:191], v[62:63], v[76:77]
    ds_write_b64 v4, v[192:193] offset:6336
    v_pk_fma_f32 v[204:205], v[56:57], v[76:77], v[180:181] neg_lo:[0,0,1] neg_hi:[0,0,1]
    ds_write_b64 v4, v[196:197] offset:7392
    v_pk_fma_f32 v[212:213], v[60:61], v[76:77], v[188:189] neg_lo:[0,0,1] neg_hi:[0,0,1]
    v_pk_fma_f32 v[206:207], v[56:57], v[78:79], v[182:183]
    v_pk_fma_f32 v[214:215], v[60:61], v[78:79], v[190:191]
    v_cvt_pk_f16_f32 v194, v204, v206
    v_cvt_pk_f16_f32 v198, v212, v214
    v_cvt_pk_f16_f32 v195, v205, v207
    v_cvt_pk_f16_f32 v199, v213, v215
    ds_write_b64 v4, v[194:195] offset:6864
    ds_write_b64 v4, v[198:199] offset:7920
    ds_read_b128 v[144:147], v5 offset:0
    ds_read_b128 v[148:151], v5 offset:64
    ds_read_b128 v[152:155], v5 offset:128
    ds_read_b128 v[156:159], v5 offset:192
    ds_read_b128 v[160:163], v5 offset:256
    ds_read_b128 v[164:167], v5 offset:320
    ds_read_b128 v[168:171], v5 offset:384
    ds_read_b128 v[172:175], v5 offset:448
    s_waitcnt lgkmcnt(7)
    v_mfma_f32_16x16x32_f16 v[12:15], v[144:147], v[112:115], 0
    s_waitcnt lgkmcnt(6)
    v_mfma_f32_16x16x32_f16 v[12:15], v[148:151], v[116:119], v[12:15]
    s_waitcnt lgkmcnt(5)
    v_mfma_f32_16x16x32_f16 v[12:15], v[152:155], v[120:123], v[12:15]
    s_waitcnt lgkmcnt(4)
    v_mfma_f32_16x16x32_f16 v[12:15], v[156:159], v[124:127], v[12:15]
    s_waitcnt lgkmcnt(3)
    v_mfma_f32_16x16x32_f16 v[12:15], v[160:163], v[128:131], v[12:15]
    s_waitcnt lgkmcnt(2)
    v_mfma_f32_16x16x32_f16 v[12:15], v[164:167], v[132:135], v[12:15]
    s_waitcnt lgkmcnt(1)
    v_mfma_f32_16x16x32_f16 v[12:15], v[168:171], v[136:139], v[12:15]
    s_waitcnt lgkmcnt(0)
    v_mfma_f32_16x16x32_f16 v[12:15], v[172:175], v[140:143], v[12:15]
    buffer_load_dwordx4 v[24:27], v218, s[28:31], s94 offen sc1
    v_pk_mul_f32 v[176:177], v[34:35], v[110:111]
    v_pk_mul_f32 v[180:181], v[38:39], v[110:111]
    v_pk_mul_f32 v[184:185], v[42:43], v[110:111]
    v_pk_mul_f32 v[188:189], v[46:47], v[110:111]
    v_pk_mul_f32 v[178:179], v[34:35], v[108:109]
    v_pk_mul_f32 v[182:183], v[38:39], v[108:109]
    v_pk_mul_f32 v[186:187], v[42:43], v[108:109]
    v_pk_mul_f32 v[190:191], v[46:47], v[108:109]
    v_pk_fma_f32 v[64:65], v[32:33], v[108:109], v[176:177] neg_lo:[0,0,1] neg_hi:[0,0,1]
    v_pk_fma_f32 v[204:205], v[36:37], v[108:109], v[180:181] neg_lo:[0,0,1] neg_hi:[0,0,1]
    v_pk_fma_f32 v[208:209], v[40:41], v[108:109], v[184:185] neg_lo:[0,0,1] neg_hi:[0,0,1]
    v_pk_fma_f32 v[212:213], v[44:45], v[108:109], v[188:189] neg_lo:[0,0,1] neg_hi:[0,0,1]
    v_pk_fma_f32 v[66:67], v[32:33], v[110:111], v[178:179]
    v_pk_fma_f32 v[206:207], v[36:37], v[110:111], v[182:183]
    v_pk_fma_f32 v[210:211], v[40:41], v[110:111], v[186:187]
    v_pk_fma_f32 v[214:215], v[44:45], v[110:111], v[190:191]
    v_cvt_pk_f16_f32 v192, v64, v66
    v_cvt_pk_f16_f32 v194, v204, v206
    v_cvt_pk_f16_f32 v196, v208, v210
    v_cvt_pk_f16_f32 v198, v212, v214
    v_cvt_pk_f16_f32 v193, v65, v67
    v_cvt_pk_f16_f32 v195, v205, v207
    v_cvt_pk_f16_f32 v197, v209, v211
    v_cvt_pk_f16_f32 v199, v213, v215
    ds_write_b64 v4, v[192:193] offset:0
    ds_write_b64 v4, v[194:195] offset:528
    ds_write_b64 v4, v[196:197] offset:1056
    ds_write_b64 v4, v[198:199] offset:1584
    v_mul_f32 v12, v12, v23
    v_mul_f32 v13, v13, v23
    v_mul_f32 v14, v14, v23
    v_mul_f32 v15, v15, v23
    v_cvt_pk_bf16_f32 v12, v12, v13
    v_cvt_pk_bf16_f32 v13, v14, v15
    v_add_u32 v14, s68, v7
    v_add_u32 v15, s68, v8
    ds_write_b32 v14, v12
    ds_write_b32 v15, v13
    v_pk_mul_f32 v[176:177], v[50:51], v[110:111]
    v_pk_mul_f32 v[180:181], v[54:55], v[110:111]
    v_pk_mul_f32 v[184:185], v[58:59], v[110:111]
    v_pk_mul_f32 v[188:189], v[62:63], v[110:111]
    v_pk_mul_f32 v[178:179], v[50:51], v[108:109]
    v_pk_mul_f32 v[182:183], v[54:55], v[108:109]
    v_pk_mul_f32 v[186:187], v[58:59], v[108:109]
    v_pk_mul_f32 v[190:191], v[62:63], v[108:109]
    v_pk_fma_f32 v[200:201], v[48:49], v[108:109], v[176:177] neg_lo:[0,0,1] neg_hi:[0,0,1]
    v_pk_fma_f32 v[204:205], v[52:53], v[108:109], v[180:181] neg_lo:[0,0,1] neg_hi:[0,0,1]
    v_pk_fma_f32 v[208:209], v[56:57], v[108:109], v[184:185] neg_lo:[0,0,1] neg_hi:[0,0,1]
    v_pk_fma_f32 v[212:213], v[60:61], v[108:109], v[188:189] neg_lo:[0,0,1] neg_hi:[0,0,1]
    v_pk_fma_f32 v[202:203], v[48:49], v[110:111], v[178:179]
    v_pk_fma_f32 v[206:207], v[52:53], v[110:111], v[182:183]
    v_pk_fma_f32 v[210:211], v[56:57], v[110:111], v[186:187]
    v_pk_fma_f32 v[214:215], v[60:61], v[110:111], v[190:191]
    v_cvt_pk_f16_f32 v192, v200, v202
    v_cvt_pk_f16_f32 v194, v204, v206
    v_cvt_pk_f16_f32 v196, v208, v210
    v_cvt_pk_f16_f32 v198, v212, v214
    v_cvt_pk_f16_f32 v193, v201, v203
    v_cvt_pk_f16_f32 v195, v205, v207
    v_cvt_pk_f16_f32 v197, v209, v211
    v_cvt_pk_f16_f32 v199, v213, v215
    ds_write_b64 v4, v[192:193] offset:2112
    ds_write_b64 v4, v[194:195] offset:2640
    ds_write_b64 v4, v[196:197] offset:3168
    ds_write_b64 v4, v[198:199] offset:3696
    v_pk_mul_f32 v[176:177], v[66:67], v[110:111]
    v_pk_mul_f32 v[178:179], v[66:67], v[108:109]
    v_pk_fma_f32 v[200:201], v[64:65], v[108:109], v[176:177] neg_lo:[0,0,1] neg_hi:[0,0,1]
    v_pk_fma_f32 v[202:203], v[64:65], v[110:111], v[178:179]
    v_cvt_pk_f16_f32 v192, v200, v202
    v_cvt_pk_f16_f32 v193, v201, v203
    ds_write_b64 v4, v[192:193] offset:4224
    ds_read_b128 v[144:147], v5 offset:0
    ds_read_b128 v[148:151], v5 offset:64
    ds_read_b128 v[152:155], v5 offset:128
    ds_read_b128 v[156:159], v5 offset:192
    ds_read_b128 v[160:163], v5 offset:256
    ds_read_b128 v[164:167], v5 offset:320
    ds_read_b128 v[168:171], v5 offset:384
    ds_read_b128 v[172:175], v5 offset:448
    s_waitcnt lgkmcnt(7)
    v_mfma_f32_16x16x32_f16 v[12:15], v[144:147], v[112:115], 0
    s_waitcnt lgkmcnt(6)
    v_mfma_f32_16x16x32_f16 v[12:15], v[148:151], v[116:119], v[12:15]
    s_waitcnt lgkmcnt(5)
    v_mfma_f32_16x16x32_f16 v[12:15], v[152:155], v[120:123], v[12:15]
    s_waitcnt lgkmcnt(4)
    v_mfma_f32_16x16x32_f16 v[12:15], v[156:159], v[124:127], v[12:15]
    s_waitcnt lgkmcnt(3)
    v_mfma_f32_16x16x32_f16 v[12:15], v[160:163], v[128:131], v[12:15]
    s_waitcnt lgkmcnt(2)
    v_mfma_f32_16x16x32_f16 v[12:15], v[164:167], v[132:135], v[12:15]
    s_waitcnt lgkmcnt(1)
    v_mfma_f32_16x16x32_f16 v[12:15], v[168:171], v[136:139], v[12:15]
    s_waitcnt lgkmcnt(0)
    v_mfma_f32_16x16x32_f16 v[12:15], v[172:175], v[140:143], v[12:15]
    s_waitcnt vmcnt(0)
    s_cmp_lg_u32 s93, 0
    s_cbranch_scc1 L_uf_skip
    v_xor_b32 v24, s6, v24
    v_xor_b32 v25, s6, v25
    v_xor_b32 v26, s6, v26
    v_xor_b32 v27, s6, v27
    v_or3_b32 v24, v24, v25, v26
    v_or_b32 v24, v24, v27
    v_cmp_ne_u32 vcc, 0, v24
    s_cbranch_vccnz L_uf_skip
    s_mov_b32 s93, 1
    s_add_u32 s92, s70, s3
    s_lshl_b32 s78, s92, 12
    s_add_u32 s78, s78, 1048576
    s_sub_u32 s80, s78, 4
    s_add_u32 m0, s67, 13440
    s_lshl_b32 s81, s92, 1
    buffer_load_dwordx4 v11, s[28:31], s78 offen offset:0 sc1 lds
    buffer_load_dwordx4 v11, s[28:31], s78 offen offset:1024 sc1 lds
    buffer_load_dwordx4 v11, s[28:31], s78 offen offset:2048 sc1 lds
    buffer_load_dwordx4 v11, s[28:31], s78 offen offset:3072 sc1 lds
    s_add_u32 m0, s67, 9216
    s_nop 0
    buffer_load_dwordx4 v11, s[28:31], s80 offen offset:0 sc1 lds
    buffer_load_dwordx4 v11, s[28:31], s80 offen offset:1024 sc1 lds
    buffer_load_dwordx4 v11, s[28:31], s80 offen offset:2048 sc1 lds
    buffer_load_dwordx4 v11, s[28:31], s80 offen offset:3072 sc1 lds
    buffer_load_ushort v22, v10, s[32:35], s81 offen
L_uf_skip:
    s_cmp_lg_u32 s69, 0
    s_cbranch_scc1 L_wj3_skip
    s_cmp_eq_u32 s71, 0
    s_cbranch_scc1 L_wj3_skip
    s_lshl_b32 s78, s73, 5
    s_add_u32 s78, s78, s72
    s_lshl_b32 s78, s78, 7
    s_add_u32 s78, s78, 458752
    v_mov_b32 v28, s6
    v_lshlrev_b32 v29, 2, v1
    s_mov_b32 exec_hi, 0
    buffer_store_dword v28, v29, s[28:31], s78 offen sc1
    s_mov_b64 exec, -1
L_wj3_skip:
    v_mul_f32 v12, v12, v23
    v_mul_f32 v13, v13, v23
    v_mul_f32 v14, v14, v23
    v_mul_f32 v15, v15, v23
    v_cvt_pk_bf16_f32 v12, v12, v13
    v_cvt_pk_bf16_f32 v13, v14, v15
    v_add_u32 v14, s68, v9
    ds_write_b16 v14, v12
    ds_write_b16_d16_hi v14, v12 offset:32
    ds_write_b16 v14, v13 offset:64
    ds_write_b16_d16_hi v14, v13 offset:96
    v_mov_b32 v15, s68
    ds_write_b32 v15, v10 offset:1536
    s_cmp_lg_u32 s69, 0
    s_cbranch_scc1 L_kgen_done
    s_cmp_lt_u32 s3, 6
    s_cbranch_scc1 L_kgen_done
    s_mov_b32 s69, 1
    s_add_u32 s68, s68, 3136
    s_branch L_kgen
L_kgen_done:
    s_add_u32 s66, s70, s3
    v_and_b32 v12, 1, v3
    v_mul_u32_u24 v60, 4576, v12
    v_lshrrev_b32 v13, 1, v3
    v_lshlrev_b32 v13, 6, v13
    v_lshl_add_u32 v13, v2, 4, v13
    v_sub_u32 v60, v60, v13
    v_add_u32 v60, 944, v60
    v_add_u32 v60, s67, v60
    v_mul_u32_u24 v61, 4224, v12
    v_or_b32 v13, 1, v3
    v_lshl_add_u32 v61, v13, 2, v61
    v_lshlrev_b32 v13, 4, v2
    v_sub_u32 v61, v61, v13
    v_add_u32 v61, 9652, v61
    v_add_u32 v61, s67, v61
    v_add_u32 v62, s67, v11
    v_and_b32 v12, 31, v1
    v_min_u32 v12, 29, v12
    v_lshlrev_b32 v12, 4, v12
    v_lshrrev_b32 v13, 5, v1
    v_mul_u32_u24 v13, 4576, v13
    v_add3_u32 v63, v12, v13, s67
    v_lshlrev_b32 v66, 7, v2
    v_lshl_add_u32 v66, v3, 2, v66
    v_add_u32 v66, s67, v66
    v_add_u32 v65, 13440, v66
    v_lshrrev_b32 v12, 3, v1
    s_mov_b32 s78, 81920
    v_mul_lo_u32 v67, v12, s78
    v_and_b32 v12, 7, v1
    v_lshl_add_u32 v67, v12, 4, v67
    v_mov_b32 v72, 0
    v_mov_b32 v73, 0
    v_mov_b32 v74, 0
    v_mov_b32 v75, 0
    v_and_b32 v12, 3, v1
    v_lshlrev_b32 v12, 4, v12
    v_bfe_u32 v13, v1, 2, 1
    v_mul_u32_u24 v13, 4224, v13
    v_add3_u32 v12, v12, v13, s67
    ds_write_b128 v12, v[72:75] offset:9152
    s_mov_b32 s69, 0
    s_mov_b32 s75, 8
    s_mov_b32 s76, 0
    s_add_u32 s66, s70, s3
    s_mul_i32 s68, s3, 1568
    s_add_u32 s68, s68, 140800
    v_add_u32 v220, s68, v220
    v_add_u32 v221, s68, v221
    v_add_u32 v222, s68, v222
    v_add_u32 v223, s68, v223
    v_add_u32 v224, s68, v224
    v_add_u32 v225, s68, v225
    v_add_u32 v226, s68, v226
    v_add_u32 v227, s68, v227
    v_add_u32 v228, s68, v228
    v_add_u32 v229, s68, v229
    v_add_u32 v230, s68, v230
    v_add_u32 v231, s68, v231
    v_add_u32 v232, s68, v232
    v_add_u32 v233, s68, v233
    v_add_u32 v234, s68, v234
    v_add_u32 v235, s68, v235
    v_add_u32 v236, s68, v236
    v_add_u32 v237, s68, v237
    v_add_u32 v238, s68, v238
    v_add_u32 v239, s68, v239
    v_add_u32 v240, s68, v240
    v_add_u32 v241, s68, v241
    v_add_u32 v242, s68, v242
    v_add_u32 v243, s68, v243
    v_add_u32 v244, s68, v244
    v_add_u32 v245, s68, v245
    v_add_u32 v246, s68, v246
    v_add_u32 v247, s68, v247
    v_add_u32 v248, s68, v248
    v_add_u32 v249, s68, v249
    v_add_u32 v250, s68, v250
    v_add_u32 v251, s68, v251
    v_add_u32 v252, s68, v252
    v_add_u32 v253, s68, v253
    v_add_u32 v254, s68, v254
    v_add_u32 v255, s68, v255
    s_setprio 0
L_conv:
    s_nop 0
    ds_read_u16 v76, v220
    ds_read_u16 v77, v221
    ds_read_u16 v78, v222
    ds_read_u16 v79, v223
    ds_read_u16 v80, v224
    ds_read_u16 v81, v225
    ds_read_u16 v82, v226
    ds_read_u16 v83, v227
    ds_read_u16 v84, v228
    s_waitcnt lgkmcnt(0)
    s_nop 0
    v_lshl_or_b32 v112, v78, 16, v77
    v_lshl_or_b32 v116, v77, 16, v76
    v_lshl_or_b32 v113, v80, 16, v79
    v_lshl_or_b32 v117, v79, 16, v78
    v_lshl_or_b32 v114, v82, 16, v81
    v_lshl_or_b32 v118, v81, 16, v80
    v_lshl_or_b32 v115, v84, 16, v83
    v_lshl_or_b32 v119, v83, 16, v82
    ds_write_b128 v62, v[112:115] offset:0
    ds_write_b128 v62, v[116:119] offset:4576
    ds_read_u16 v85, v229
    ds_read_u16 v86, v230
    ds_read_u16 v87, v231
    ds_read_u16 v88, v232
    ds_read_u16 v89, v233
    ds_read_u16 v90, v234
    ds_read_u16 v91, v235
    ds_read_u16 v92, v236
    ds_read_u16 v93, v237
    s_waitcnt lgkmcnt(0)
    s_nop 0
    v_lshl_or_b32 v120, v87, 16, v86
    v_lshl_or_b32 v124, v86, 16, v85
    v_lshl_or_b32 v121, v89, 16, v88
    v_lshl_or_b32 v125, v88, 16, v87
    v_lshl_or_b32 v122, v91, 16, v90
    v_lshl_or_b32 v126, v90, 16, v89
    v_lshl_or_b32 v123, v93, 16, v92
    v_lshl_or_b32 v127, v92, 16, v91
    ds_write_b128 v62, v[120:123] offset:1024
    ds_write_b128 v62, v[124:127] offset:5600
    ds_read_u16 v94, v238
    ds_read_u16 v95, v239
    ds_read_u16 v96, v240
    ds_read_u16 v97, v241
    ds_read_u16 v98, v242
    ds_read_u16 v99, v243
    ds_read_u16 v100, v244
    ds_read_u16 v101, v245
    ds_read_u16 v102, v246
    s_waitcnt lgkmcnt(0)
    s_nop 0
    v_lshl_or_b32 v112, v96, 16, v95
    v_lshl_or_b32 v116, v95, 16, v94
    v_lshl_or_b32 v113, v98, 16, v97
    v_lshl_or_b32 v117, v97, 16, v96
    v_lshl_or_b32 v114, v100, 16, v99
    v_lshl_or_b32 v118, v99, 16, v98
    v_lshl_or_b32 v115, v102, 16, v101
    v_lshl_or_b32 v119, v101, 16, v100
    ds_write_b128 v62, v[112:115] offset:2048
    ds_write_b128 v62, v[116:119] offset:6624
    ds_read_u16 v103, v247
    ds_read_u16 v104, v248
    ds_read_u16 v105, v249
    ds_read_u16 v106, v250
    ds_read_u16 v107, v251
    ds_read_u16 v108, v252
    ds_read_u16 v109, v253
    ds_read_u16 v110, v254
    ds_read_u16 v111, v255
    s_waitcnt lgkmcnt(0)
    s_nop 0
    v_lshl_or_b32 v120, v105, 16, v104
    v_lshl_or_b32 v124, v104, 16, v103
    v_lshl_or_b32 v121, v107, 16, v106
    v_lshl_or_b32 v125, v106, 16, v105
    v_lshl_or_b32 v122, v109, 16, v108
    v_lshl_or_b32 v126, v108, 16, v107
    v_lshl_or_b32 v123, v111, 16, v110
    v_lshl_or_b32 v127, v110, 16, v109
    ds_write_b128 v62, v[120:123] offset:3072
    ds_write_b128 v62, v[124:127] offset:7648
    ds_write_b128 v63, v[72:75] offset:4096
    v_mov_b32 v69, v60
    v_mov_b32 v70, v61
    v_mov_b32 v12, s67
    s_cmp_lg_u32 s93, 0
    s_cbranch_scc1 L_nofetch
    s_mov_b32 s82, 200000
L_xpoll:
    buffer_load_dwordx4 v[24:27], v218, s[28:31], s94 offen sc1
    s_waitcnt vmcnt(0)
    v_xor_b32 v24, s6, v24
    v_xor_b32 v25, s6, v25
    v_xor_b32 v26, s6, v26
    v_xor_b32 v27, s6, v27
    v_or3_b32 v24, v24, v25, v26
    v_or_b32 v24, v24, v27
    v_cmp_ne_u32 vcc, 0, v24
    s_cbranch_vccz L_xpolld
    s_mov_b64 exec, vcc
    s_sleep 12
    s_sub_u32 s82, s82, 1
    s_cmp_lg_u32 s82, 0
    s_cbranch_scc1 L_xpoll
L_xpolld:
    s_mov_b64 exec, -1
    s_lshl_b32 s78, s66, 12
    s_add_u32 s78, s78, 1048576
    s_sub_u32 s80, s78, 4
    s_add_u32 m0, s67, 13440
    s_lshl_b32 s81, s66, 1
    buffer_load_dwordx4 v11, s[28:31], s78 offen offset:0 sc1 lds
    buffer_load_dwordx4 v11, s[28:31], s78 offen offset:1024 sc1 lds
    buffer_load_dwordx4 v11, s[28:31], s78 offen offset:2048 sc1 lds
    buffer_load_dwordx4 v11, s[28:31], s78 offen offset:3072 sc1 lds
    s_add_u32 m0, s67, 9216
    s_nop 0
    buffer_load_dwordx4 v11, s[28:31], s80 offen offset:0 sc1 lds
    buffer_load_dwordx4 v11, s[28:31], s80 offen offset:1024 sc1 lds
    buffer_load_dwordx4 v11, s[28:31], s80 offen offset:2048 sc1 lds
    buffer_load_dwordx4 v11, s[28:31], s80 offen offset:3072 sc1 lds
    buffer_load_ushort v22, v10, s[32:35], s81 offen
    s_mov_b32 s93, 1
L_nofetch:
    v_mov_b32 v140, 0
    v_mov_b32 v141, 0
    v_mov_b32 v142, 0
    v_mov_b32 v143, 0
    v_mov_b32 v144, 0
    v_mov_b32 v145, 0
    v_mov_b32 v146, 0
    v_mov_b32 v147, 0
    v_mov_b32 v148, 0
    v_mov_b32 v149, 0
    v_mov_b32 v150, 0
    v_mov_b32 v151, 0
    v_mov_b32 v152, 0
    v_mov_b32 v153, 0
    v_mov_b32 v154, 0
    v_mov_b32 v155, 0
    v_mov_b32 v156, 0
    v_mov_b32 v157, 0
    v_mov_b32 v158, 0
    v_mov_b32 v159, 0
    v_mov_b32 v160, 0
    v_mov_b32 v161, 0
    v_mov_b32 v162, 0
    v_mov_b32 v163, 0
    v_mov_b32 v164, 0
    v_mov_b32 v165, 0
    v_mov_b32 v166, 0
    v_mov_b32 v167, 0
    v_mov_b32 v168, 0
    v_mov_b32 v169, 0
    v_mov_b32 v170, 0
    v_mov_b32 v171, 0
    s_mov_b32 s74, s75
    v_subrev_u32 v69, s76, v69
    v_subrev_u32 v70, s76, v70
    s_waitcnt vmcnt(0)
    ds_write_b32 v12, v10 offset:9216
    v_lshlrev_b32 v172, 16, v22
    v_mov_b32 v173, v172
    s_cmp_lg_u32 s69, 0
    s_cbranch_scc1 L_pfq
    v_lshrrev_b32 v30, 3, v1
    v_lshlrev_b32 v30, 12, v30
    v_and_b32 v31, 7, v1
    v_lshl_add_u32 v30, v31, 7, v30
    s_and_b32 s78, s2, 6
    s_lshl_b32 s78, s78, 2
    s_lshr_b32 s80, s4, 3
    s_add_u32 s78, s78, s80
    s_lshl_b32 s78, s78, 3
    s_add_u32 s78, s78, s3
    s_lshl_b32 s78, s78, 15
    s_add_u32 s78, s78, s83
    buffer_load_dword v217, v30, s[52:55], s78 offen
    s_add_u32 s83, s83, 1024
    s_and_b32 s83, s83, 4095
    s_mov_b32 s84, 6
L_pfq:
L_mu0:
    ds_read_b128 v[76:79], v69 offset:3584
    ds_read_b64 v[108:109], v70 offset:0
    ds_read_b64 v[110:111], v70 offset:8
    ds_read_b128 v[80:83], v69 offset:3072
    ds_read_b64 v[112:113], v70 offset:512
    ds_read_b64 v[114:115], v70 offset:520
    ds_read_b128 v[84:87], v69 offset:2560
    ds_read_b64 v[116:117], v70 offset:1024
    ds_read_b64 v[118:119], v70 offset:1032
    ds_read_b128 v[88:91], v69 offset:2048
    ds_read_b64 v[120:121], v70 offset:1536
    ds_read_b64 v[122:123], v70 offset:1544
    ds_read_b128 v[92:95], v69 offset:1536
    ds_read_b64 v[124:125], v70 offset:2048
    ds_read_b64 v[126:127], v70 offset:2056
    s_waitcnt lgkmcnt(12)
    v_mfma_f32_16x16x32_bf16 v[140:143], v[76:79], v[108:111], v[140:143]
    ds_read_b128 v[96:99], v69 offset:1024
    ds_read_b64 v[128:129], v70 offset:2560
    ds_read_b64 v[130:131], v70 offset:2568
    s_waitcnt lgkmcnt(12)
    v_mfma_f32_16x16x32_bf16 v[144:147], v[80:83], v[108:111], v[144:147]
    v_mfma_f32_16x16x32_bf16 v[148:151], v[80:83], v[112:115], v[148:151]
    v_mfma_f32_16x16x32_bf16 v[144:147], v[76:79], v[112:115], v[144:147]
    ds_read_b128 v[100:103], v69 offset:512
    ds_read_b64 v[132:133], v70 offset:3072
    ds_read_b64 v[134:135], v70 offset:3080
    s_waitcnt lgkmcnt(12)
    s_nop 0
    v_mfma_f32_16x16x32_bf16 v[148:151], v[84:87], v[108:111], v[148:151]
    v_mfma_f32_16x16x32_bf16 v[152:155], v[84:87], v[112:115], v[152:155]
    v_mfma_f32_16x16x32_bf16 v[156:159], v[84:87], v[116:119], v[156:159]
    v_mfma_f32_16x16x32_bf16 v[148:151], v[76:79], v[116:119], v[148:151]
    v_mfma_f32_16x16x32_bf16 v[152:155], v[80:83], v[116:119], v[152:155]
    ds_read_b128 v[104:107], v69 offset:0
    ds_read_b64 v[136:137], v70 offset:3584
    ds_read_b64 v[138:139], v70 offset:3592
    s_waitcnt lgkmcnt(12)
    v_mfma_f32_16x16x32_bf16 v[152:155], v[88:91], v[108:111], v[152:155]
    v_mfma_f32_16x16x32_bf16 v[156:159], v[88:91], v[112:115], v[156:159]
    v_mfma_f32_16x16x32_bf16 v[160:163], v[88:91], v[116:119], v[160:163]
    v_mfma_f32_16x16x32_bf16 v[164:167], v[88:91], v[120:123], v[164:167]
    v_mfma_f32_16x16x32_bf16 v[152:155], v[76:79], v[120:123], v[152:155]
    v_mfma_f32_16x16x32_bf16 v[156:159], v[80:83], v[120:123], v[156:159]
    v_mfma_f32_16x16x32_bf16 v[160:163], v[84:87], v[120:123], v[160:163]
    s_waitcnt lgkmcnt(9)
    v_mfma_f32_16x16x32_bf16 v[156:159], v[92:95], v[108:111], v[156:159]
    v_mfma_f32_16x16x32_bf16 v[160:163], v[92:95], v[112:115], v[160:163]
    v_mfma_f32_16x16x32_bf16 v[164:167], v[92:95], v[116:119], v[164:167]
    v_mfma_f32_16x16x32_bf16 v[168:171], v[92:95], v[120:123], v[168:171]
    v_mfma_f32_16x16x32_bf16 v[156:159], v[76:79], v[124:127], v[156:159]
    v_mfma_f32_16x16x32_bf16 v[160:163], v[80:83], v[124:127], v[160:163]
    v_mfma_f32_16x16x32_bf16 v[164:167], v[84:87], v[124:127], v[164:167]
    v_mfma_f32_16x16x32_bf16 v[168:171], v[88:91], v[124:127], v[168:171]
    s_waitcnt lgkmcnt(6)
    v_mfma_f32_16x16x32_bf16 v[160:163], v[96:99], v[108:111], v[160:163]
    v_mfma_f32_16x16x32_bf16 v[164:167], v[96:99], v[112:115], v[164:167]
    v_mfma_f32_16x16x32_bf16 v[168:171], v[96:99], v[116:119], v[168:171]
    v_mfma_f32_16x16x32_bf16 v[160:163], v[76:79], v[128:131], v[160:163]
    v_mfma_f32_16x16x32_bf16 v[164:167], v[80:83], v[128:131], v[164:167]
    v_mfma_f32_16x16x32_bf16 v[168:171], v[84:87], v[128:131], v[168:171]
    s_waitcnt lgkmcnt(3)
    v_mfma_f32_16x16x32_bf16 v[164:167], v[100:103], v[108:111], v[164:167]
    v_mfma_f32_16x16x32_bf16 v[168:171], v[100:103], v[112:115], v[168:171]
    v_mfma_f32_16x16x32_bf16 v[164:167], v[76:79], v[132:135], v[164:167]
    v_mfma_f32_16x16x32_bf16 v[168:171], v[80:83], v[132:135], v[168:171]
    s_waitcnt lgkmcnt(0)
    v_mfma_f32_16x16x32_bf16 v[168:171], v[104:107], v[108:111], v[168:171]
    v_mfma_f32_16x16x32_bf16 v[168:171], v[76:79], v[136:139], v[168:171]
    s_cmp_eq_u32 s84, 0
    s_cbranch_scc1 Lpf_65
    s_add_u32 s92, s77, s83
    buffer_load_dword v217, v216, s[52:55], s92 offen
    s_add_u32 s83, s83, 512
    s_and_b32 s83, s83, 4095
    s_sub_u32 s84, s84, 1
Lpf_65:
    v_subrev_u32 v69, 64, v69
    v_subrev_u32 v70, 64, v70
    s_sub_u32 s74, s74, 1
    s_cmp_lg_u32 s74, 0
    s_cbranch_scc1 L_mu0
    s_cmp_eq_u32 s69, 0
    s_cbranch_scc1 L_epi
    s_cmp_lt_u32 s3, 2
    s_cbranch_scc1 L_red_rd
    ds_write_b128 v62, v[140:143] offset:0
    ds_write_b128 v62, v[144:147] offset:1024
    ds_write_b128 v62, v[148:151] offset:2048
    ds_write_b128 v62, v[152:155] offset:3072
    ds_write_b128 v62, v[156:159] offset:4096
    ds_write_b128 v62, v[160:163] offset:5120
    ds_write_b128 v62, v[164:167] offset:6144
    ds_write_b128 v62, v[168:171] offset:7168
    s_waitcnt lgkmcnt(0)
    s_barrier
    s_branch L_conv_done
L_red_rd:
    s_barrier
    ds_read_b128 v[108:111], v62 offset:35200
    ds_read_b128 v[112:115], v62 offset:36224
    ds_read_b128 v[116:119], v62 offset:37248
    ds_read_b128 v[120:123], v62 offset:38272
    ds_read_b128 v[124:127], v62 offset:39296
    ds_read_b128 v[128:131], v62 offset:40320
    ds_read_b128 v[132:135], v62 offset:41344
    ds_read_b128 v[136:139], v62 offset:42368
    s_waitcnt lgkmcnt(7)
    v_pk_add_f32 v[140:141], v[140:141], v[108:109]
    v_pk_add_f32 v[142:143], v[142:143], v[110:111]
    s_waitcnt lgkmcnt(6)
    v_pk_add_f32 v[144:145], v[144:145], v[112:113]
    v_pk_add_f32 v[146:147], v[146:147], v[114:115]
    s_waitcnt lgkmcnt(5)
    v_pk_add_f32 v[148:149], v[148:149], v[116:117]
    v_pk_add_f32 v[150:151], v[150:151], v[118:119]
    s_waitcnt lgkmcnt(4)
    v_pk_add_f32 v[152:153], v[152:153], v[120:121]
    v_pk_add_f32 v[154:155], v[154:155], v[122:123]
    s_waitcnt lgkmcnt(3)
    v_pk_add_f32 v[156:157], v[156:157], v[124:125]
    v_pk_add_f32 v[158:159], v[158:159], v[126:127]
    s_waitcnt lgkmcnt(2)
    v_pk_add_f32 v[160:161], v[160:161], v[128:129]
    v_pk_add_f32 v[162:163], v[162:163], v[130:131]
    s_waitcnt lgkmcnt(1)
    v_pk_add_f32 v[164:165], v[164:165], v[132:133]
    v_pk_add_f32 v[166:167], v[166:167], v[134:135]
    s_waitcnt lgkmcnt(0)
    v_pk_add_f32 v[168:169], v[168:169], v[136:137]
    v_pk_add_f32 v[170:171], v[170:171], v[138:139]
L_epi:
    ds_read2_b32 v[76:77], v65 offset0:0 offset1:16
    ds_read2_b32 v[78:79], v65 offset0:128 offset1:144
    ds_read_b32 v80, v65 offset:1024
    ds_read_b32 v81, v65 offset:1088
    ds_read_b32 v82, v65 offset:1536
    ds_read_b32 v83, v65 offset:1600
    ds_read_b32 v84, v65 offset:2048
    ds_read_b32 v85, v65 offset:2112
    ds_read_b32 v86, v65 offset:2560
    ds_read_b32 v87, v65 offset:2624
    ds_read_b32 v88, v65 offset:3072
    ds_read_b32 v89, v65 offset:3136
    ds_read_b32 v90, v65 offset:3584
    ds_read_b32 v91, v65 offset:3648
    s_mov_b32 s79, 0xffff0000
    s_waitcnt lgkmcnt(0)
    s_cmp_lg_u32 s69, 0
    s_cbranch_scc1 L_nou2
    s_cmp_ge_u32 s3, 4
    s_cbranch_scc1 L_nou2
    s_lshl_b32 s78, s91, 12
    s_add_u32 s78, s78, 1048576
    s_sub_u32 s80, s78, 4
    s_add_u32 m0, s67, 13440
    s_lshl_b32 s81, s91, 1
    buffer_load_dwordx4 v11, s[28:31], s78 offen offset:0 sc1 lds
    buffer_load_dwordx4 v11, s[28:31], s78 offen offset:1024 sc1 lds
    buffer_load_dwordx4 v11, s[28:31], s78 offen offset:2048 sc1 lds
    buffer_load_dwordx4 v11, s[28:31], s78 offen offset:3072 sc1 lds
    s_add_u32 m0, s67, 9216
    s_nop 0
    buffer_load_dwordx4 v11, s[28:31], s80 offen offset:0 sc1 lds
    buffer_load_dwordx4 v11, s[28:31], s80 offen offset:1024 sc1 lds
    buffer_load_dwordx4 v11, s[28:31], s80 offen offset:2048 sc1 lds
    buffer_load_dwordx4 v11, s[28:31], s80 offen offset:3072 sc1 lds
    buffer_load_ushort v22, v10, s[32:35], s81 offen
L_nou2:
    v_lshlrev_b32 v12, 16, v76
    v_and_b32 v13, s79, v76
    v_pk_fma_f32 v[140:141], v[12:13], v[172:173], v[140:141]
    v_cvt_pk_bf16_f32 v140, v140, v141
    ds_write_b32 v66, v140 offset:0
    v_lshlrev_b32 v14, 16, v77
    v_and_b32 v15, s79, v77
    v_pk_fma_f32 v[142:143], v[14:15], v[172:173], v[142:143]
    v_cvt_pk_bf16_f32 v142, v142, v143
    ds_write_b32 v66, v142 offset:64
    v_lshlrev_b32 v12, 16, v78
    v_and_b32 v13, s79, v78
    v_pk_fma_f32 v[144:145], v[12:13], v[172:173], v[144:145]
    v_cvt_pk_bf16_f32 v144, v144, v145
    ds_write_b32 v66, v144 offset:512
    v_lshlrev_b32 v14, 16, v79
    v_and_b32 v15, s79, v79
    v_pk_fma_f32 v[146:147], v[14:15], v[172:173], v[146:147]
    v_cvt_pk_bf16_f32 v146, v146, v147
    ds_write_b32 v66, v146 offset:576
    v_lshlrev_b32 v12, 16, v80
    v_and_b32 v13, s79, v80
    v_pk_fma_f32 v[148:149], v[12:13], v[172:173], v[148:149]
    v_cvt_pk_bf16_f32 v148, v148, v149
    ds_write_b32 v66, v148 offset:1024
    v_lshlrev_b32 v14, 16, v81
    v_and_b32 v15, s79, v81
    v_pk_fma_f32 v[150:151], v[14:15], v[172:173], v[150:151]
    v_cvt_pk_bf16_f32 v150, v150, v151
    ds_write_b32 v66, v150 offset:1088
    v_lshlrev_b32 v12, 16, v82
    v_and_b32 v13, s79, v82
    v_pk_fma_f32 v[152:153], v[12:13], v[172:173], v[152:153]
    v_cvt_pk_bf16_f32 v152, v152, v153
    ds_write_b32 v66, v152 offset:1536
    v_lshlrev_b32 v14, 16, v83
    v_and_b32 v15, s79, v83
    v_pk_fma_f32 v[154:155], v[14:15], v[172:173], v[154:155]
    v_cvt_pk_bf16_f32 v154, v154, v155
    ds_write_b32 v66, v154 offset:1600
    v_lshlrev_b32 v12, 16, v84
    v_and_b32 v13, s79, v84
    v_pk_fma_f32 v[156:157], v[12:13], v[172:173], v[156:157]
    v_cvt_pk_bf16_f32 v156, v156, v157
    ds_write_b32 v66, v156 offset:2048
    v_lshlrev_b32 v14, 16, v85
    v_and_b32 v15, s79, v85
    v_pk_fma_f32 v[158:159], v[14:15], v[172:173], v[158:159]
    v_cvt_pk_bf16_f32 v158, v158, v159
    ds_write_b32 v66, v158 offset:2112
    v_lshlrev_b32 v12, 16, v86
    v_and_b32 v13, s79, v86
    v_pk_fma_f32 v[160:161], v[12:13], v[172:173], v[160:161]
    v_cvt_pk_bf16_f32 v160, v160, v161
    ds_write_b32 v66, v160 offset:2560
    v_lshlrev_b32 v14, 16, v87
    v_and_b32 v15, s79, v87
    v_pk_fma_f32 v[162:163], v[14:15], v[172:173], v[162:163]
    v_cvt_pk_bf16_f32 v162, v162, v163
    ds_write_b32 v66, v162 offset:2624
    v_lshlrev_b32 v12, 16, v88
    v_and_b32 v13, s79, v88
    v_pk_fma_f32 v[164:165], v[12:13], v[172:173], v[164:165]
    v_cvt_pk_bf16_f32 v164, v164, v165
    ds_write_b32 v66, v164 offset:3072
    v_lshlrev_b32 v14, 16, v89
    v_and_b32 v15, s79, v89
    v_pk_fma_f32 v[166:167], v[14:15], v[172:173], v[166:167]
    v_cvt_pk_bf16_f32 v166, v166, v167
    ds_write_b32 v66, v166 offset:3136
    v_lshlrev_b32 v12, 16, v90
    v_and_b32 v13, s79, v90
    v_pk_fma_f32 v[168:169], v[12:13], v[172:173], v[168:169]
    v_cvt_pk_bf16_f32 v168, v168, v169
    ds_write_b32 v66, v168 offset:3584
    v_lshlrev_b32 v14, 16, v91
    v_and_b32_e64 v15, s79, v91
    v_pk_fma_f32 v[170:171], v[14:15], v[172:173], v[170:171]
    v_cvt_pk_bf16_f32 v170, v170, v171
    ds_write_b32 v66, v170 offset:3648
    ds_read_b128 v[108:111], v62 offset:0
    ds_read_b128 v[112:115], v62 offset:1024
    ds_read_b128 v[116:119], v62 offset:2048
    ds_read_b128 v[120:123], v62 offset:3072
    s_lshl_b32 s78, s66, 7
    s_add_u32 s78, s78, 12582912
    s_waitcnt lgkmcnt(3)
    buffer_store_dwordx4 v[108:111], v67, s[28:31], s78 offen sc1
    s_add_u32 s78, s78, 655360
    s_waitcnt lgkmcnt(2)
    buffer_store_dwordx4 v[112:115], v67, s[28:31], s78 offen sc1
    s_add_u32 s78, s78, 655360
    s_waitcnt lgkmcnt(1)
    buffer_store_dwordx4 v[116:119], v67, s[28:31], s78 offen sc1
    s_add_u32 s78, s78, 655360
    s_waitcnt lgkmcnt(0)
    buffer_store_dwordx4 v[120:123], v67, s[28:31], s78 offen sc1
    s_add_u32 s78, s78, 655360
    s_cmp_eq_u32 s84, 0
    s_cbranch_scc1 Lpf_66
    s_add_u32 s92, s77, s83
    buffer_load_dword v217, v216, s[52:55], s92 offen
    s_add_u32 s83, s83, 512
    s_and_b32 s83, s83, 4095
    s_sub_u32 s84, s84, 1
Lpf_66:
    s_cmp_eq_u32 s84, 0
    s_cbranch_scc1 Lpf_67
    s_add_u32 s92, s77, s83
    buffer_load_dword v217, v216, s[52:55], s92 offen
    s_add_u32 s83, s83, 512
    s_and_b32 s83, s83, 4095
    s_sub_u32 s84, s84, 1
Lpf_67:
    s_cmp_lg_u32 s69, 0
    s_cbranch_scc1 L_conv_done
    s_cmp_ge_u32 s3, 4
    s_cbranch_scc1 L_conv_idle
    s_barrier
    s_mov_b32 s69, 1
    s_mov_b32 s75, 4
    s_lshr_b32 s76, s3, 1
    s_lshl_b32 s76, s76, 8
    s_and_b32 s78, s3, 1
    s_add_u32 s66, s70, 8
    s_add_u32 s66, s66, s78
    s_add_u32 s78, s78, 8
    s_sub_u32 s78, s78, s3
    s_mul_i32 s78, s78, 1568
    v_add_u32 v220, s78, v220
    v_add_u32 v221, s78, v221
    v_add_u32 v222, s78, v222
    v_add_u32 v223, s78, v223
    v_add_u32 v224, s78, v224
    v_add_u32 v225, s78, v225
    v_add_u32 v226, s78, v226
    v_add_u32 v227, s78, v227
    v_add_u32 v228, s78, v228
    v_add_u32 v229, s78, v229
    v_add_u32 v230, s78, v230
    v_add_u32 v231, s78, v231
    v_add_u32 v232, s78, v232
    v_add_u32 v233, s78, v233
    v_add_u32 v234, s78, v234
    v_add_u32 v235, s78, v235
    v_add_u32 v236, s78, v236
    v_add_u32 v237, s78, v237
    v_add_u32 v238, s78, v238
    v_add_u32 v239, s78, v239
    v_add_u32 v240, s78, v240
    v_add_u32 v241, s78, v241
    v_add_u32 v242, s78, v242
    v_add_u32 v243, s78, v243
    v_add_u32 v244, s78, v244
    v_add_u32 v245, s78, v245
    v_add_u32 v246, s78, v246
    v_add_u32 v247, s78, v247
    v_add_u32 v248, s78, v248
    v_add_u32 v249, s78, v249
    v_add_u32 v250, s78, v250
    v_add_u32 v251, s78, v251
    v_add_u32 v252, s78, v252
    v_add_u32 v253, s78, v253
    v_add_u32 v254, s78, v254
    v_add_u32 v255, s78, v255
    s_branch L_conv
L_conv_idle:
    s_lshr_b32 s78, s4, 3
    s_lshl_b32 s78, s78, 2
    s_add_u32 s78, s78, s3
    s_sub_u32 s78, s78, 4
    s_mul_i32 s78, s78, 54
    v_min_u32 v30, 53, v1
    v_add_u32 v30, s78, v30
    v_mul_u32_u24 v31, 1821, v30
    v_lshrrev_b32 v31, 20, v31
    v_mul_u32_u24 v29, 576, v31
    v_sub_u32 v30, v30, v29
    s_mov_b32 s78, 589824
    v_mul_lo_u32 v31, v31, s78
    v_lshl_add_u32 v30, v30, 7, v31
    s_and_b32 s80, s2, 1
    s_mul_i32 s80, s80, 1769472
    s_add_u32 s80, s80, 4194304
    s_and_b32 s81, s2, 6
    s_lshl_b32 s81, s81, 2
    s_add_u32 s81, s81, 8
    s_and_b32 s81, s81, 31
    s_mul_i32 s78, s81, 18432
    s_add_u32 s78, s78, s80
    buffer_load_dword v217, v30, s[28:31], s78 offen sc1
    s_add_u32 s81, s81, 4
    s_and_b32 s81, s81, 31
    s_mul_i32 s78, s81, 18432
    s_add_u32 s78, s78, s80
    buffer_load_dword v217, v30, s[28:31], s78 offen sc1
    s_add_u32 s81, s81, 4
    s_and_b32 s81, s81, 31
    s_mul_i32 s78, s81, 18432
    s_add_u32 s78, s78, s80
    buffer_load_dword v217, v30, s[28:31], s78 offen sc1
    s_add_u32 s81, s81, 4
    s_and_b32 s81, s81, 31
    s_mul_i32 s78, s81, 18432
    s_add_u32 s78, s78, s80
    buffer_load_dword v217, v30, s[28:31], s78 offen sc1
    s_add_u32 s81, s81, 4
    s_and_b32 s81, s81, 31
    s_mul_i32 s78, s81, 18432
    s_add_u32 s78, s78, s80
    buffer_load_dword v217, v30, s[28:31], s78 offen sc1
    s_add_u32 s81, s81, 4
    s_and_b32 s81, s81, 31
    s_mul_i32 s78, s81, 18432
    s_add_u32 s78, s78, s80
    buffer_load_dword v217, v30, s[28:31], s78 offen sc1
    s_add_u32 s81, s81, 4
    s_barrier
    s_barrier
L_conv_done:
    s_waitcnt vmcnt(0)
    s_barrier
    s_cmp_lg_u32 s3, 0
    s_cbranch_scc1 L_end
    s_lshl_b32 s78, s4, 7
    s_add_u32 s78, s78, 393216
    v_mov_b32 v12, s6
    v_lshlrev_b32 v13, 2, v1
    s_mov_b32 exec_hi, 0
    buffer_store_dword v12, v13, s[28:31], s78 offen sc1
    s_mov_b64 exec, -1
    s_branch L_end
L_end:
    s_endpgm
L_exit:
    s_endpgm
.p2align 8
.type L_gtab,@object
L_gtab:
.long 1280, 1280, 1280, 1280, 1278, 1278, 1278, 1276, 1276, 1276, 1276, 1276, 1274, 1274, 1274, 1272
.long 1272, 1272, 1272, 1272, 1270, 1270, 1270, 1268, 1268, 1268, 1268, 1268, 1266, 1266, 1266, 1264
.long 1264, 1264, 1264, 1264, 1262, 1262, 1262, 1260, 1260, 1260, 1260, 1260, 1258, 1258, 1258, 1256
.long 1256, 1256, 1256, 1256, 1254, 1254, 1254, 1252, 1252, 1252, 1252, 1252, 1250, 1250, 1250, 1248
.long 1248, 1248, 1248, 1248, 1246, 1246, 1246, 1244, 1244, 1244, 1244, 1244, 1242, 1242, 1242, 1240
.long 1240, 1240, 1240, 1240, 1238, 1238, 1238, 1236, 1236, 1236, 1236, 1236, 1234, 1234, 1234, 1232
.long 1232, 1232, 1232, 1232, 1230, 1230, 1230, 1228, 1228, 1228, 1228, 1228, 1226, 1226, 1226, 1224
.long 1224, 1224, 1224, 1224, 1222, 1222, 1222, 1220, 1220, 1220, 1220, 1220, 1218, 1218, 1218, 1216
.long 1216, 1216, 1216, 1216, 1214, 1214, 1214, 1212, 1212, 1212, 1212, 1212, 1210, 1210, 1210, 1208
.long 1208, 1208, 1208, 1208, 1206, 1206, 1206, 1204, 1204, 1204, 1204, 1204, 1202, 1202, 1202, 1200
.long 1200, 1200, 1200, 1200, 1198, 1198, 1198, 1196, 1196, 1196, 1196, 1196, 1194, 1194, 1194, 1192
.long 1192, 1192, 1192, 1192, 1190, 1190, 1190, 1188, 1188, 1188, 1188, 1188, 1186, 1186, 1186, 1184
.long 1184, 1184, 1184, 1184, 1182, 1182, 1182, 1180, 1180, 1180, 1180, 1180, 1178, 1178, 1178, 1176
.long 1176, 1176, 1176, 1176, 1174, 1174, 1174, 1172, 1172, 1172, 1172, 1172, 1170, 1170, 1170, 1168
.long 1168, 1168, 1168, 1168, 1166, 1166, 1166, 1164, 1164, 1164, 1164, 1164, 1162, 1162, 1162, 1160
.long 1160, 1160, 1160, 1160, 1158, 1158, 1158, 1156, 1156, 1156, 1156, 1156, 1154, 1154, 1154, 1152
.long 1278, 1278, 1278, 1278, 1276, 1276, 1276, 1276, 1274, 1274, 1274, 1274, 1272, 1272, 1272, 1272
.long 1270, 1270, 1270, 1270, 1268, 1268, 1268, 1268, 1266, 1266, 1266, 1266, 1264, 1264, 1264, 1264
.long 1262, 1262, 1262, 1262, 1260, 1260, 1260, 1260, 1258, 1258, 1258, 1258, 1256, 1256, 1256, 1256
.long 1254, 1254, 1254, 1254, 1252, 1252, 1252, 1252, 1250, 1250, 1250, 1250, 1248, 1248, 1248, 1248
.long 1246, 1246, 1246, 1246, 1244, 1244, 1244, 1244, 1242, 1242, 1242, 1242, 1240, 1240, 1240, 1240
.long 1238, 1238, 1238, 1238, 1236, 1236, 1236, 1236, 1234, 1234, 1234, 1234, 1232, 1232, 1232, 1232
.long 1230, 1230, 1230, 1230, 1228, 1228, 1228, 1228, 1226, 1226, 1226, 1226, 1224, 1224, 1224, 1224
.long 1222, 1222, 1222, 1222, 1220, 1220, 1220, 1220, 1218, 1218, 1218, 1218, 1216, 1216, 1216, 1216
.long 1214, 1214, 1214, 1214, 1212, 1212, 1212, 1212, 1210, 1210, 1210, 1210, 1208, 1208, 1208, 1208
.long 1206, 1206, 1206, 1206, 1204, 1204, 1204, 1204, 1202, 1202, 1202, 1202, 1200, 1200, 1200, 1200
.long 1198, 1198, 1198, 1198, 1196, 1196, 1196, 1196, 1194, 1194, 1194, 1194, 1192, 1192, 1192, 1192
.long 1190, 1190, 1190, 1190, 1188, 1188, 1188, 1188, 1186, 1186, 1186, 1186, 1184, 1184, 1184, 1184
.long 1182, 1182, 1182, 1182, 1180, 1180, 1180, 1180, 1178, 1178, 1178, 1178, 1176, 1176, 1176, 1176
.long 1174, 1174, 1174, 1174, 1172, 1172, 1172, 1172, 1170, 1170, 1170, 1170, 1168, 1168, 1168, 1168
.long 1166, 1166, 1166, 1166, 1164, 1164, 1164, 1164, 1162, 1162, 1162, 1162, 1160, 1160, 1160, 1160
.long 1158, 1158, 1158, 1158, 1156, 1156, 1156, 1156, 1154, 1154, 1154, 1154, 1152, 1152, 1152, 1152
.long 1278, 1152, 1152, 1152, 1276, 1150, 1150, 1150, 1274, 1148, 1148, 1148, 1272, 1146, 1146, 1146
.long 1270, 1144, 1144, 1144, 1268, 1142, 1142, 1142, 1266, 1140, 1140, 1140, 1264, 1138, 1138, 1138
.long 1262, 1136, 1136, 1136, 1260, 1134, 1134, 1134, 1258, 1132, 1132, 1132, 1256, 1130, 1130, 1130
.long 1254, 1128, 1128, 1128, 1252, 1126, 1126, 1126, 1250, 1124, 1124, 1124, 1248, 1122, 1122, 1122
.long 1246, 1120, 1120, 1120, 1244, 1118, 1118, 1118, 1242, 1116, 1116, 1116, 1240, 1114, 1114, 1114
.long 1238, 1112, 1112, 1112, 1236, 1110, 1110, 1110, 1234, 1108, 1108, 1108, 1232, 1106, 1106, 1106
.long 1230, 1104, 1104, 1104, 1228, 1102, 1102, 1102, 1226, 1100, 1100, 1100, 1224, 1098, 1098, 1098
.long 1222, 1096, 1096, 1096, 1220, 1094, 1094, 1094, 1218, 1092, 1092, 1092, 1216, 1090, 1090, 1090
.long 1214, 1088, 1088, 1088, 1212, 1086, 1086, 1086, 1210, 1084, 1084, 1084, 1208, 1082, 1082, 1082
.long 1206, 1080, 1080, 1080, 1204, 1078, 1078, 1078, 1202, 1076, 1076, 1076, 1200, 1074, 1074, 1074
.long 1198, 1072, 1072, 1072, 1196, 1070, 1070, 1070, 1194, 1068, 1068, 1068, 1192, 1066, 1066, 1066
.long 1190, 1064, 1064, 1064, 1188, 1062, 1062, 1062, 1186, 1060, 1060, 1060, 1184, 1058, 1058, 1058
.long 1182, 1056, 1056, 1056, 1180, 1054, 1054, 1054, 1178, 1052, 1052, 1052, 1176, 1050, 1050, 1050
.long 1174, 1048, 1048, 1048, 1172, 1046, 1046, 1046, 1170, 1044, 1044, 1044, 1168, 1042, 1042, 1042
.long 1166, 1040, 1040, 1040, 1164, 1038, 1038, 1038, 1162, 1036, 1036, 1036, 1160, 1034, 1034, 1034
.long 1158, 1032, 1032, 1032, 1156, 1030, 1030, 1030, 1154, 1028, 1028, 1028, 1152, 1026, 1026, 1026
.long 1152, 1150, 1150, 1150, 1148, 1148, 1148, 1148, 1148, 1146, 1146, 1146, 1144, 1144, 1144, 1144
.long 1144, 1142, 1142, 1142, 1140, 1140, 1140, 1140, 1140, 1138, 1138, 1138, 1136, 1136, 1136, 1136
.long 1136, 1134, 1134, 1134, 1132, 1132, 1132, 1132, 1132, 1130, 1130, 1130, 1128, 1128, 1128, 1128
.long 1128, 1126, 1126, 1126, 1124, 1124, 1124, 1124, 1124, 1122, 1122, 1122, 1120, 1120, 1120, 1120
.long 1120, 1118, 1118, 1118, 1116, 1116, 1116, 1116, 1116, 1114, 1114, 1114, 1112, 1112, 1112, 1112
.long 1112, 1110, 1110, 1110, 1108, 1108, 1108, 1108, 1108, 1106, 1106, 1106, 1104, 1104, 1104, 1104
.long 1104, 1102, 1102, 1102, 1100, 1100, 1100, 1100, 1100, 1098, 1098, 1098, 1096, 1096, 1096, 1096
.long 1096, 1094, 1094, 1094, 1092, 1092, 1092, 1092, 1092, 1090, 1090, 1090, 1088, 1088, 1088, 1088
.long 1088, 1086, 1086, 1086, 1084, 1084, 1084, 1084, 1084, 1082, 1082, 1082, 1080, 1080, 1080, 1080
.long 1080, 1078, 1078, 1078, 1076, 1076, 1076, 1076, 1076, 1074, 1074, 1074, 1072, 1072, 1072, 1072
.long 1072, 1070, 1070, 1070, 1068, 1068, 1068, 1068, 1068, 1066, 1066, 1066, 1064, 1064, 1064, 1064
.long 1064, 1062, 1062, 1062, 1060, 1060, 1060, 1060, 1060, 1058, 1058, 1058, 1056, 1056, 1056, 1056
.long 1056, 1054, 1054, 1054, 1052, 1052, 1052, 1052, 1052, 1050, 1050, 1050, 1048, 1048, 1048, 1048
.long 1048, 1046, 1046, 1046, 1044, 1044, 1044, 1044, 1044, 1042, 1042, 1042, 1040, 1040, 1040, 1040
.long 1040, 1038, 1038, 1038, 1036, 1036, 1036, 1036, 1036, 1034, 1034, 1034, 1032, 1032, 1032, 1032
.long 1032, 1030, 1030, 1030, 1028, 1028, 1028, 1028, 1028, 1026, 1026, 1026, 1024, 1024, 1024, 1024
.long 1150, 1150, 1024, 1024, 1148, 1148, 1020, 1020, 1146, 1146, 1016, 1016, 1144, 1144, 1012, 1012
.long 1142, 1142, 1008, 1008, 1140, 1140, 1004, 1004, 1138, 1138, 1000, 1000, 1136, 1136, 996, 996
.long 1134, 1134, 992, 992, 1132, 1132, 988, 988, 1130, 1130, 984, 984, 1128, 1128, 980, 980
.long 1126, 1126, 976, 976, 1124, 1124, 972, 972, 1122, 1122, 968, 968, 1120, 1120, 964, 964
.long 1118, 1118, 960, 960, 1116, 1116, 956, 956, 1114, 1114, 952, 952, 1112, 1112, 948, 948
.long 1110, 1110, 944, 944, 1108, 1108, 940, 940, 1106, 1106, 936, 936, 1104, 1104, 932, 932
.long 1102, 1102, 928, 928, 1100, 1100, 924, 924, 1098, 1098, 920, 920, 1096, 1096, 916, 916
.long 1094, 1094, 912, 912, 1092, 1092, 908, 908, 1090, 1090, 904, 904, 1088, 1088, 900, 900
.long 1086, 1086, 896, 896, 1084, 1084, 892, 892, 1082, 1082, 888, 888, 1080, 1080, 884, 884
.long 1078, 1078, 880, 880, 1076, 1076, 876, 876, 1074, 1074, 872, 872, 1072, 1072, 868, 868
.long 1070, 1070, 864, 864, 1068, 1068, 860, 860, 1066, 1066, 856, 856, 1064, 1064, 852, 852
.long 1062, 1062, 848, 848, 1060, 1060, 844, 844, 1058, 1058, 840, 840, 1056, 1056, 836, 836
.long 1054, 1054, 832, 832, 1052, 1052, 828, 828, 1050, 1050, 824, 824, 1048, 1048, 820, 820
.long 1046, 1046, 816, 816, 1044, 1044, 812, 812, 1042, 1042, 808, 808, 1040, 1040, 804, 804
.long 1038, 1038, 800, 800, 1036, 1036, 796, 796, 1034, 1034, 792, 792, 1032, 1032, 788, 788
.long 1030, 1030, 784, 784, 1028, 1028, 780, 780, 1026, 1026, 776, 776, 1024, 1024, 772, 772
.long 1022, 1022, 1022, 1020, 1018, 1018, 1018, 1016, 1014, 1014, 1014, 1012, 1010, 1010, 1010, 1008
.long 1006, 1006, 1006, 1004, 1002, 1002, 1002, 1000, 998, 998, 998, 996, 994, 994, 994, 992
.long 990, 990, 990, 988, 986, 986, 986, 984, 982, 982, 982, 980, 978, 978, 978, 976
.long 974, 974, 974, 972, 970, 970, 970, 968, 966, 966, 966, 964, 962, 962, 962, 960
.long 958, 958, 958, 956, 954, 954, 954, 952, 950, 950, 950, 948, 946, 946, 946, 944
.long 942, 942, 942, 940, 938, 938, 938, 936, 934, 934, 934, 932, 930, 930, 930, 928
.long 926, 926, 926, 924, 922, 922, 922, 920, 918, 918, 918, 916, 914, 914, 914, 912
.long 910, 910, 910, 908, 906, 906, 906, 904, 902, 902, 902, 900, 898, 898, 898, 896
.long 894, 894, 894, 892, 890, 890, 890, 888, 886, 886, 886, 884, 882, 882, 882, 880
.long 878, 878, 878, 876, 874, 874, 874, 872, 870, 870, 870, 868, 866, 866, 866, 864
.long 862, 862, 862, 860, 858, 858, 858, 856, 854, 854, 854, 852, 850, 850, 850, 848
.long 846, 846, 846, 844, 842, 842, 842, 840, 838, 838, 838, 836, 834, 834, 834, 832
.long 830, 830, 830, 828, 826, 826, 826, 824, 822, 822, 822, 820, 818, 818, 818, 816
.long 814, 814, 814, 812, 810, 810, 810, 808, 806, 806, 806, 804, 802, 802, 802, 800
.long 798, 798, 798, 796, 794, 794, 794, 792, 790, 790, 790, 788, 786, 786, 786, 784
.long 782, 782, 782, 780, 778, 778, 778, 776, 774, 774, 774, 772, 770, 770, 770, 768
.long 1020, 1020, 1020, 768, 1016, 1016, 1016, 760, 1012, 1012, 1012, 752, 1008, 1008, 1008, 744
.long 1004, 1004, 1004, 736, 1000, 1000, 1000, 728, 996, 996, 996, 720, 992, 992, 992, 712
.long 988, 988, 988, 704, 984, 984, 984, 696, 980, 980, 980, 688, 976, 976, 976, 680
.long 972, 972, 972, 672, 968, 968, 968, 664, 964, 964, 964, 656, 960, 960, 960, 648
.long 956, 956, 956, 640, 952, 952, 952, 632, 948, 948, 948, 624, 944, 944, 944, 616
.long 940, 940, 940, 608, 936, 936, 936, 600, 932, 932, 932, 592, 928, 928, 928, 584
.long 924, 924, 924, 576, 920, 920, 920, 568, 916, 916, 916, 560, 912, 912, 912, 552
.long 908, 908, 908, 544, 904, 904, 904, 536, 900, 900, 900, 528, 896, 896, 896, 520
.long 892, 892, 892, 510, 888, 888, 888, 494, 884, 884, 884, 478, 880, 880, 880, 462
.long 876, 876, 876, 446, 872, 872, 872, 430, 868, 868, 868, 414, 864, 864, 864, 398
.long 860, 860, 860, 382, 856, 856, 856, 366, 852, 852, 852, 350, 848, 848, 848, 334
.long 844, 844, 844, 318, 840, 840, 840, 302, 836, 836, 836, 286, 832, 832, 832, 270
.long 828, 828, 828, 254, 824, 824, 824, 238, 820, 820, 820, 222, 816, 816, 816, 206
.long 812, 812, 812, 190, 808, 808, 808, 174, 804, 804, 804, 158, 800, 800, 800, 142
.long 796, 796, 796, 126, 792, 792, 792, 110, 788, 788, 788, 94, 784, 784, 784, 78
.long 780, 780, 780, 62, 776, 776, 776, 46, 772, 772, 772, 30, 768, 768, 768, 14
.long 766, 764, 764, 764, 758, 756, 756, 756, 750, 748, 748, 748, 742, 740, 740, 740
.long 734, 732, 732, 732, 726, 724, 724, 724, 718, 716, 716, 716, 710, 708, 708, 708
.long 702, 700, 700, 700, 694, 692, 692, 692, 686, 684, 684, 684, 678, 676, 676, 676
.long 670, 668, 668, 668, 662, 660, 660, 660, 654, 652, 652, 652, 646, 644, 644, 644
.long 638, 636, 636, 636, 630, 628, 628, 628, 622, 620, 620, 620, 614, 612, 612, 612
.long 606, 604, 604, 604, 598, 596, 596, 596, 590, 588, 588, 588, 582, 580, 580, 580
.long 574, 572, 572, 572, 566, 564, 564, 564, 558, 556, 556, 556, 550, 548, 548, 548
.long 542, 540, 540, 540, 534, 532, 532, 532, 526, 524, 524, 524, 518, 516, 516, 516
.long 508, 506, 504, 502, 492, 490, 488, 486, 476, 474, 472, 470, 460, 458, 456, 454
.long 444, 442, 440, 438, 428, 426, 424, 422, 412, 410, 408, 406, 396, 394, 392, 390
.long 380, 378, 376, 374, 364, 362, 360, 358, 348, 346, 344, 342, 332, 330, 328, 326
.long 316, 314, 312, 310, 300, 298, 296, 294, 284, 282, 280, 278, 268, 266, 264, 262
.long 252, 250, 248, 246, 236, 234, 232, 230, 220, 218, 216, 214, 204, 202, 200, 198
.long 188, 186, 184, 182, 172, 170, 168, 166, 156, 154, 152, 150, 140, 138, 136, 134
.long 124, 122, 120, 118, 108, 106, 104, 102, 92, 90, 88, 86, 76, 74, 72, 70
.long 60, 58, 56, 54, 44, 42, 40, 38, 28, 26, 24, 22, 12, 10, 8, 6
.long 762, 760, 760, 760, 754, 752, 752, 752, 746, 744, 744, 744, 738, 736, 736, 736
.long 730, 728, 728, 728, 722, 720, 720, 720, 714, 712, 712, 712, 706, 704, 704, 704
.long 698, 696, 696, 696, 690, 688, 688, 688, 682, 680, 680, 680, 674, 672, 672, 672
.long 666, 664, 664, 664, 658, 656, 656, 656, 650, 648, 648, 648, 642, 640, 640, 640
.long 634, 632, 632, 632, 626, 624, 624, 624, 618, 616, 616, 616, 610, 608, 608, 608
.long 602, 600, 600, 600, 594, 592, 592, 592, 586, 584, 584, 584, 578, 576, 576, 576
.long 570, 568, 568, 568, 562, 560, 560, 560, 554, 552, 552, 552, 546, 544, 544, 544
.long 538, 536, 536, 536, 530, 528, 528, 528, 522, 520, 520, 520, 514, 512, 512, 510
.long 500, 498, 496, 494, 484, 482, 480, 478, 468, 466, 464, 462, 452, 450, 448, 446
.long 436, 434, 432, 430, 420, 418, 416, 414, 404, 402, 400, 398, 388, 386, 384, 382
.long 372, 370, 368, 366, 356, 354, 352, 350, 340, 338, 336, 334, 324, 322, 320, 318
.long 308, 306, 304, 302, 292, 290, 288, 286, 276, 274, 272, 270, 260, 258, 256, 254
.long 244, 242, 240, 238, 228, 226, 224, 222, 212, 210, 208, 206, 196, 194, 192, 190
.long 180, 178, 176, 174, 164, 162, 160, 158, 148, 146, 144, 142, 132, 130, 128, 126
.long 116, 114, 112, 110, 100, 98, 96, 94, 84, 82, 80, 78, 68, 66, 64, 62
.long 52, 50, 48, 46, 36, 34, 32, 30, 20, 18, 16, 14, 4, 2, 0, 1536
L_tabend:
.section .rodata,"a"
.p2align 6
.amdhsa_kernel parallel_sum__ssm_conv_s4d__mixer_gmlp__prompt_kernel
  .amdhsa_next_free_vgpr 256
  .amdhsa_next_free_sgpr 102
  .amdhsa_accum_offset 256
  .amdhsa_group_segment_fixed_size 0
  .amdhsa_kernarg_size 120
  .amdhsa_user_sgpr_count 2
  .amdhsa_user_sgpr_kernarg_segment_ptr 1
  .amdhsa_system_sgpr_workgroup_id_x 1
.end_amdhsa_kernel
```
